```python
import torch

def _softmax(x, axis=-1):
    return torch.softmax(x, dim=axis)
def _gelu(x):
    return torch.nn.functional.gelu(x, approximate="tanh")
def _silu(x):
    return torch.nn.functional.silu(x)
def _sigmoid(x):
    return torch.sigmoid(x)
def _layernorm(x, axis=-1, eps=1e-5):
    m = x.mean(dim=axis, keepdim=True)
    v = x.var(dim=axis, keepdim=True, unbiased=False)
    return (x - m) / torch.sqrt(v + eps)
def _scatter_add(tgt, idx, src, axis=0):
    return tgt.clone().index_add_(axis, idx, src)
def _segment_sum(src, seg, n):
    out = torch.zeros((n,) + src.shape[1:], dtype=src.dtype)
    return out.index_add_(0, seg, src)
def _pad(x, pw):
    flat = tuple(v for pair in reversed(pw) for v in pair)
    return torch.nn.functional.pad(x, flat)

kernel_name = 'recurrent_scan__ssm_conv_s5__dense_activation_silu__prompt'

def setup_inputs():

    _w = (lambda a: (lambda t: t.to(torch.bfloat16) if t.is_floating_point() else t)(torch.as_tensor(a)))
    def _A_setup():
        B, S, D = 1, 2048, 640
        P = D
        Lambda_re = -0.5 * (lambda _x: torch.exp(torch.as_tensor(_x)))((lambda *s: torch.randn(*s, dtype=torch.bfloat16) * 0.8)(P))
        Lambda_im = (lambda *s: torch.randn(*s, dtype=torch.bfloat16) * 0.8)(P) * 1.0
        B_re = (lambda *s: torch.randn(*s, dtype=torch.bfloat16) * 0.8)(P, D) * (D ** -0.5)
        B_im = (lambda *s: torch.randn(*s, dtype=torch.bfloat16) * 0.8)(P, D) * (D ** -0.5)
        C_re = (lambda *s: torch.randn(*s, dtype=torch.bfloat16) * 0.8)(D, P) * (P ** -0.5)
        C_im = (lambda *s: torch.randn(*s, dtype=torch.bfloat16) * 0.8)(D, P) * (P ** -0.5)
        log_dt = (lambda *s: torch.randn(*s, dtype=torch.bfloat16) * 0.8)(P) * 0.3 - 2.0
        Dskip = (lambda *s: torch.randn(*s, dtype=torch.bfloat16) * 0.4)(D)
        return {
            "x": _w((lambda *s: torch.randn(*s, dtype=torch.bfloat16) * 0.05)(B, S, D)),
            "Lambda_re": _w(Lambda_re),
            "Lambda_im": _w(Lambda_im),
            "B_re": _w(B_re),
            "B_im": _w(B_im),
            "C_re": _w(C_re),
            "C_im": _w(C_im),
            "log_dt": _w(log_dt),
            "Dskip": _w(Dskip),
        }
    _A_in = _A_setup()

    def _B_setup():
        B, S, D, F = 1, 2048, 640, 1536
        return {
            "x": _w((lambda *s: torch.randn(*s, dtype=torch.bfloat16) * 0.05)(B, S, D)),
            "w1": _w((lambda *s: torch.randn(*s, dtype=torch.bfloat16) * 0.8)(D, F) * (D ** -0.5)),
            "w2": _w((lambda *s: torch.randn(*s, dtype=torch.bfloat16) * 0.1)(F, D) * (F ** -0.5)),
        }
    _B_in = _B_setup()

    return {
        "A_x": _A_in["x"],
        "A_Lambda_re": _A_in["Lambda_re"],
        "A_Lambda_im": _A_in["Lambda_im"],
        "A_B_re": _A_in["B_re"],
        "A_B_im": _A_in["B_im"],
        "A_C_re": _A_in["C_re"],
        "A_C_im": _A_in["C_im"],
        "A_log_dt": _A_in["log_dt"],
        "A_Dskip": _A_in["Dskip"],
        "B_x": _B_in["x"],
        "B_w1": _B_in["w1"],
        "B_w2": _B_in["w2"],
    }

def reference(A_x, A_Lambda_re, A_Lambda_im, A_B_re, A_B_im, A_C_re, A_C_im, A_log_dt, A_Dskip, B_x, B_w1, B_w2):
    def _A_ref(x, Lambda_re, Lambda_im, B_re, B_im, C_re, C_im, log_dt, Dskip):
        Bsz, L, H = x.shape
        Lam = Lambda_re + 1j * Lambda_im
        Bmat = B_re + 1j * B_im
        Cmat = C_re + 1j * C_im
        dt = torch.exp(log_dt)
        Lam_bar = torch.exp(dt * Lam)
        B_bar = ((Lam_bar - 1.0) / Lam)[:, None] * Bmat
        Bu = torch.einsum("bld,pd->blp", x + 0j, B_bar)
        h = torch.zeros_like(Bu[:, 0, :])
        hs = []
        for t in range(L):
            h = Lam_bar[None, :] * h + Bu[:, t, :]
            hs.append(h)
        hseq = torch.stack(hs, 1)
        y = 2.0 * torch.einsum("blp,dp->bld", hseq, Cmat).real + x * Dskip[None, None, :]
        return y

    def _B_ref(x, w1, w2):
        h = torch.einsum("bsd,df->bsf", x, w1)
        h = _silu(h)
        out = torch.einsum("bsf,fd->bsd", h, w2)
        return out

    x = A_x
    xn = _layernorm(x, axis=-1)
    s = _A_ref(xn, A_Lambda_re, A_Lambda_im, A_B_re, A_B_im, A_C_re, A_C_im, A_log_dt, A_Dskip)
    g = _silu(_B_ref(xn, B_w1, B_w2))
    return x + s * g
```

```asm
; @launch kernel=k0_kernel grid=(708,1,1) block=(256,1,1) lds=9216
; @launch kernel=k1_kernel grid=(256,1,1) block=(384,1,1) lds=163840
; @launch kernel=k2_kernel grid=(256,1,1) block=(256,1,1) lds=147456
.amdgcn_target "amdgcn-amd-amdhsa--gfx950"
.text
.globl k0_kernel
.p2align 8
.type k0_kernel,@function
k0_kernel:
    s_load_dwordx2 s[20:21], s[0:1], 0
    s_load_dwordx4 s[24:27], s[0:1], 24
    s_load_dwordx4 s[28:31], s[0:1], 40
    s_load_dwordx4 s[32:35], s[0:1], 80
    s_load_dwordx2 s[36:37], s[0:1], 112
    s_waitcnt lgkmcnt(0)
    s_mov_b32 s8, s36
    s_and_b32 s9, s37, 0xffff
    s_mov_b32 s10, 22446080
    s_mov_b32 s11, 0x00020000
    s_cmp_lt_u32 s2, 128
    s_cbranch_scc1 k0_ln
    s_cmp_lt_u32 s2, 128
    s_cbranch_scc1 k0_cpb
    s_cmp_lt_u32 s2, 128
    s_cbranch_scc1 k0_tw1
    s_cmp_lt_u32 s2, 128
    s_cbranch_scc1 k0_ilc
    s_cmp_lt_u32 s2, 368
    s_cbranch_scc1 k0_tw2
    s_cmp_lt_u32 s2, 388
    s_cbranch_scc0 k0_pf
    s_sub_u32 s3, s2, 368
    s_lshl_b32 s3, s3, 12
    s_add_u32 s3, s3, 21970944
    v_lshlrev_b32 v1, 4, v0
    v_add_u32 v1, s3, v1
    v_mov_b32 v4, -1
    v_mov_b32 v5, -1
    v_mov_b32 v6, -1
    v_mov_b32 v7, -1
    buffer_store_dwordx4 v[4:7], v1, s[8:11], 0 offen
k0_exit:
    s_endpgm
k0_pf:
    s_cmp_lt_u32 s2, 708
    s_cbranch_scc0 k0_exit
    s_cmp_lt_u32 s2, 708
    s_cbranch_scc1 k0_pf2
    s_sub_u32 s3, s2, 708
    s_lshr_b32 s3, s3, 3
    s_lshl_b32 s3, s3, 14
    s_getpc_b64 s[16:17]
k0_pc:
    s_add_u32 s16, s16, k1_kernel-k0_pc
    s_addc_u32 s17, s17, 0
    v_lshlrev_b32 v1, 4, v0
    v_add_u32 v1, s3, v1
    s_mov_b32 s4, k_code_end-k1_kernel-16
    v_cmp_ge_u32 vcc, s4, v1
    s_and_saveexec_b64 s[6:7], vcc
    s_cbranch_execz k0_cp_done
    global_load_dwordx4 v[4:7], v1, s[16:17]
    v_add_u32 v1, 4096, v1
    v_cmp_ge_u32 vcc, s4, v1
    s_and_saveexec_b64 s[6:7], vcc
    s_cbranch_execz k0_cp_done
    global_load_dwordx4 v[8:11], v1, s[16:17]
    v_add_u32 v1, 4096, v1
    v_cmp_ge_u32 vcc, s4, v1
    s_and_saveexec_b64 s[6:7], vcc
    s_cbranch_execz k0_cp_done
    global_load_dwordx4 v[12:15], v1, s[16:17]
    v_add_u32 v1, 4096, v1
    v_cmp_ge_u32 vcc, s4, v1
    s_and_saveexec_b64 s[6:7], vcc
    s_cbranch_execz k0_cp_done
    global_load_dwordx4 v[16:19], v1, s[16:17]
    v_add_u32 v1, 4096, v1
k0_cp_done:
    s_waitcnt vmcnt(0)
    s_endpgm
k0_pf2:
    s_sub_u32 s3, s2, 388
    s_mov_b32 s12, s24
    s_mov_b32 s13, s25
    s_mov_b32 s14, 819200
    s_mov_b32 s6, s3
    s_sub_u32 s7, s3, 50
    s_cmp_ge_u32 s3, 50
    s_cselect_b32 s12, s26, s12
    s_cselect_b32 s13, s27, s13
    s_cselect_b32 s6, s7, s6
    s_sub_u32 s7, s3, 100
    s_cmp_ge_u32 s3, 100
    s_cselect_b32 s12, s28, s12
    s_cselect_b32 s13, s29, s13
    s_cselect_b32 s6, s7, s6
    s_sub_u32 s7, s3, 150
    s_cmp_ge_u32 s3, 150
    s_cselect_b32 s12, s30, s12
    s_cselect_b32 s13, s31, s13
    s_cselect_b32 s6, s7, s6
    s_sub_u32 s7, s3, 200
    s_cmp_ge_u32 s3, 200
    s_cselect_b32 s12, s32, s12
    s_cselect_b32 s13, s33, s13
    s_cselect_b32 s6, s7, s6
    s_cselect_b32 s14, 1966080, s14
    s_and_b32 s13, s13, 0xffff
    s_mov_b32 s15, 0x00020000
    s_lshl_b32 s6, s6, 14
    v_lshlrev_b32 v1, 4, v0
    v_add_u32 v1, s6, v1
    buffer_load_dwordx4 v[4:7], v1, s[12:15], 0 offen
    v_add_u32 v1, 4096, v1
    buffer_load_dwordx4 v[8:11], v1, s[12:15], 0 offen
    v_add_u32 v1, 4096, v1
    buffer_load_dwordx4 v[12:15], v1, s[12:15], 0 offen
    v_add_u32 v1, 4096, v1
    buffer_load_dwordx4 v[16:19], v1, s[12:15], 0 offen
    v_add_u32 v1, 4096, v1
    s_waitcnt vmcnt(0)
    s_endpgm
k0_ln:
    s_mov_b32 s12, s20
    s_and_b32 s13, s21, 0xffff
    s_mov_b32 s14, 2621440
    s_mov_b32 s15, 0x00020000
    v_lshrrev_b32 v1, 4, v0
    v_and_b32 v2, 15, v0
    s_lshl_b32 s3, s2, 4
    v_add_u32 v1, s3, v1
    s_movk_i32 s4, 1408
    v_mul_lo_u32 v3, v1, s4
    v_lshl_add_u32 v3, v2, 4, v3
    s_movk_i32 s4, 1280
    v_mul_lo_u32 v1, v1, s4
    v_lshl_add_u32 v1, v2, 4, v1
    buffer_load_dwordx4 v[8:11], v1, s[12:15], 0 offen offset:0
    buffer_load_dwordx4 v[12:15], v1, s[12:15], 0 offen offset:256
    buffer_load_dwordx4 v[16:19], v1, s[12:15], 0 offen offset:512
    buffer_load_dwordx4 v[20:23], v1, s[12:15], 0 offen offset:768
    buffer_load_dwordx4 v[24:27], v1, s[12:15], 0 offen offset:1024
    s_waitcnt vmcnt(0)
    v_lshlrev_b32 v32, 16, v8
    v_and_b32 v33, 0xffff0000, v8
    v_lshlrev_b32 v34, 16, v9
    v_and_b32 v35, 0xffff0000, v9
    v_lshlrev_b32 v36, 16, v10
    v_and_b32 v37, 0xffff0000, v10
    v_lshlrev_b32 v38, 16, v11
    v_and_b32 v39, 0xffff0000, v11
    v_lshlrev_b32 v40, 16, v12
    v_and_b32 v41, 0xffff0000, v12
    v_lshlrev_b32 v42, 16, v13
    v_and_b32 v43, 0xffff0000, v13
    v_lshlrev_b32 v44, 16, v14
    v_and_b32 v45, 0xffff0000, v14
    v_lshlrev_b32 v46, 16, v15
    v_and_b32 v47, 0xffff0000, v15
    v_lshlrev_b32 v48, 16, v16
    v_and_b32 v49, 0xffff0000, v16
    v_lshlrev_b32 v50, 16, v17
    v_and_b32 v51, 0xffff0000, v17
    v_lshlrev_b32 v52, 16, v18
    v_and_b32 v53, 0xffff0000, v18
    v_lshlrev_b32 v54, 16, v19
    v_and_b32 v55, 0xffff0000, v19
    v_lshlrev_b32 v56, 16, v20
    v_and_b32 v57, 0xffff0000, v20
    v_lshlrev_b32 v58, 16, v21
    v_and_b32 v59, 0xffff0000, v21
    v_lshlrev_b32 v60, 16, v22
    v_and_b32 v61, 0xffff0000, v22
    v_lshlrev_b32 v62, 16, v23
    v_and_b32 v63, 0xffff0000, v23
    v_lshlrev_b32 v64, 16, v24
    v_and_b32 v65, 0xffff0000, v24
    v_lshlrev_b32 v66, 16, v25
    v_and_b32 v67, 0xffff0000, v25
    v_lshlrev_b32 v68, 16, v26
    v_and_b32 v69, 0xffff0000, v26
    v_lshlrev_b32 v70, 16, v27
    v_and_b32 v71, 0xffff0000, v27
    v_add_f32 v80, v32, v36
    v_add_f32 v81, v33, v37
    v_add_f32 v82, v34, v38
    v_add_f32 v83, v35, v39
    v_add_f32 v80, v80, v40
    v_add_f32 v81, v81, v41
    v_add_f32 v82, v82, v42
    v_add_f32 v83, v83, v43
    v_add_f32 v80, v80, v44
    v_add_f32 v81, v81, v45
    v_add_f32 v82, v82, v46
    v_add_f32 v83, v83, v47
    v_add_f32 v80, v80, v48
    v_add_f32 v81, v81, v49
    v_add_f32 v82, v82, v50
    v_add_f32 v83, v83, v51
    v_add_f32 v80, v80, v52
    v_add_f32 v81, v81, v53
    v_add_f32 v82, v82, v54
    v_add_f32 v83, v83, v55
    v_add_f32 v80, v80, v56
    v_add_f32 v81, v81, v57
    v_add_f32 v82, v82, v58
    v_add_f32 v83, v83, v59
    v_add_f32 v80, v80, v60
    v_add_f32 v81, v81, v61
    v_add_f32 v82, v82, v62
    v_add_f32 v83, v83, v63
    v_add_f32 v80, v80, v64
    v_add_f32 v81, v81, v65
    v_add_f32 v82, v82, v66
    v_add_f32 v83, v83, v67
    v_add_f32 v80, v80, v68
    v_add_f32 v81, v81, v69
    v_add_f32 v82, v82, v70
    v_add_f32 v83, v83, v71
    v_add_f32 v80, v80, v81
    v_add_f32 v82, v82, v83
    v_add_f32 v80, v80, v82
    s_nop 1
    v_add_f32_dpp v81, v80, v80 quad_perm:[1,0,3,2] row_mask:0xf bank_mask:0xf
    v_mov_b32 v80, v81
    s_nop 1
    v_add_f32_dpp v81, v80, v80 quad_perm:[2,3,0,1] row_mask:0xf bank_mask:0xf
    v_mov_b32 v80, v81
    s_nop 1
    v_add_f32_dpp v81, v80, v80 row_half_mirror row_mask:0xf bank_mask:0xf
    v_mov_b32 v80, v81
    s_nop 1
    v_add_f32_dpp v81, v80, v80 row_mirror row_mask:0xf bank_mask:0xf
    v_mov_b32 v80, v81
    s_mov_b32 s5, 0x3acccccd
    s_mov_b32 s6, 0x44200000
    v_mul_f32 v84, s5, v80
    v_fma_f32 v85, -v84, s6, v80
    v_fma_f32 v84, v85, s5, v84
    v_sub_f32 v86, v32, v84
    v_mul_f32 v80, v86, v86
    v_sub_f32 v87, v33, v84
    v_mul_f32 v81, v87, v87
    v_sub_f32 v88, v34, v84
    v_mul_f32 v82, v88, v88
    v_sub_f32 v89, v35, v84
    v_mul_f32 v83, v89, v89
    v_sub_f32 v86, v36, v84
    v_fma_f32 v80, v86, v86, v80
    v_sub_f32 v87, v37, v84
    v_fma_f32 v81, v87, v87, v81
    v_sub_f32 v88, v38, v84
    v_fma_f32 v82, v88, v88, v82
    v_sub_f32 v89, v39, v84
    v_fma_f32 v83, v89, v89, v83
    v_sub_f32 v86, v40, v84
    v_fma_f32 v80, v86, v86, v80
    v_sub_f32 v87, v41, v84
    v_fma_f32 v81, v87, v87, v81
    v_sub_f32 v88, v42, v84
    v_fma_f32 v82, v88, v88, v82
    v_sub_f32 v89, v43, v84
    v_fma_f32 v83, v89, v89, v83
    v_sub_f32 v86, v44, v84
    v_fma_f32 v80, v86, v86, v80
    v_sub_f32 v87, v45, v84
    v_fma_f32 v81, v87, v87, v81
    v_sub_f32 v88, v46, v84
    v_fma_f32 v82, v88, v88, v82
    v_sub_f32 v89, v47, v84
    v_fma_f32 v83, v89, v89, v83
    v_sub_f32 v86, v48, v84
    v_fma_f32 v80, v86, v86, v80
    v_sub_f32 v87, v49, v84
    v_fma_f32 v81, v87, v87, v81
    v_sub_f32 v88, v50, v84
    v_fma_f32 v82, v88, v88, v82
    v_sub_f32 v89, v51, v84
    v_fma_f32 v83, v89, v89, v83
    v_sub_f32 v86, v52, v84
    v_fma_f32 v80, v86, v86, v80
    v_sub_f32 v87, v53, v84
    v_fma_f32 v81, v87, v87, v81
    v_sub_f32 v88, v54, v84
    v_fma_f32 v82, v88, v88, v82
    v_sub_f32 v89, v55, v84
    v_fma_f32 v83, v89, v89, v83
    v_sub_f32 v86, v56, v84
    v_fma_f32 v80, v86, v86, v80
    v_sub_f32 v87, v57, v84
    v_fma_f32 v81, v87, v87, v81
    v_sub_f32 v88, v58, v84
    v_fma_f32 v82, v88, v88, v82
    v_sub_f32 v89, v59, v84
    v_fma_f32 v83, v89, v89, v83
    v_sub_f32 v86, v60, v84
    v_fma_f32 v80, v86, v86, v80
    v_sub_f32 v87, v61, v84
    v_fma_f32 v81, v87, v87, v81
    v_sub_f32 v88, v62, v84
    v_fma_f32 v82, v88, v88, v82
    v_sub_f32 v89, v63, v84
    v_fma_f32 v83, v89, v89, v83
    v_sub_f32 v86, v64, v84
    v_fma_f32 v80, v86, v86, v80
    v_sub_f32 v87, v65, v84
    v_fma_f32 v81, v87, v87, v81
    v_sub_f32 v88, v66, v84
    v_fma_f32 v82, v88, v88, v82
    v_sub_f32 v89, v67, v84
    v_fma_f32 v83, v89, v89, v83
    v_sub_f32 v86, v68, v84
    v_fma_f32 v80, v86, v86, v80
    v_sub_f32 v87, v69, v84
    v_fma_f32 v81, v87, v87, v81
    v_sub_f32 v88, v70, v84
    v_fma_f32 v82, v88, v88, v82
    v_sub_f32 v89, v71, v84
    v_fma_f32 v83, v89, v89, v83
    v_add_f32 v80, v80, v81
    v_add_f32 v82, v82, v83
    v_add_f32 v80, v80, v82
    s_nop 1
    v_add_f32_dpp v81, v80, v80 quad_perm:[1,0,3,2] row_mask:0xf bank_mask:0xf
    v_mov_b32 v80, v81
    s_nop 1
    v_add_f32_dpp v81, v80, v80 quad_perm:[2,3,0,1] row_mask:0xf bank_mask:0xf
    v_mov_b32 v80, v81
    s_nop 1
    v_add_f32_dpp v81, v80, v80 row_half_mirror row_mask:0xf bank_mask:0xf
    v_mov_b32 v80, v81
    s_nop 1
    v_add_f32_dpp v81, v80, v80 row_mirror row_mask:0xf bank_mask:0xf
    v_mov_b32 v80, v81
    v_mul_f32 v85, s5, v80
    v_fma_f32 v86, -v85, s6, v80
    v_fma_f32 v85, v86, s5, v85
    v_cvt_pk_bf16_f32 v84, v84, v84
    v_lshlrev_b32 v84, 16, v84
    v_cvt_pk_bf16_f32 v85, v85, v85
    v_lshlrev_b32 v85, 16, v85
    v_add_f32 v85, 0x3727c5ac, v85
    v_cvt_pk_bf16_f32 v85, v85, v85
    v_lshlrev_b32 v85, 16, v85
    v_sqrt_f32 v85, v85
    s_nop 0
    v_cvt_pk_bf16_f32 v85, v85, v85
    v_lshlrev_b32 v85, 16, v85
    v_rcp_f32 v86, v85
    s_nop 0
    v_sub_f32 v32, v32, v84
    v_sub_f32 v33, v33, v84
    v_cvt_pk_bf16_f32 v90, v32, v33
    v_lshlrev_b32 v32, 16, v90
    v_and_b32 v33, 0xffff0000, v90
    v_mul_f32 v91, v32, v86
    v_mul_f32 v92, v33, v86
    v_fma_f32 v93, -v91, v85, v32
    v_fma_f32 v94, -v92, v85, v33
    v_fma_f32 v91, v93, v86, v91
    v_fma_f32 v92, v94, v86, v92
    v_cvt_pk_bf16_f32 v8, v91, v92
    v_sub_f32 v34, v34, v84
    v_sub_f32 v35, v35, v84
    v_cvt_pk_bf16_f32 v90, v34, v35
    v_lshlrev_b32 v34, 16, v90
    v_and_b32 v35, 0xffff0000, v90
    v_mul_f32 v91, v34, v86
    v_mul_f32 v92, v35, v86
    v_fma_f32 v93, -v91, v85, v34
    v_fma_f32 v94, -v92, v85, v35
    v_fma_f32 v91, v93, v86, v91
    v_fma_f32 v92, v94, v86, v92
    v_cvt_pk_bf16_f32 v9, v91, v92
    v_sub_f32 v36, v36, v84
    v_sub_f32 v37, v37, v84
    v_cvt_pk_bf16_f32 v90, v36, v37
    v_lshlrev_b32 v36, 16, v90
    v_and_b32 v37, 0xffff0000, v90
    v_mul_f32 v91, v36, v86
    v_mul_f32 v92, v37, v86
    v_fma_f32 v93, -v91, v85, v36
    v_fma_f32 v94, -v92, v85, v37
    v_fma_f32 v91, v93, v86, v91
    v_fma_f32 v92, v94, v86, v92
    v_cvt_pk_bf16_f32 v10, v91, v92
    v_sub_f32 v38, v38, v84
    v_sub_f32 v39, v39, v84
    v_cvt_pk_bf16_f32 v90, v38, v39
    v_lshlrev_b32 v38, 16, v90
    v_and_b32 v39, 0xffff0000, v90
    v_mul_f32 v91, v38, v86
    v_mul_f32 v92, v39, v86
    v_fma_f32 v93, -v91, v85, v38
    v_fma_f32 v94, -v92, v85, v39
    v_fma_f32 v91, v93, v86, v91
    v_fma_f32 v92, v94, v86, v92
    v_cvt_pk_bf16_f32 v11, v91, v92
    v_sub_f32 v40, v40, v84
    v_sub_f32 v41, v41, v84
    v_cvt_pk_bf16_f32 v90, v40, v41
    v_lshlrev_b32 v40, 16, v90
    v_and_b32 v41, 0xffff0000, v90
    v_mul_f32 v91, v40, v86
    v_mul_f32 v92, v41, v86
    v_fma_f32 v93, -v91, v85, v40
    v_fma_f32 v94, -v92, v85, v41
    v_fma_f32 v91, v93, v86, v91
    v_fma_f32 v92, v94, v86, v92
    v_cvt_pk_bf16_f32 v12, v91, v92
    v_sub_f32 v42, v42, v84
    v_sub_f32 v43, v43, v84
    v_cvt_pk_bf16_f32 v90, v42, v43
    v_lshlrev_b32 v42, 16, v90
    v_and_b32 v43, 0xffff0000, v90
    v_mul_f32 v91, v42, v86
    v_mul_f32 v92, v43, v86
    v_fma_f32 v93, -v91, v85, v42
    v_fma_f32 v94, -v92, v85, v43
    v_fma_f32 v91, v93, v86, v91
    v_fma_f32 v92, v94, v86, v92
    v_cvt_pk_bf16_f32 v13, v91, v92
    v_sub_f32 v44, v44, v84
    v_sub_f32 v45, v45, v84
    v_cvt_pk_bf16_f32 v90, v44, v45
    v_lshlrev_b32 v44, 16, v90
    v_and_b32 v45, 0xffff0000, v90
    v_mul_f32 v91, v44, v86
    v_mul_f32 v92, v45, v86
    v_fma_f32 v93, -v91, v85, v44
    v_fma_f32 v94, -v92, v85, v45
    v_fma_f32 v91, v93, v86, v91
    v_fma_f32 v92, v94, v86, v92
    v_cvt_pk_bf16_f32 v14, v91, v92
    v_sub_f32 v46, v46, v84
    v_sub_f32 v47, v47, v84
    v_cvt_pk_bf16_f32 v90, v46, v47
    v_lshlrev_b32 v46, 16, v90
    v_and_b32 v47, 0xffff0000, v90
    v_mul_f32 v91, v46, v86
    v_mul_f32 v92, v47, v86
    v_fma_f32 v93, -v91, v85, v46
    v_fma_f32 v94, -v92, v85, v47
    v_fma_f32 v91, v93, v86, v91
    v_fma_f32 v92, v94, v86, v92
    v_cvt_pk_bf16_f32 v15, v91, v92
    v_sub_f32 v48, v48, v84
    v_sub_f32 v49, v49, v84
    v_cvt_pk_bf16_f32 v90, v48, v49
    v_lshlrev_b32 v48, 16, v90
    v_and_b32 v49, 0xffff0000, v90
    v_mul_f32 v91, v48, v86
    v_mul_f32 v92, v49, v86
    v_fma_f32 v93, -v91, v85, v48
    v_fma_f32 v94, -v92, v85, v49
    v_fma_f32 v91, v93, v86, v91
    v_fma_f32 v92, v94, v86, v92
    v_cvt_pk_bf16_f32 v16, v91, v92
    v_sub_f32 v50, v50, v84
    v_sub_f32 v51, v51, v84
    v_cvt_pk_bf16_f32 v90, v50, v51
    v_lshlrev_b32 v50, 16, v90
    v_and_b32 v51, 0xffff0000, v90
    v_mul_f32 v91, v50, v86
    v_mul_f32 v92, v51, v86
    v_fma_f32 v93, -v91, v85, v50
    v_fma_f32 v94, -v92, v85, v51
    v_fma_f32 v91, v93, v86, v91
    v_fma_f32 v92, v94, v86, v92
    v_cvt_pk_bf16_f32 v17, v91, v92
    v_sub_f32 v52, v52, v84
    v_sub_f32 v53, v53, v84
    v_cvt_pk_bf16_f32 v90, v52, v53
    v_lshlrev_b32 v52, 16, v90
    v_and_b32 v53, 0xffff0000, v90
    v_mul_f32 v91, v52, v86
    v_mul_f32 v92, v53, v86
    v_fma_f32 v93, -v91, v85, v52
    v_fma_f32 v94, -v92, v85, v53
    v_fma_f32 v91, v93, v86, v91
    v_fma_f32 v92, v94, v86, v92
    v_cvt_pk_bf16_f32 v18, v91, v92
    v_sub_f32 v54, v54, v84
    v_sub_f32 v55, v55, v84
    v_cvt_pk_bf16_f32 v90, v54, v55
    v_lshlrev_b32 v54, 16, v90
    v_and_b32 v55, 0xffff0000, v90
    v_mul_f32 v91, v54, v86
    v_mul_f32 v92, v55, v86
    v_fma_f32 v93, -v91, v85, v54
    v_fma_f32 v94, -v92, v85, v55
    v_fma_f32 v91, v93, v86, v91
    v_fma_f32 v92, v94, v86, v92
    v_cvt_pk_bf16_f32 v19, v91, v92
    v_sub_f32 v56, v56, v84
    v_sub_f32 v57, v57, v84
    v_cvt_pk_bf16_f32 v90, v56, v57
    v_lshlrev_b32 v56, 16, v90
    v_and_b32 v57, 0xffff0000, v90
    v_mul_f32 v91, v56, v86
    v_mul_f32 v92, v57, v86
    v_fma_f32 v93, -v91, v85, v56
    v_fma_f32 v94, -v92, v85, v57
    v_fma_f32 v91, v93, v86, v91
    v_fma_f32 v92, v94, v86, v92
    v_cvt_pk_bf16_f32 v20, v91, v92
    v_sub_f32 v58, v58, v84
    v_sub_f32 v59, v59, v84
    v_cvt_pk_bf16_f32 v90, v58, v59
    v_lshlrev_b32 v58, 16, v90
    v_and_b32 v59, 0xffff0000, v90
    v_mul_f32 v91, v58, v86
    v_mul_f32 v92, v59, v86
    v_fma_f32 v93, -v91, v85, v58
    v_fma_f32 v94, -v92, v85, v59
    v_fma_f32 v91, v93, v86, v91
    v_fma_f32 v92, v94, v86, v92
    v_cvt_pk_bf16_f32 v21, v91, v92
    v_sub_f32 v60, v60, v84
    v_sub_f32 v61, v61, v84
    v_cvt_pk_bf16_f32 v90, v60, v61
    v_lshlrev_b32 v60, 16, v90
    v_and_b32 v61, 0xffff0000, v90
    v_mul_f32 v91, v60, v86
    v_mul_f32 v92, v61, v86
    v_fma_f32 v93, -v91, v85, v60
    v_fma_f32 v94, -v92, v85, v61
    v_fma_f32 v91, v93, v86, v91
    v_fma_f32 v92, v94, v86, v92
    v_cvt_pk_bf16_f32 v22, v91, v92
    v_sub_f32 v62, v62, v84
    v_sub_f32 v63, v63, v84
    v_cvt_pk_bf16_f32 v90, v62, v63
    v_lshlrev_b32 v62, 16, v90
    v_and_b32 v63, 0xffff0000, v90
    v_mul_f32 v91, v62, v86
    v_mul_f32 v92, v63, v86
    v_fma_f32 v93, -v91, v85, v62
    v_fma_f32 v94, -v92, v85, v63
    v_fma_f32 v91, v93, v86, v91
    v_fma_f32 v92, v94, v86, v92
    v_cvt_pk_bf16_f32 v23, v91, v92
    v_sub_f32 v64, v64, v84
    v_sub_f32 v65, v65, v84
    v_cvt_pk_bf16_f32 v90, v64, v65
    v_lshlrev_b32 v64, 16, v90
    v_and_b32 v65, 0xffff0000, v90
    v_mul_f32 v91, v64, v86
    v_mul_f32 v92, v65, v86
    v_fma_f32 v93, -v91, v85, v64
    v_fma_f32 v94, -v92, v85, v65
    v_fma_f32 v91, v93, v86, v91
    v_fma_f32 v92, v94, v86, v92
    v_cvt_pk_bf16_f32 v24, v91, v92
    v_sub_f32 v66, v66, v84
    v_sub_f32 v67, v67, v84
    v_cvt_pk_bf16_f32 v90, v66, v67
    v_lshlrev_b32 v66, 16, v90
    v_and_b32 v67, 0xffff0000, v90
    v_mul_f32 v91, v66, v86
    v_mul_f32 v92, v67, v86
    v_fma_f32 v93, -v91, v85, v66
    v_fma_f32 v94, -v92, v85, v67
    v_fma_f32 v91, v93, v86, v91
    v_fma_f32 v92, v94, v86, v92
    v_cvt_pk_bf16_f32 v25, v91, v92
    v_sub_f32 v68, v68, v84
    v_sub_f32 v69, v69, v84
    v_cvt_pk_bf16_f32 v90, v68, v69
    v_lshlrev_b32 v68, 16, v90
    v_and_b32 v69, 0xffff0000, v90
    v_mul_f32 v91, v68, v86
    v_mul_f32 v92, v69, v86
    v_fma_f32 v93, -v91, v85, v68
    v_fma_f32 v94, -v92, v85, v69
    v_fma_f32 v91, v93, v86, v91
    v_fma_f32 v92, v94, v86, v92
    v_cvt_pk_bf16_f32 v26, v91, v92
    v_sub_f32 v70, v70, v84
    v_sub_f32 v71, v71, v84
    v_cvt_pk_bf16_f32 v90, v70, v71
    v_lshlrev_b32 v70, 16, v90
    v_and_b32 v71, 0xffff0000, v90
    v_mul_f32 v91, v70, v86
    v_mul_f32 v92, v71, v86
    v_fma_f32 v93, -v91, v85, v70
    v_fma_f32 v94, -v92, v85, v71
    v_fma_f32 v91, v93, v86, v91
    v_fma_f32 v92, v94, v86, v92
    v_cvt_pk_bf16_f32 v27, v91, v92
    buffer_store_dwordx4 v[8:11], v3, s[8:11], 0 offen offset:0
    buffer_store_dwordx4 v[12:15], v3, s[8:11], 0 offen offset:256
    buffer_store_dwordx4 v[16:19], v3, s[8:11], 0 offen offset:512
    buffer_store_dwordx4 v[20:23], v3, s[8:11], 0 offen offset:768
    buffer_store_dwordx4 v[24:27], v3, s[8:11], 0 offen offset:1024
    s_waitcnt vmcnt(0)
    s_endpgm
k0_cpb:
    s_sub_u32 s3, s2, 128
    s_mov_b32 s4, 0x1999999a
    s_mul_hi_u32 s5, s3, s4
    s_mul_i32 s6, s5, 10
    s_sub_u32 s6, s3, s6
    s_cmp_ge_u32 s6, 5
    s_cselect_b32 s12, s26, s24
    s_cselect_b32 s13, s27, s25
    s_cselect_b32 s7, 5, 0
    s_and_b32 s13, s13, 0xffff
    s_mov_b32 s14, 819200
    s_mov_b32 s15, 0x00020000
    s_sub_u32 s6, s6, s7
    s_mul_i32 s5, s5, 80
    s_lshl_b32 s6, s6, 4
    s_add_u32 s5, s5, s6
    v_lshrrev_b32 v1, 4, v0
    v_and_b32 v2, 15, v0
    s_movk_i32 s4, 1280
    v_add_u32 v3, s5, v1
    v_mul_lo_u32 v3, v3, s4
    v_lshl_add_u32 v3, v2, 4, v3
    s_lshl_b32 s6, s3, 4
    v_add_u32 v4, s6, v1
    s_movk_i32 s4, 1408
    v_mul_lo_u32 v4, v4, s4
    v_lshl_add_u32 v4, v2, 4, v4
    v_add_u32 v4, 2883584, v4
    buffer_load_dwordx4 v[8:11], v3, s[12:15], 0 offen offset:0
    buffer_load_dwordx4 v[12:15], v3, s[12:15], 0 offen offset:256
    buffer_load_dwordx4 v[16:19], v3, s[12:15], 0 offen offset:512
    buffer_load_dwordx4 v[20:23], v3, s[12:15], 0 offen offset:768
    buffer_load_dwordx4 v[24:27], v3, s[12:15], 0 offen offset:1024
    s_waitcnt vmcnt(0)
    buffer_store_dwordx4 v[8:11], v4, s[8:11], 0 offen offset:0
    buffer_store_dwordx4 v[12:15], v4, s[8:11], 0 offen offset:256
    buffer_store_dwordx4 v[16:19], v4, s[8:11], 0 offen offset:512
    buffer_store_dwordx4 v[20:23], v4, s[8:11], 0 offen offset:768
    buffer_store_dwordx4 v[24:27], v4, s[8:11], 0 offen offset:1024
    s_endpgm
k0_tw1:
    s_sub_u32 s3, s2, 128
    s_mov_b32 s12, s32
    s_and_b32 s13, s33, 0xffff
    s_mov_b32 s14, 1966080
    s_mov_b32 s15, 0x00020000
    s_mov_b32 s16, 0xaaaaaab
    s_mul_hi_u32 s17, s3, s16
    s_mul_i32 s18, s17, 24
    s_sub_u32 s18, s3, s18
    s_movk_i32 s4, 3072
    s_movk_i32 s5, 1408
    s_mul_i32 s6, s17, 196608
    s_lshl_b32 s19, s18, 7
    s_add_u32 s6, s6, s19
    s_mul_i32 s7, s18, 90112
    s_lshl_b32 s19, s17, 7
    s_add_u32 s7, s7, s19
    s_add_u32 s7, s7, 2883584
    s_branch k0_tr
k0_tw2:
    s_sub_u32 s3, s2, 128
    s_mov_b32 s12, s34
    s_and_b32 s13, s35, 0xffff
    s_mov_b32 s14, 1966080
    s_mov_b32 s15, 0x00020000
    s_mov_b32 s16, 0x1999999a
    s_mul_hi_u32 s17, s3, s16
    s_mul_i32 s18, s17, 10
    s_sub_u32 s18, s3, s18
    s_movk_i32 s4, 1280
    s_movk_i32 s5, 3200
    s_mul_i32 s6, s17, 81920
    s_lshl_b32 s19, s18, 7
    s_add_u32 s6, s6, s19
    s_mul_i32 s7, s18, 204800
    s_lshl_b32 s19, s17, 7
    s_add_u32 s7, s7, s19
    s_add_u32 s7, s7, 2883584
k0_tr:
    v_lshrrev_b32 v1, 2, v0
    v_and_b32 v2, 3, v0
    v_mul_lo_u32 v3, v1, s4
    v_lshl_add_u32 v3, v2, 5, v3
    v_add_u32 v3, s6, v3
    buffer_load_dwordx4 v[8:11], v3, s[12:15], 0 offen
    buffer_load_dwordx4 v[12:15], v3, s[12:15], 0 offen offset:16
    v_mul_u32_u24 v4, 144, v1
    v_lshl_add_u32 v4, v2, 5, v4
    s_waitcnt vmcnt(0)
    ds_write_b128 v4, v[8:11]
    ds_write_b128 v4, v[12:15] offset:16
    s_waitcnt lgkmcnt(0)
    s_barrier
    v_mul_u32_u24 v5, 2304, v2
    v_lshl_add_u32 v5, v1, 1, v5
    ds_read_u16 v24, v5 offset:0
    ds_read_u16 v25, v5 offset:144
    ds_read_u16 v26, v5 offset:288
    ds_read_u16 v27, v5 offset:432
    ds_read_u16 v28, v5 offset:576
    ds_read_u16 v29, v5 offset:720
    ds_read_u16 v30, v5 offset:864
    ds_read_u16 v31, v5 offset:1008
    ds_read_u16 v32, v5 offset:1152
    ds_read_u16 v33, v5 offset:1296
    ds_read_u16 v34, v5 offset:1440
    ds_read_u16 v35, v5 offset:1584
    ds_read_u16 v36, v5 offset:1728
    ds_read_u16 v37, v5 offset:1872
    ds_read_u16 v38, v5 offset:2016
    ds_read_u16 v39, v5 offset:2160
    v_mul_lo_u32 v6, v1, s5
    v_lshl_add_u32 v6, v2, 5, v6
    v_add_u32 v6, s7, v6
    s_waitcnt lgkmcnt(0)
    v_lshl_or_b32 v16, v25, 16, v24
    v_lshl_or_b32 v17, v27, 16, v26
    v_lshl_or_b32 v18, v29, 16, v28
    v_lshl_or_b32 v19, v31, 16, v30
    v_lshl_or_b32 v20, v33, 16, v32
    v_lshl_or_b32 v21, v35, 16, v34
    v_lshl_or_b32 v22, v37, 16, v36
    v_lshl_or_b32 v23, v39, 16, v38
    buffer_store_dwordx4 v[16:19], v6, s[8:11], 0 offen
    buffer_store_dwordx4 v[20:23], v6, s[8:11], 0 offen offset:16
    s_waitcnt vmcnt(0)
    s_endpgm
k0_ilc:
    s_sub_u32 s3, s2, 128
    s_mov_b32 s12, s28
    s_and_b32 s13, s29, 0xffff
    s_mov_b32 s14, 819200
    s_mov_b32 s15, 0x00020000
    s_mov_b32 s16, s30
    s_and_b32 s17, s31, 0xffff
    s_mov_b32 s18, 819200
    s_mov_b32 s19, 0x00020000
    v_lshrrev_b32 v1, 4, v0
    v_and_b32 v2, 15, v0
    s_lshl_b32 s4, s3, 4
    v_add_u32 v1, s4, v1
    s_movk_i32 s5, 1280
    s_movk_i32 s6, 5760
    v_mul_lo_u32 v3, v1, s5
    v_lshl_add_u32 v3, v2, 4, v3
    v_mul_lo_u32 v4, v1, s6
    v_lshl_add_u32 v4, v2, 5, v4
    v_add_u32 v4, 2883584, v4
    buffer_load_dwordx4 v[8:11], v3, s[12:15], 0 offen offset:0
    buffer_load_dwordx4 v[12:15], v3, s[16:19], 0 offen offset:0
    buffer_load_dwordx4 v[16:19], v3, s[12:15], 0 offen offset:256
    buffer_load_dwordx4 v[20:23], v3, s[16:19], 0 offen offset:256
    buffer_load_dwordx4 v[24:27], v3, s[12:15], 0 offen offset:512
    buffer_load_dwordx4 v[28:31], v3, s[16:19], 0 offen offset:512
    buffer_load_dwordx4 v[32:35], v3, s[12:15], 0 offen offset:768
    buffer_load_dwordx4 v[36:39], v3, s[16:19], 0 offen offset:768
    buffer_load_dwordx4 v[40:43], v3, s[12:15], 0 offen offset:1024
    buffer_load_dwordx4 v[44:47], v3, s[16:19], 0 offen offset:1024
    s_mov_b32 s7, 0x05040100
    s_mov_b32 s3, 0x07060302
    s_waitcnt vmcnt(0)
    v_perm_b32 v48, v12, v8, s7
    v_perm_b32 v49, v12, v8, s3
    v_perm_b32 v50, v13, v9, s7
    v_perm_b32 v51, v13, v9, s3
    v_perm_b32 v52, v14, v10, s7
    v_perm_b32 v53, v14, v10, s3
    v_perm_b32 v54, v15, v11, s7
    v_perm_b32 v55, v15, v11, s3
    v_perm_b32 v56, v20, v16, s7
    v_perm_b32 v57, v20, v16, s3
    v_perm_b32 v58, v21, v17, s7
    v_perm_b32 v59, v21, v17, s3
    v_perm_b32 v60, v22, v18, s7
    v_perm_b32 v61, v22, v18, s3
    v_perm_b32 v62, v23, v19, s7
    v_perm_b32 v63, v23, v19, s3
    v_perm_b32 v64, v28, v24, s7
    v_perm_b32 v65, v28, v24, s3
    v_perm_b32 v66, v29, v25, s7
    v_perm_b32 v67, v29, v25, s3
    v_perm_b32 v68, v30, v26, s7
    v_perm_b32 v69, v30, v26, s3
    v_perm_b32 v70, v31, v27, s7
    v_perm_b32 v71, v31, v27, s3
    v_perm_b32 v72, v36, v32, s7
    v_perm_b32 v73, v36, v32, s3
    v_perm_b32 v74, v37, v33, s7
    v_perm_b32 v75, v37, v33, s3
    v_perm_b32 v76, v38, v34, s7
    v_perm_b32 v77, v38, v34, s3
    v_perm_b32 v78, v39, v35, s7
    v_perm_b32 v79, v39, v35, s3
    v_perm_b32 v80, v44, v40, s7
    v_perm_b32 v81, v44, v40, s3
    v_perm_b32 v82, v45, v41, s7
    v_perm_b32 v83, v45, v41, s3
    v_perm_b32 v84, v46, v42, s7
    v_perm_b32 v85, v46, v42, s3
    v_perm_b32 v86, v47, v43, s7
    v_perm_b32 v87, v47, v43, s3
    buffer_store_dwordx4 v[48:51], v4, s[8:11], 0 offen offset:0
    buffer_store_dwordx4 v[52:55], v4, s[8:11], 0 offen offset:16
    buffer_store_dwordx4 v[56:59], v4, s[8:11], 0 offen offset:512
    buffer_store_dwordx4 v[60:63], v4, s[8:11], 0 offen offset:528
    buffer_store_dwordx4 v[64:67], v4, s[8:11], 0 offen offset:1024
    buffer_store_dwordx4 v[68:71], v4, s[8:11], 0 offen offset:1040
    buffer_store_dwordx4 v[72:75], v4, s[8:11], 0 offen offset:1536
    buffer_store_dwordx4 v[76:79], v4, s[8:11], 0 offen offset:1552
    buffer_store_dwordx4 v[80:83], v4, s[8:11], 0 offen offset:2048
    buffer_store_dwordx4 v[84:87], v4, s[8:11], 0 offen offset:2064
    s_endpgm
.globl k1_kernel
.p2align 8
.type k1_kernel,@function
k1_kernel:
    s_cmp_ge_u32 s2, 256
    s_cbranch_scc1 k1_exit
    s_load_dwordx8 s[64:71], s[0:1], 8
    s_load_dwordx2 s[76:77], s[0:1], 56
    s_load_dwordx2 s[78:79], s[0:1], 80
    s_load_dwordx2 s[80:81], s[0:1], 112
    v_lshrrev_b32 v1, 6, v0
    v_and_b32 v2, 63, v0
    v_readfirstlane_b32 s32, v1
    v_and_b32 v3, 15, v0
    v_lshrrev_b32 v4, 4, v2
    s_and_b32 s31, s2, 7
    s_lshl_b32 s31, s31, 1
    s_lshr_b32 s34, s2, 7
    s_add_u32 s31, s31, s34
    s_lshr_b32 s30, s2, 3
    s_and_b32 s30, s30, 15
    s_movk_i32 s36, 1408
    s_waitcnt lgkmcnt(0)
    s_mov_b32 s8, s80
    s_and_b32 s9, s81, 0xffff
    s_mov_b32 s10, 22446080
    s_mov_b32 s11, 0x00020000
    s_cmp_ge_u32 s32, 4
    s_cbranch_scc1 k1_loader
    s_cmp_ge_u32 s30, 10
    s_cbranch_scc1 k1_ffn
    s_mov_b32 s24, s64
    s_and_b32 s25, s65, 0xffff
    s_mov_b32 s26, 1280
    s_mov_b32 s27, 0x00020000
    s_mov_b32 s56, s66
    s_and_b32 s57, s67, 0xffff
    s_mov_b32 s58, 1280
    s_mov_b32 s59, 0x00020000
    s_mov_b32 s60, s76
    s_and_b32 s61, s77, 0xffff
    s_mov_b32 s62, 1280
    s_mov_b32 s63, 0x00020000
    s_mul_i32 s37, s30, 64
    v_add_u32 v9, s37, v0
    v_lshlrev_b32 v9, 1, v9
    buffer_load_ushort v40, v9, s[24:27], 0 offen
    buffer_load_ushort v41, v9, s[56:59], 0 offen
    buffer_load_ushort v42, v9, s[60:63], 0 offen
    s_lshl_b32 s37, s32, 12
    v_mov_b32 v36, s37
    v_lshrrev_b32 v5, 1, v3
    v_or_b32 v6, 0, v4
    v_xor_b32 v5, v5, v6
    v_lshlrev_b32 v5, 4, v5
    v_lshl_add_u32 v5, v3, 7, v5
    v_add_u32 v5, v5, v36
    v_add_u32 v20, 0, v5
    v_add_u32 v21, 32768, v5
    v_add_u32 v22, 65536, v5
    v_add_u32 v23, 98304, v5
    v_lshrrev_b32 v5, 1, v3
    v_or_b32 v6, 4, v4
    v_xor_b32 v5, v5, v6
    v_lshlrev_b32 v5, 4, v5
    v_lshl_add_u32 v5, v3, 7, v5
    v_add_u32 v5, v5, v36
    v_add_u32 v24, 0, v5
    v_add_u32 v25, 32768, v5
    v_add_u32 v26, 65536, v5
    v_add_u32 v27, 98304, v5
    v_mov_b32 v36, 16384
    v_lshrrev_b32 v5, 1, v3
    v_or_b32 v6, 0, v4
    v_xor_b32 v5, v5, v6
    v_lshlrev_b32 v5, 4, v5
    v_lshl_add_u32 v5, v3, 7, v5
    v_add_u32 v5, v5, v36
    v_add_u32 v28, 0, v5
    v_add_u32 v29, 32768, v5
    v_add_u32 v30, 65536, v5
    v_add_u32 v31, 98304, v5
    v_lshrrev_b32 v5, 1, v3
    v_or_b32 v6, 4, v4
    v_xor_b32 v5, v5, v6
    v_lshlrev_b32 v5, 4, v5
    v_lshl_add_u32 v5, v3, 7, v5
    v_add_u32 v5, v5, v36
    v_add_u32 v32, 0, v5
    v_add_u32 v33, 32768, v5
    v_add_u32 v34, 65536, v5
    v_add_u32 v35, 98304, v5
    s_waitcnt vmcnt(0)
    v_lshlrev_b32 v40, 16, v40
    v_lshlrev_b32 v41, 16, v41
    v_lshlrev_b32 v42, 16, v42
    s_mov_b32 s37, 0x3fb8aa3b
    s_mov_b32 s38, 0x3e22f983
    v_mul_f32 v42, s37, v42
    v_exp_f32 v42, v42
    s_nop 0
    v_cvt_pk_bf16_f32 v42, v42, v42
    v_lshlrev_b32 v42, 16, v42
    v_mul_f32 v43, v42, v40
    v_mul_f32 v44, v42, v41
    v_mul_f32 v43, s37, v43
    v_exp_f32 v43, v43
    v_mul_f32 v44, s38, v44
    v_rndne_f32 v45, v44
    v_sub_f32 v44, v44, v45
    v_sin_f32 v45, v44
    v_cos_f32 v46, v44
    s_nop 0
    v_mul_f32 v48, v43, v46
    v_mul_f32 v49, v43, v45
    v_add_f32 v45, -1.0, v48
    v_mul_f32 v46, v40, v40
    v_fma_f32 v46, v41, v41, v46
    v_rcp_f32 v47, v46
    v_mul_f32 v50, v45, v40
    v_fma_f32 v50, v49, v41, v50
    v_mul_f32 v51, v49, v40
    v_fma_f32 v51, -v45, v41, v51
    v_add_f32 v47, v47, v47
    v_mul_f32 v50, v50, v47
    v_mul_f32 v51, v51, v47
    v_mov_b32 v52, v48
    v_mov_b32 v53, v49
    v_mul_f32 v56, v52, v52
    v_mul_f32 v57, v52, v53
    v_fma_f32 v56, -v53, v53, v56
    v_fma_f32 v57, v53, v52, v57
    v_mov_b32 v52, v56
    v_mov_b32 v53, v57
    v_mul_f32 v56, v52, v52
    v_mul_f32 v57, v52, v53
    v_fma_f32 v56, -v53, v53, v56
    v_fma_f32 v57, v53, v52, v57
    v_mov_b32 v52, v56
    v_mov_b32 v53, v57
    v_mul_f32 v56, v52, v52
    v_mul_f32 v57, v52, v53
    v_fma_f32 v56, -v53, v53, v56
    v_fma_f32 v57, v53, v52, v57
    v_mov_b32 v52, v56
    v_mov_b32 v53, v57
    v_mov_b32 v54, v52
    v_mov_b32 v55, v53
    v_mul_f32 v56, v54, v54
    v_mul_f32 v57, v54, v55
    v_fma_f32 v56, -v55, v55, v56
    v_fma_f32 v57, v55, v54, v57
    v_mov_b32 v54, v56
    v_mov_b32 v55, v57
    v_mul_f32 v56, v54, v54
    v_mul_f32 v57, v54, v55
    v_fma_f32 v56, -v55, v55, v56
    v_fma_f32 v57, v55, v54, v57
    v_mov_b32 v54, v56
    v_mov_b32 v55, v57
    v_mul_f32 v56, v54, v54
    v_mul_f32 v57, v54, v55
    v_fma_f32 v56, -v55, v55, v56
    v_fma_f32 v57, v55, v54, v57
    v_mov_b32 v54, v56
    v_mov_b32 v55, v57
    v_mul_f32 v56, v54, v54
    v_mul_f32 v57, v54, v55
    v_fma_f32 v56, -v55, v55, v56
    v_fma_f32 v57, v55, v54, v57
    v_mov_b32 v54, v56
    v_mov_b32 v55, v57
    v_lshlrev_b32 v9, 5, v0
    v_add_u32 v9, 131072, v9
    ds_write_b128 v9, v[48:51]
    ds_write_b128 v9, v[52:55] offset:16
    s_waitcnt lgkmcnt(0)
    s_barrier
    ds_read_b128 v[40:43], v20 offset:0
    ds_read_b128 v[44:47], v20 offset:2048
    ds_read_b128 v[48:51], v28 offset:0
    ds_read_b128 v[52:55], v28 offset:2048
    ds_read_b128 v[56:59], v28 offset:4096
    ds_read_b128 v[60:63], v28 offset:6144
    ds_read_b128 v[64:67], v28 offset:8192
    ds_read_b128 v[68:71], v28 offset:10240
    ds_read_b128 v[72:75], v28 offset:12288
    ds_read_b128 v[76:79], v28 offset:14336
    s_waitcnt lgkmcnt(0)
    v_mfma_f32_16x16x32_bf16 v[136:139], v[40:43], v[48:51], 0
    ds_read_b128 v[80:83], v24 offset:0
    v_mfma_f32_16x16x32_bf16 v[140:143], v[40:43], v[52:55], 0
    ds_read_b128 v[84:87], v24 offset:2048
    v_mfma_f32_16x16x32_bf16 v[144:147], v[40:43], v[56:59], 0
    ds_read_b128 v[88:91], v32 offset:0
    v_mfma_f32_16x16x32_bf16 v[148:151], v[40:43], v[60:63], 0
    ds_read_b128 v[92:95], v32 offset:2048
    v_mfma_f32_16x16x32_bf16 v[152:155], v[40:43], v[64:67], 0
    ds_read_b128 v[96:99], v32 offset:4096
    v_mfma_f32_16x16x32_bf16 v[156:159], v[40:43], v[68:71], 0
    ds_read_b128 v[100:103], v32 offset:6144
    v_mfma_f32_16x16x32_bf16 v[160:163], v[40:43], v[72:75], 0
    ds_read_b128 v[104:107], v32 offset:8192
    v_mfma_f32_16x16x32_bf16 v[164:167], v[40:43], v[76:79], 0
    ds_read_b128 v[108:111], v32 offset:10240
    v_mfma_f32_16x16x32_bf16 v[168:171], v[44:47], v[48:51], 0
    ds_read_b128 v[112:115], v32 offset:12288
    v_mfma_f32_16x16x32_bf16 v[172:175], v[44:47], v[52:55], 0
    ds_read_b128 v[116:119], v32 offset:14336
    v_mfma_f32_16x16x32_bf16 v[176:179], v[44:47], v[56:59], 0
    v_mfma_f32_16x16x32_bf16 v[180:183], v[44:47], v[60:63], 0
    v_mfma_f32_16x16x32_bf16 v[184:187], v[44:47], v[64:67], 0
    v_mfma_f32_16x16x32_bf16 v[188:191], v[44:47], v[68:71], 0
    v_mfma_f32_16x16x32_bf16 v[192:195], v[44:47], v[72:75], 0
    v_mfma_f32_16x16x32_bf16 v[196:199], v[44:47], v[76:79], 0
    s_waitcnt lgkmcnt(0)
    s_barrier
    v_mfma_f32_16x16x32_bf16 v[136:139], v[80:83], v[88:91], v[136:139]
    ds_read_b128 v[40:43], v21 offset:0
    v_mfma_f32_16x16x32_bf16 v[140:143], v[80:83], v[92:95], v[140:143]
    ds_read_b128 v[44:47], v21 offset:2048
    v_mfma_f32_16x16x32_bf16 v[144:147], v[80:83], v[96:99], v[144:147]
    ds_read_b128 v[48:51], v29 offset:0
    v_mfma_f32_16x16x32_bf16 v[148:151], v[80:83], v[100:103], v[148:151]
    ds_read_b128 v[52:55], v29 offset:2048
    v_mfma_f32_16x16x32_bf16 v[152:155], v[80:83], v[104:107], v[152:155]
    ds_read_b128 v[56:59], v29 offset:4096
    v_mfma_f32_16x16x32_bf16 v[156:159], v[80:83], v[108:111], v[156:159]
    ds_read_b128 v[60:63], v29 offset:6144
    v_mfma_f32_16x16x32_bf16 v[160:163], v[80:83], v[112:115], v[160:163]
    ds_read_b128 v[64:67], v29 offset:8192
    v_mfma_f32_16x16x32_bf16 v[164:167], v[80:83], v[116:119], v[164:167]
    ds_read_b128 v[68:71], v29 offset:10240
    v_mfma_f32_16x16x32_bf16 v[168:171], v[84:87], v[88:91], v[168:171]
    ds_read_b128 v[72:75], v29 offset:12288
    v_mfma_f32_16x16x32_bf16 v[172:175], v[84:87], v[92:95], v[172:175]
    ds_read_b128 v[76:79], v29 offset:14336
    v_mfma_f32_16x16x32_bf16 v[176:179], v[84:87], v[96:99], v[176:179]
    v_mfma_f32_16x16x32_bf16 v[180:183], v[84:87], v[100:103], v[180:183]
    v_mfma_f32_16x16x32_bf16 v[184:187], v[84:87], v[104:107], v[184:187]
    v_mfma_f32_16x16x32_bf16 v[188:191], v[84:87], v[108:111], v[188:191]
    v_mfma_f32_16x16x32_bf16 v[192:195], v[84:87], v[112:115], v[192:195]
    v_mfma_f32_16x16x32_bf16 v[196:199], v[84:87], v[116:119], v[196:199]
    s_waitcnt lgkmcnt(0)
    v_mfma_f32_16x16x32_bf16 v[136:139], v[40:43], v[48:51], v[136:139]
    ds_read_b128 v[80:83], v25 offset:0
    v_mfma_f32_16x16x32_bf16 v[140:143], v[40:43], v[52:55], v[140:143]
    ds_read_b128 v[84:87], v25 offset:2048
    v_mfma_f32_16x16x32_bf16 v[144:147], v[40:43], v[56:59], v[144:147]
    ds_read_b128 v[88:91], v33 offset:0
    v_mfma_f32_16x16x32_bf16 v[148:151], v[40:43], v[60:63], v[148:151]
    ds_read_b128 v[92:95], v33 offset:2048
    v_mfma_f32_16x16x32_bf16 v[152:155], v[40:43], v[64:67], v[152:155]
    ds_read_b128 v[96:99], v33 offset:4096
    v_mfma_f32_16x16x32_bf16 v[156:159], v[40:43], v[68:71], v[156:159]
    ds_read_b128 v[100:103], v33 offset:6144
    v_mfma_f32_16x16x32_bf16 v[160:163], v[40:43], v[72:75], v[160:163]
    ds_read_b128 v[104:107], v33 offset:8192
    v_mfma_f32_16x16x32_bf16 v[164:167], v[40:43], v[76:79], v[164:167]
    ds_read_b128 v[108:111], v33 offset:10240
    v_mfma_f32_16x16x32_bf16 v[168:171], v[44:47], v[48:51], v[168:171]
    ds_read_b128 v[112:115], v33 offset:12288
    v_mfma_f32_16x16x32_bf16 v[172:175], v[44:47], v[52:55], v[172:175]
    ds_read_b128 v[116:119], v33 offset:14336
    v_mfma_f32_16x16x32_bf16 v[176:179], v[44:47], v[56:59], v[176:179]
    v_mfma_f32_16x16x32_bf16 v[180:183], v[44:47], v[60:63], v[180:183]
    v_mfma_f32_16x16x32_bf16 v[184:187], v[44:47], v[64:67], v[184:187]
    v_mfma_f32_16x16x32_bf16 v[188:191], v[44:47], v[68:71], v[188:191]
    v_mfma_f32_16x16x32_bf16 v[192:195], v[44:47], v[72:75], v[192:195]
    v_mfma_f32_16x16x32_bf16 v[196:199], v[44:47], v[76:79], v[196:199]
    s_waitcnt lgkmcnt(0)
    s_barrier
    v_mfma_f32_16x16x32_bf16 v[136:139], v[80:83], v[88:91], v[136:139]
    ds_read_b128 v[40:43], v22 offset:0
    v_mfma_f32_16x16x32_bf16 v[140:143], v[80:83], v[92:95], v[140:143]
    ds_read_b128 v[44:47], v22 offset:2048
    v_mfma_f32_16x16x32_bf16 v[144:147], v[80:83], v[96:99], v[144:147]
    ds_read_b128 v[48:51], v30 offset:0
    v_mfma_f32_16x16x32_bf16 v[148:151], v[80:83], v[100:103], v[148:151]
    ds_read_b128 v[52:55], v30 offset:2048
    v_mfma_f32_16x16x32_bf16 v[152:155], v[80:83], v[104:107], v[152:155]
    ds_read_b128 v[56:59], v30 offset:4096
    v_mfma_f32_16x16x32_bf16 v[156:159], v[80:83], v[108:111], v[156:159]
    ds_read_b128 v[60:63], v30 offset:6144
    v_mfma_f32_16x16x32_bf16 v[160:163], v[80:83], v[112:115], v[160:163]
    ds_read_b128 v[64:67], v30 offset:8192
    v_mfma_f32_16x16x32_bf16 v[164:167], v[80:83], v[116:119], v[164:167]
    ds_read_b128 v[68:71], v30 offset:10240
    v_mfma_f32_16x16x32_bf16 v[168:171], v[84:87], v[88:91], v[168:171]
    ds_read_b128 v[72:75], v30 offset:12288
    v_mfma_f32_16x16x32_bf16 v[172:175], v[84:87], v[92:95], v[172:175]
    ds_read_b128 v[76:79], v30 offset:14336
    v_mfma_f32_16x16x32_bf16 v[176:179], v[84:87], v[96:99], v[176:179]
    v_mfma_f32_16x16x32_bf16 v[180:183], v[84:87], v[100:103], v[180:183]
    v_mfma_f32_16x16x32_bf16 v[184:187], v[84:87], v[104:107], v[184:187]
    v_mfma_f32_16x16x32_bf16 v[188:191], v[84:87], v[108:111], v[188:191]
    v_mfma_f32_16x16x32_bf16 v[192:195], v[84:87], v[112:115], v[192:195]
    v_mfma_f32_16x16x32_bf16 v[196:199], v[84:87], v[116:119], v[196:199]
    s_waitcnt lgkmcnt(0)
    v_mfma_f32_16x16x32_bf16 v[136:139], v[40:43], v[48:51], v[136:139]
    ds_read_b128 v[80:83], v26 offset:0
    v_mfma_f32_16x16x32_bf16 v[140:143], v[40:43], v[52:55], v[140:143]
    ds_read_b128 v[84:87], v26 offset:2048
    v_mfma_f32_16x16x32_bf16 v[144:147], v[40:43], v[56:59], v[144:147]
    ds_read_b128 v[88:91], v34 offset:0
    v_mfma_f32_16x16x32_bf16 v[148:151], v[40:43], v[60:63], v[148:151]
    ds_read_b128 v[92:95], v34 offset:2048
    v_mfma_f32_16x16x32_bf16 v[152:155], v[40:43], v[64:67], v[152:155]
    ds_read_b128 v[96:99], v34 offset:4096
    v_mfma_f32_16x16x32_bf16 v[156:159], v[40:43], v[68:71], v[156:159]
    ds_read_b128 v[100:103], v34 offset:6144
    v_mfma_f32_16x16x32_bf16 v[160:163], v[40:43], v[72:75], v[160:163]
    ds_read_b128 v[104:107], v34 offset:8192
    v_mfma_f32_16x16x32_bf16 v[164:167], v[40:43], v[76:79], v[164:167]
    ds_read_b128 v[108:111], v34 offset:10240
    v_mfma_f32_16x16x32_bf16 v[168:171], v[44:47], v[48:51], v[168:171]
    ds_read_b128 v[112:115], v34 offset:12288
    v_mfma_f32_16x16x32_bf16 v[172:175], v[44:47], v[52:55], v[172:175]
    ds_read_b128 v[116:119], v34 offset:14336
    v_mfma_f32_16x16x32_bf16 v[176:179], v[44:47], v[56:59], v[176:179]
    v_mfma_f32_16x16x32_bf16 v[180:183], v[44:47], v[60:63], v[180:183]
    v_mfma_f32_16x16x32_bf16 v[184:187], v[44:47], v[64:67], v[184:187]
    v_mfma_f32_16x16x32_bf16 v[188:191], v[44:47], v[68:71], v[188:191]
    v_mfma_f32_16x16x32_bf16 v[192:195], v[44:47], v[72:75], v[192:195]
    v_mfma_f32_16x16x32_bf16 v[196:199], v[44:47], v[76:79], v[196:199]
    s_waitcnt lgkmcnt(0)
    s_barrier
    v_mfma_f32_16x16x32_bf16 v[136:139], v[80:83], v[88:91], v[136:139]
    ds_read_b128 v[40:43], v23 offset:0
    v_mfma_f32_16x16x32_bf16 v[140:143], v[80:83], v[92:95], v[140:143]
    ds_read_b128 v[44:47], v23 offset:2048
    v_mfma_f32_16x16x32_bf16 v[144:147], v[80:83], v[96:99], v[144:147]
    ds_read_b128 v[48:51], v31 offset:0
    v_mfma_f32_16x16x32_bf16 v[148:151], v[80:83], v[100:103], v[148:151]
    ds_read_b128 v[52:55], v31 offset:2048
    v_mfma_f32_16x16x32_bf16 v[152:155], v[80:83], v[104:107], v[152:155]
    ds_read_b128 v[56:59], v31 offset:4096
    v_mfma_f32_16x16x32_bf16 v[156:159], v[80:83], v[108:111], v[156:159]
    ds_read_b128 v[60:63], v31 offset:6144
    v_mfma_f32_16x16x32_bf16 v[160:163], v[80:83], v[112:115], v[160:163]
    ds_read_b128 v[64:67], v31 offset:8192
    v_mfma_f32_16x16x32_bf16 v[164:167], v[80:83], v[116:119], v[164:167]
    ds_read_b128 v[68:71], v31 offset:10240
    v_mfma_f32_16x16x32_bf16 v[168:171], v[84:87], v[88:91], v[168:171]
    ds_read_b128 v[72:75], v31 offset:12288
    v_mfma_f32_16x16x32_bf16 v[172:175], v[84:87], v[92:95], v[172:175]
    ds_read_b128 v[76:79], v31 offset:14336
    v_mfma_f32_16x16x32_bf16 v[176:179], v[84:87], v[96:99], v[176:179]
    v_mfma_f32_16x16x32_bf16 v[180:183], v[84:87], v[100:103], v[180:183]
    v_mfma_f32_16x16x32_bf16 v[184:187], v[84:87], v[104:107], v[184:187]
    v_mfma_f32_16x16x32_bf16 v[188:191], v[84:87], v[108:111], v[188:191]
    v_mfma_f32_16x16x32_bf16 v[192:195], v[84:87], v[112:115], v[192:195]
    v_mfma_f32_16x16x32_bf16 v[196:199], v[84:87], v[116:119], v[196:199]
    s_waitcnt lgkmcnt(0)
    v_mfma_f32_16x16x32_bf16 v[136:139], v[40:43], v[48:51], v[136:139]
    ds_read_b128 v[80:83], v27 offset:0
    v_mfma_f32_16x16x32_bf16 v[140:143], v[40:43], v[52:55], v[140:143]
    ds_read_b128 v[84:87], v27 offset:2048
    v_mfma_f32_16x16x32_bf16 v[144:147], v[40:43], v[56:59], v[144:147]
    ds_read_b128 v[88:91], v35 offset:0
    v_mfma_f32_16x16x32_bf16 v[148:151], v[40:43], v[60:63], v[148:151]
    ds_read_b128 v[92:95], v35 offset:2048
    v_mfma_f32_16x16x32_bf16 v[152:155], v[40:43], v[64:67], v[152:155]
    ds_read_b128 v[96:99], v35 offset:4096
    v_mfma_f32_16x16x32_bf16 v[156:159], v[40:43], v[68:71], v[156:159]
    ds_read_b128 v[100:103], v35 offset:6144
    v_mfma_f32_16x16x32_bf16 v[160:163], v[40:43], v[72:75], v[160:163]
    ds_read_b128 v[104:107], v35 offset:8192
    v_mfma_f32_16x16x32_bf16 v[164:167], v[40:43], v[76:79], v[164:167]
    ds_read_b128 v[108:111], v35 offset:10240
    v_mfma_f32_16x16x32_bf16 v[168:171], v[44:47], v[48:51], v[168:171]
    ds_read_b128 v[112:115], v35 offset:12288
    v_mfma_f32_16x16x32_bf16 v[172:175], v[44:47], v[52:55], v[172:175]
    ds_read_b128 v[116:119], v35 offset:14336
    v_mfma_f32_16x16x32_bf16 v[176:179], v[44:47], v[56:59], v[176:179]
    v_mfma_f32_16x16x32_bf16 v[180:183], v[44:47], v[60:63], v[180:183]
    v_mfma_f32_16x16x32_bf16 v[184:187], v[44:47], v[64:67], v[184:187]
    v_mfma_f32_16x16x32_bf16 v[188:191], v[44:47], v[68:71], v[188:191]
    v_mfma_f32_16x16x32_bf16 v[192:195], v[44:47], v[72:75], v[192:195]
    v_mfma_f32_16x16x32_bf16 v[196:199], v[44:47], v[76:79], v[196:199]
    s_waitcnt lgkmcnt(0)
    s_barrier
    v_mfma_f32_16x16x32_bf16 v[136:139], v[80:83], v[88:91], v[136:139]
    ds_read_b128 v[40:43], v20 offset:0
    v_mfma_f32_16x16x32_bf16 v[140:143], v[80:83], v[92:95], v[140:143]
    ds_read_b128 v[44:47], v20 offset:2048
    v_mfma_f32_16x16x32_bf16 v[144:147], v[80:83], v[96:99], v[144:147]
    ds_read_b128 v[48:51], v28 offset:0
    v_mfma_f32_16x16x32_bf16 v[148:151], v[80:83], v[100:103], v[148:151]
    ds_read_b128 v[52:55], v28 offset:2048
    v_mfma_f32_16x16x32_bf16 v[152:155], v[80:83], v[104:107], v[152:155]
    ds_read_b128 v[56:59], v28 offset:4096
    v_mfma_f32_16x16x32_bf16 v[156:159], v[80:83], v[108:111], v[156:159]
    ds_read_b128 v[60:63], v28 offset:6144
    v_mfma_f32_16x16x32_bf16 v[160:163], v[80:83], v[112:115], v[160:163]
    ds_read_b128 v[64:67], v28 offset:8192
    v_mfma_f32_16x16x32_bf16 v[164:167], v[80:83], v[116:119], v[164:167]
    ds_read_b128 v[68:71], v28 offset:10240
    v_mfma_f32_16x16x32_bf16 v[168:171], v[84:87], v[88:91], v[168:171]
    ds_read_b128 v[72:75], v28 offset:12288
    v_mfma_f32_16x16x32_bf16 v[172:175], v[84:87], v[92:95], v[172:175]
    ds_read_b128 v[76:79], v28 offset:14336
    v_mfma_f32_16x16x32_bf16 v[176:179], v[84:87], v[96:99], v[176:179]
    v_mfma_f32_16x16x32_bf16 v[180:183], v[84:87], v[100:103], v[180:183]
    v_mfma_f32_16x16x32_bf16 v[184:187], v[84:87], v[104:107], v[184:187]
    v_mfma_f32_16x16x32_bf16 v[188:191], v[84:87], v[108:111], v[188:191]
    v_mfma_f32_16x16x32_bf16 v[192:195], v[84:87], v[112:115], v[192:195]
    v_mfma_f32_16x16x32_bf16 v[196:199], v[84:87], v[116:119], v[196:199]
    s_waitcnt lgkmcnt(0)
    v_mfma_f32_16x16x32_bf16 v[136:139], v[40:43], v[48:51], v[136:139]
    ds_read_b128 v[80:83], v24 offset:0
    v_mfma_f32_16x16x32_bf16 v[140:143], v[40:43], v[52:55], v[140:143]
    ds_read_b128 v[84:87], v24 offset:2048
    v_mfma_f32_16x16x32_bf16 v[144:147], v[40:43], v[56:59], v[144:147]
    ds_read_b128 v[88:91], v32 offset:0
    v_mfma_f32_16x16x32_bf16 v[148:151], v[40:43], v[60:63], v[148:151]
    ds_read_b128 v[92:95], v32 offset:2048
    v_mfma_f32_16x16x32_bf16 v[152:155], v[40:43], v[64:67], v[152:155]
    ds_read_b128 v[96:99], v32 offset:4096
    v_mfma_f32_16x16x32_bf16 v[156:159], v[40:43], v[68:71], v[156:159]
    ds_read_b128 v[100:103], v32 offset:6144
    v_mfma_f32_16x16x32_bf16 v[160:163], v[40:43], v[72:75], v[160:163]
    ds_read_b128 v[104:107], v32 offset:8192
    v_mfma_f32_16x16x32_bf16 v[164:167], v[40:43], v[76:79], v[164:167]
    ds_read_b128 v[108:111], v32 offset:10240
    v_mfma_f32_16x16x32_bf16 v[168:171], v[44:47], v[48:51], v[168:171]
    ds_read_b128 v[112:115], v32 offset:12288
    v_mfma_f32_16x16x32_bf16 v[172:175], v[44:47], v[52:55], v[172:175]
    ds_read_b128 v[116:119], v32 offset:14336
    v_mfma_f32_16x16x32_bf16 v[176:179], v[44:47], v[56:59], v[176:179]
    v_mfma_f32_16x16x32_bf16 v[180:183], v[44:47], v[60:63], v[180:183]
    v_mfma_f32_16x16x32_bf16 v[184:187], v[44:47], v[64:67], v[184:187]
    v_mfma_f32_16x16x32_bf16 v[188:191], v[44:47], v[68:71], v[188:191]
    v_mfma_f32_16x16x32_bf16 v[192:195], v[44:47], v[72:75], v[192:195]
    v_mfma_f32_16x16x32_bf16 v[196:199], v[44:47], v[76:79], v[196:199]
    s_waitcnt lgkmcnt(0)
    s_barrier
    v_mfma_f32_16x16x32_bf16 v[136:139], v[80:83], v[88:91], v[136:139]
    ds_read_b128 v[40:43], v21 offset:0
    v_mfma_f32_16x16x32_bf16 v[140:143], v[80:83], v[92:95], v[140:143]
    ds_read_b128 v[44:47], v21 offset:2048
    v_mfma_f32_16x16x32_bf16 v[144:147], v[80:83], v[96:99], v[144:147]
    ds_read_b128 v[48:51], v29 offset:0
    v_mfma_f32_16x16x32_bf16 v[148:151], v[80:83], v[100:103], v[148:151]
    ds_read_b128 v[52:55], v29 offset:2048
    v_mfma_f32_16x16x32_bf16 v[152:155], v[80:83], v[104:107], v[152:155]
    ds_read_b128 v[56:59], v29 offset:4096
    v_mfma_f32_16x16x32_bf16 v[156:159], v[80:83], v[108:111], v[156:159]
    ds_read_b128 v[60:63], v29 offset:6144
    v_mfma_f32_16x16x32_bf16 v[160:163], v[80:83], v[112:115], v[160:163]
    ds_read_b128 v[64:67], v29 offset:8192
    v_mfma_f32_16x16x32_bf16 v[164:167], v[80:83], v[116:119], v[164:167]
    ds_read_b128 v[68:71], v29 offset:10240
    v_mfma_f32_16x16x32_bf16 v[168:171], v[84:87], v[88:91], v[168:171]
    ds_read_b128 v[72:75], v29 offset:12288
    v_mfma_f32_16x16x32_bf16 v[172:175], v[84:87], v[92:95], v[172:175]
    ds_read_b128 v[76:79], v29 offset:14336
    v_mfma_f32_16x16x32_bf16 v[176:179], v[84:87], v[96:99], v[176:179]
    v_mfma_f32_16x16x32_bf16 v[180:183], v[84:87], v[100:103], v[180:183]
    v_mfma_f32_16x16x32_bf16 v[184:187], v[84:87], v[104:107], v[184:187]
    v_mfma_f32_16x16x32_bf16 v[188:191], v[84:87], v[108:111], v[188:191]
    v_mfma_f32_16x16x32_bf16 v[192:195], v[84:87], v[112:115], v[192:195]
    v_mfma_f32_16x16x32_bf16 v[196:199], v[84:87], v[116:119], v[196:199]
    s_waitcnt lgkmcnt(0)
    v_mfma_f32_16x16x32_bf16 v[136:139], v[40:43], v[48:51], v[136:139]
    ds_read_b128 v[80:83], v25 offset:0
    v_mfma_f32_16x16x32_bf16 v[140:143], v[40:43], v[52:55], v[140:143]
    ds_read_b128 v[84:87], v25 offset:2048
    v_mfma_f32_16x16x32_bf16 v[144:147], v[40:43], v[56:59], v[144:147]
    ds_read_b128 v[88:91], v33 offset:0
    v_mfma_f32_16x16x32_bf16 v[148:151], v[40:43], v[60:63], v[148:151]
    ds_read_b128 v[92:95], v33 offset:2048
    v_mfma_f32_16x16x32_bf16 v[152:155], v[40:43], v[64:67], v[152:155]
    ds_read_b128 v[96:99], v33 offset:4096
    v_mfma_f32_16x16x32_bf16 v[156:159], v[40:43], v[68:71], v[156:159]
    ds_read_b128 v[100:103], v33 offset:6144
    v_mfma_f32_16x16x32_bf16 v[160:163], v[40:43], v[72:75], v[160:163]
    ds_read_b128 v[104:107], v33 offset:8192
    v_mfma_f32_16x16x32_bf16 v[164:167], v[40:43], v[76:79], v[164:167]
    ds_read_b128 v[108:111], v33 offset:10240
    v_mfma_f32_16x16x32_bf16 v[168:171], v[44:47], v[48:51], v[168:171]
    ds_read_b128 v[112:115], v33 offset:12288
    v_mfma_f32_16x16x32_bf16 v[172:175], v[44:47], v[52:55], v[172:175]
    ds_read_b128 v[116:119], v33 offset:14336
    v_mfma_f32_16x16x32_bf16 v[176:179], v[44:47], v[56:59], v[176:179]
    v_mfma_f32_16x16x32_bf16 v[180:183], v[44:47], v[60:63], v[180:183]
    v_mfma_f32_16x16x32_bf16 v[184:187], v[44:47], v[64:67], v[184:187]
    v_mfma_f32_16x16x32_bf16 v[188:191], v[44:47], v[68:71], v[188:191]
    v_mfma_f32_16x16x32_bf16 v[192:195], v[44:47], v[72:75], v[192:195]
    v_mfma_f32_16x16x32_bf16 v[196:199], v[44:47], v[76:79], v[196:199]
    s_waitcnt lgkmcnt(0)
    s_barrier
    v_mfma_f32_16x16x32_bf16 v[136:139], v[80:83], v[88:91], v[136:139]
    ds_read_b128 v[40:43], v22 offset:0
    v_mfma_f32_16x16x32_bf16 v[140:143], v[80:83], v[92:95], v[140:143]
    ds_read_b128 v[44:47], v22 offset:2048
    v_mfma_f32_16x16x32_bf16 v[144:147], v[80:83], v[96:99], v[144:147]
    ds_read_b128 v[48:51], v30 offset:0
    v_mfma_f32_16x16x32_bf16 v[148:151], v[80:83], v[100:103], v[148:151]
    ds_read_b128 v[52:55], v30 offset:2048
    v_mfma_f32_16x16x32_bf16 v[152:155], v[80:83], v[104:107], v[152:155]
    ds_read_b128 v[56:59], v30 offset:4096
    v_mfma_f32_16x16x32_bf16 v[156:159], v[80:83], v[108:111], v[156:159]
    ds_read_b128 v[60:63], v30 offset:6144
    v_mfma_f32_16x16x32_bf16 v[160:163], v[80:83], v[112:115], v[160:163]
    ds_read_b128 v[64:67], v30 offset:8192
    v_mfma_f32_16x16x32_bf16 v[164:167], v[80:83], v[116:119], v[164:167]
    ds_read_b128 v[68:71], v30 offset:10240
    v_mfma_f32_16x16x32_bf16 v[168:171], v[84:87], v[88:91], v[168:171]
    ds_read_b128 v[72:75], v30 offset:12288
    v_mfma_f32_16x16x32_bf16 v[172:175], v[84:87], v[92:95], v[172:175]
    ds_read_b128 v[76:79], v30 offset:14336
    v_mfma_f32_16x16x32_bf16 v[176:179], v[84:87], v[96:99], v[176:179]
    v_mfma_f32_16x16x32_bf16 v[180:183], v[84:87], v[100:103], v[180:183]
    v_mfma_f32_16x16x32_bf16 v[184:187], v[84:87], v[104:107], v[184:187]
    v_mfma_f32_16x16x32_bf16 v[188:191], v[84:87], v[108:111], v[188:191]
    v_mfma_f32_16x16x32_bf16 v[192:195], v[84:87], v[112:115], v[192:195]
    v_mfma_f32_16x16x32_bf16 v[196:199], v[84:87], v[116:119], v[196:199]
    s_waitcnt lgkmcnt(0)
    v_mfma_f32_16x16x32_bf16 v[136:139], v[40:43], v[48:51], v[136:139]
    ds_read_b128 v[80:83], v26 offset:0
    v_mfma_f32_16x16x32_bf16 v[140:143], v[40:43], v[52:55], v[140:143]
    ds_read_b128 v[84:87], v26 offset:2048
    v_mfma_f32_16x16x32_bf16 v[144:147], v[40:43], v[56:59], v[144:147]
    ds_read_b128 v[88:91], v34 offset:0
    v_mfma_f32_16x16x32_bf16 v[148:151], v[40:43], v[60:63], v[148:151]
    ds_read_b128 v[92:95], v34 offset:2048
    v_mfma_f32_16x16x32_bf16 v[152:155], v[40:43], v[64:67], v[152:155]
    ds_read_b128 v[96:99], v34 offset:4096
    v_mfma_f32_16x16x32_bf16 v[156:159], v[40:43], v[68:71], v[156:159]
    ds_read_b128 v[100:103], v34 offset:6144
    v_mfma_f32_16x16x32_bf16 v[160:163], v[40:43], v[72:75], v[160:163]
    ds_read_b128 v[104:107], v34 offset:8192
    v_mfma_f32_16x16x32_bf16 v[164:167], v[40:43], v[76:79], v[164:167]
    ds_read_b128 v[108:111], v34 offset:10240
    v_mfma_f32_16x16x32_bf16 v[168:171], v[44:47], v[48:51], v[168:171]
    ds_read_b128 v[112:115], v34 offset:12288
    v_mfma_f32_16x16x32_bf16 v[172:175], v[44:47], v[52:55], v[172:175]
    ds_read_b128 v[116:119], v34 offset:14336
    v_mfma_f32_16x16x32_bf16 v[176:179], v[44:47], v[56:59], v[176:179]
    v_mfma_f32_16x16x32_bf16 v[180:183], v[44:47], v[60:63], v[180:183]
    v_mfma_f32_16x16x32_bf16 v[184:187], v[44:47], v[64:67], v[184:187]
    v_mfma_f32_16x16x32_bf16 v[188:191], v[44:47], v[68:71], v[188:191]
    v_mfma_f32_16x16x32_bf16 v[192:195], v[44:47], v[72:75], v[192:195]
    v_mfma_f32_16x16x32_bf16 v[196:199], v[44:47], v[76:79], v[196:199]
    s_waitcnt lgkmcnt(0)
    s_barrier
    v_mfma_f32_16x16x32_bf16 v[136:139], v[80:83], v[88:91], v[136:139]
    ds_read_b128 v[40:43], v23 offset:0
    v_mfma_f32_16x16x32_bf16 v[140:143], v[80:83], v[92:95], v[140:143]
    ds_read_b128 v[44:47], v23 offset:2048
    v_mfma_f32_16x16x32_bf16 v[144:147], v[80:83], v[96:99], v[144:147]
    ds_read_b128 v[48:51], v31 offset:0
    v_mfma_f32_16x16x32_bf16 v[148:151], v[80:83], v[100:103], v[148:151]
    ds_read_b128 v[52:55], v31 offset:2048
    v_mfma_f32_16x16x32_bf16 v[152:155], v[80:83], v[104:107], v[152:155]
    ds_read_b128 v[56:59], v31 offset:4096
    v_mfma_f32_16x16x32_bf16 v[156:159], v[80:83], v[108:111], v[156:159]
    ds_read_b128 v[60:63], v31 offset:6144
    v_mfma_f32_16x16x32_bf16 v[160:163], v[80:83], v[112:115], v[160:163]
    ds_read_b128 v[64:67], v31 offset:8192
    v_mfma_f32_16x16x32_bf16 v[164:167], v[80:83], v[116:119], v[164:167]
    ds_read_b128 v[68:71], v31 offset:10240
    v_mfma_f32_16x16x32_bf16 v[168:171], v[84:87], v[88:91], v[168:171]
    ds_read_b128 v[72:75], v31 offset:12288
    v_mfma_f32_16x16x32_bf16 v[172:175], v[84:87], v[92:95], v[172:175]
    ds_read_b128 v[76:79], v31 offset:14336
    v_mfma_f32_16x16x32_bf16 v[176:179], v[84:87], v[96:99], v[176:179]
    v_mfma_f32_16x16x32_bf16 v[180:183], v[84:87], v[100:103], v[180:183]
    v_mfma_f32_16x16x32_bf16 v[184:187], v[84:87], v[104:107], v[184:187]
    v_mfma_f32_16x16x32_bf16 v[188:191], v[84:87], v[108:111], v[188:191]
    v_mfma_f32_16x16x32_bf16 v[192:195], v[84:87], v[112:115], v[192:195]
    v_mfma_f32_16x16x32_bf16 v[196:199], v[84:87], v[116:119], v[196:199]
    s_waitcnt lgkmcnt(0)
    v_mfma_f32_16x16x32_bf16 v[136:139], v[40:43], v[48:51], v[136:139]
    ds_read_b128 v[80:83], v27 offset:0
    v_mfma_f32_16x16x32_bf16 v[140:143], v[40:43], v[52:55], v[140:143]
    ds_read_b128 v[84:87], v27 offset:2048
    v_mfma_f32_16x16x32_bf16 v[144:147], v[40:43], v[56:59], v[144:147]
    ds_read_b128 v[88:91], v35 offset:0
    v_mfma_f32_16x16x32_bf16 v[148:151], v[40:43], v[60:63], v[148:151]
    ds_read_b128 v[92:95], v35 offset:2048
    v_mfma_f32_16x16x32_bf16 v[152:155], v[40:43], v[64:67], v[152:155]
    ds_read_b128 v[96:99], v35 offset:4096
    v_mfma_f32_16x16x32_bf16 v[156:159], v[40:43], v[68:71], v[156:159]
    ds_read_b128 v[100:103], v35 offset:6144
    v_mfma_f32_16x16x32_bf16 v[160:163], v[40:43], v[72:75], v[160:163]
    ds_read_b128 v[104:107], v35 offset:8192
    v_mfma_f32_16x16x32_bf16 v[164:167], v[40:43], v[76:79], v[164:167]
    ds_read_b128 v[108:111], v35 offset:10240
    v_mfma_f32_16x16x32_bf16 v[168:171], v[44:47], v[48:51], v[168:171]
    ds_read_b128 v[112:115], v35 offset:12288
    v_mfma_f32_16x16x32_bf16 v[172:175], v[44:47], v[52:55], v[172:175]
    ds_read_b128 v[116:119], v35 offset:14336
    v_mfma_f32_16x16x32_bf16 v[176:179], v[44:47], v[56:59], v[176:179]
    v_mfma_f32_16x16x32_bf16 v[180:183], v[44:47], v[60:63], v[180:183]
    v_mfma_f32_16x16x32_bf16 v[184:187], v[44:47], v[64:67], v[184:187]
    v_mfma_f32_16x16x32_bf16 v[188:191], v[44:47], v[68:71], v[188:191]
    v_mfma_f32_16x16x32_bf16 v[192:195], v[44:47], v[72:75], v[192:195]
    v_mfma_f32_16x16x32_bf16 v[196:199], v[44:47], v[76:79], v[196:199]
    s_waitcnt lgkmcnt(0)
    s_barrier
    v_mfma_f32_16x16x32_bf16 v[136:139], v[80:83], v[88:91], v[136:139]
    ds_read_b128 v[40:43], v20 offset:0
    v_mfma_f32_16x16x32_bf16 v[140:143], v[80:83], v[92:95], v[140:143]
    ds_read_b128 v[44:47], v20 offset:2048
    v_mfma_f32_16x16x32_bf16 v[144:147], v[80:83], v[96:99], v[144:147]
    ds_read_b128 v[48:51], v28 offset:0
    v_mfma_f32_16x16x32_bf16 v[148:151], v[80:83], v[100:103], v[148:151]
    ds_read_b128 v[52:55], v28 offset:2048
    v_mfma_f32_16x16x32_bf16 v[152:155], v[80:83], v[104:107], v[152:155]
    ds_read_b128 v[56:59], v28 offset:4096
    v_mfma_f32_16x16x32_bf16 v[156:159], v[80:83], v[108:111], v[156:159]
    ds_read_b128 v[60:63], v28 offset:6144
    v_mfma_f32_16x16x32_bf16 v[160:163], v[80:83], v[112:115], v[160:163]
    ds_read_b128 v[64:67], v28 offset:8192
    v_mfma_f32_16x16x32_bf16 v[164:167], v[80:83], v[116:119], v[164:167]
    ds_read_b128 v[68:71], v28 offset:10240
    v_mfma_f32_16x16x32_bf16 v[168:171], v[84:87], v[88:91], v[168:171]
    ds_read_b128 v[72:75], v28 offset:12288
    v_mfma_f32_16x16x32_bf16 v[172:175], v[84:87], v[92:95], v[172:175]
    ds_read_b128 v[76:79], v28 offset:14336
    v_mfma_f32_16x16x32_bf16 v[176:179], v[84:87], v[96:99], v[176:179]
    v_mfma_f32_16x16x32_bf16 v[180:183], v[84:87], v[100:103], v[180:183]
    v_mfma_f32_16x16x32_bf16 v[184:187], v[84:87], v[104:107], v[184:187]
    v_mfma_f32_16x16x32_bf16 v[188:191], v[84:87], v[108:111], v[188:191]
    v_mfma_f32_16x16x32_bf16 v[192:195], v[84:87], v[112:115], v[192:195]
    v_mfma_f32_16x16x32_bf16 v[196:199], v[84:87], v[116:119], v[196:199]
    s_waitcnt lgkmcnt(0)
    v_mfma_f32_16x16x32_bf16 v[136:139], v[40:43], v[48:51], v[136:139]
    ds_read_b128 v[80:83], v24 offset:0
    v_mfma_f32_16x16x32_bf16 v[140:143], v[40:43], v[52:55], v[140:143]
    ds_read_b128 v[84:87], v24 offset:2048
    v_mfma_f32_16x16x32_bf16 v[144:147], v[40:43], v[56:59], v[144:147]
    ds_read_b128 v[88:91], v32 offset:0
    v_mfma_f32_16x16x32_bf16 v[148:151], v[40:43], v[60:63], v[148:151]
    ds_read_b128 v[92:95], v32 offset:2048
    v_mfma_f32_16x16x32_bf16 v[152:155], v[40:43], v[64:67], v[152:155]
    ds_read_b128 v[96:99], v32 offset:4096
    v_mfma_f32_16x16x32_bf16 v[156:159], v[40:43], v[68:71], v[156:159]
    ds_read_b128 v[100:103], v32 offset:6144
    v_mfma_f32_16x16x32_bf16 v[160:163], v[40:43], v[72:75], v[160:163]
    ds_read_b128 v[104:107], v32 offset:8192
    v_mfma_f32_16x16x32_bf16 v[164:167], v[40:43], v[76:79], v[164:167]
    ds_read_b128 v[108:111], v32 offset:10240
    v_mfma_f32_16x16x32_bf16 v[168:171], v[44:47], v[48:51], v[168:171]
    ds_read_b128 v[112:115], v32 offset:12288
    v_mfma_f32_16x16x32_bf16 v[172:175], v[44:47], v[52:55], v[172:175]
    ds_read_b128 v[116:119], v32 offset:14336
    v_mfma_f32_16x16x32_bf16 v[176:179], v[44:47], v[56:59], v[176:179]
    v_mfma_f32_16x16x32_bf16 v[180:183], v[44:47], v[60:63], v[180:183]
    v_mfma_f32_16x16x32_bf16 v[184:187], v[44:47], v[64:67], v[184:187]
    v_mfma_f32_16x16x32_bf16 v[188:191], v[44:47], v[68:71], v[188:191]
    v_mfma_f32_16x16x32_bf16 v[192:195], v[44:47], v[72:75], v[192:195]
    v_mfma_f32_16x16x32_bf16 v[196:199], v[44:47], v[76:79], v[196:199]
    s_waitcnt lgkmcnt(0)
    s_barrier
    v_mfma_f32_16x16x32_bf16 v[136:139], v[80:83], v[88:91], v[136:139]
    ds_read_b128 v[40:43], v21 offset:0
    v_mfma_f32_16x16x32_bf16 v[140:143], v[80:83], v[92:95], v[140:143]
    ds_read_b128 v[44:47], v21 offset:2048
    v_mfma_f32_16x16x32_bf16 v[144:147], v[80:83], v[96:99], v[144:147]
    ds_read_b128 v[48:51], v29 offset:0
    v_mfma_f32_16x16x32_bf16 v[148:151], v[80:83], v[100:103], v[148:151]
    ds_read_b128 v[52:55], v29 offset:2048
    v_mfma_f32_16x16x32_bf16 v[152:155], v[80:83], v[104:107], v[152:155]
    ds_read_b128 v[56:59], v29 offset:4096
    v_mfma_f32_16x16x32_bf16 v[156:159], v[80:83], v[108:111], v[156:159]
    ds_read_b128 v[60:63], v29 offset:6144
    v_mfma_f32_16x16x32_bf16 v[160:163], v[80:83], v[112:115], v[160:163]
    ds_read_b128 v[64:67], v29 offset:8192
    v_mfma_f32_16x16x32_bf16 v[164:167], v[80:83], v[116:119], v[164:167]
    ds_read_b128 v[68:71], v29 offset:10240
    v_mfma_f32_16x16x32_bf16 v[168:171], v[84:87], v[88:91], v[168:171]
    ds_read_b128 v[72:75], v29 offset:12288
    v_mfma_f32_16x16x32_bf16 v[172:175], v[84:87], v[92:95], v[172:175]
    ds_read_b128 v[76:79], v29 offset:14336
    v_mfma_f32_16x16x32_bf16 v[176:179], v[84:87], v[96:99], v[176:179]
    v_mfma_f32_16x16x32_bf16 v[180:183], v[84:87], v[100:103], v[180:183]
    v_mfma_f32_16x16x32_bf16 v[184:187], v[84:87], v[104:107], v[184:187]
    v_mfma_f32_16x16x32_bf16 v[188:191], v[84:87], v[108:111], v[188:191]
    v_mfma_f32_16x16x32_bf16 v[192:195], v[84:87], v[112:115], v[192:195]
    v_mfma_f32_16x16x32_bf16 v[196:199], v[84:87], v[116:119], v[196:199]
    s_waitcnt lgkmcnt(0)
    v_mfma_f32_16x16x32_bf16 v[136:139], v[40:43], v[48:51], v[136:139]
    ds_read_b128 v[80:83], v25 offset:0
    v_mfma_f32_16x16x32_bf16 v[140:143], v[40:43], v[52:55], v[140:143]
    ds_read_b128 v[84:87], v25 offset:2048
    v_mfma_f32_16x16x32_bf16 v[144:147], v[40:43], v[56:59], v[144:147]
    ds_read_b128 v[88:91], v33 offset:0
    v_mfma_f32_16x16x32_bf16 v[148:151], v[40:43], v[60:63], v[148:151]
    ds_read_b128 v[92:95], v33 offset:2048
    v_mfma_f32_16x16x32_bf16 v[152:155], v[40:43], v[64:67], v[152:155]
    ds_read_b128 v[96:99], v33 offset:4096
    v_mfma_f32_16x16x32_bf16 v[156:159], v[40:43], v[68:71], v[156:159]
    ds_read_b128 v[100:103], v33 offset:6144
    v_mfma_f32_16x16x32_bf16 v[160:163], v[40:43], v[72:75], v[160:163]
    ds_read_b128 v[104:107], v33 offset:8192
    v_mfma_f32_16x16x32_bf16 v[164:167], v[40:43], v[76:79], v[164:167]
    ds_read_b128 v[108:111], v33 offset:10240
    v_mfma_f32_16x16x32_bf16 v[168:171], v[44:47], v[48:51], v[168:171]
    ds_read_b128 v[112:115], v33 offset:12288
    v_mfma_f32_16x16x32_bf16 v[172:175], v[44:47], v[52:55], v[172:175]
    ds_read_b128 v[116:119], v33 offset:14336
    v_mfma_f32_16x16x32_bf16 v[176:179], v[44:47], v[56:59], v[176:179]
    v_mfma_f32_16x16x32_bf16 v[180:183], v[44:47], v[60:63], v[180:183]
    v_mfma_f32_16x16x32_bf16 v[184:187], v[44:47], v[64:67], v[184:187]
    v_mfma_f32_16x16x32_bf16 v[188:191], v[44:47], v[68:71], v[188:191]
    v_mfma_f32_16x16x32_bf16 v[192:195], v[44:47], v[72:75], v[192:195]
    v_mfma_f32_16x16x32_bf16 v[196:199], v[44:47], v[76:79], v[196:199]
    s_waitcnt lgkmcnt(0)
    v_mfma_f32_16x16x32_bf16 v[136:139], v[80:83], v[88:91], v[136:139]
    v_mfma_f32_16x16x32_bf16 v[140:143], v[80:83], v[92:95], v[140:143]
    v_mfma_f32_16x16x32_bf16 v[144:147], v[80:83], v[96:99], v[144:147]
    v_mfma_f32_16x16x32_bf16 v[148:151], v[80:83], v[100:103], v[148:151]
    v_mfma_f32_16x16x32_bf16 v[152:155], v[80:83], v[104:107], v[152:155]
    v_mfma_f32_16x16x32_bf16 v[156:159], v[80:83], v[108:111], v[156:159]
    v_mfma_f32_16x16x32_bf16 v[160:163], v[80:83], v[112:115], v[160:163]
    v_mfma_f32_16x16x32_bf16 v[164:167], v[80:83], v[116:119], v[164:167]
    v_mfma_f32_16x16x32_bf16 v[168:171], v[84:87], v[88:91], v[168:171]
    v_mfma_f32_16x16x32_bf16 v[172:175], v[84:87], v[92:95], v[172:175]
    v_mfma_f32_16x16x32_bf16 v[176:179], v[84:87], v[96:99], v[176:179]
    v_mfma_f32_16x16x32_bf16 v[180:183], v[84:87], v[100:103], v[180:183]
    v_mfma_f32_16x16x32_bf16 v[184:187], v[84:87], v[104:107], v[184:187]
    v_mfma_f32_16x16x32_bf16 v[188:191], v[84:87], v[108:111], v[188:191]
    v_mfma_f32_16x16x32_bf16 v[192:195], v[84:87], v[112:115], v[192:195]
    v_mfma_f32_16x16x32_bf16 v[196:199], v[84:87], v[116:119], v[196:199]
    v_lshlrev_b32 v9, 5, v3
    v_add_u32 v9, 131072, v9
    ds_read_b128 v[40:43], v9 offset:0
    ds_read_b128 v[44:47], v9 offset:512
    ds_read_b128 v[48:51], v9 offset:1024
    ds_read_b128 v[52:55], v9 offset:1536
    s_nop 7
    s_waitcnt lgkmcnt(0)
    v_mov_b32 v60, v136
    v_mov_b32 v61, v152
    v_mov_b32 v62, v140
    v_mov_b32 v63, v156
    v_mov_b32 v64, v144
    v_mov_b32 v65, v160
    v_mov_b32 v66, v148
    v_mov_b32 v67, v164
    v_fma_f32 v70, -v41, v61, v137
    v_fma_f32 v71, v41, v60, v153
    v_fma_f32 v72, -v45, v63, v141
    v_fma_f32 v73, v45, v62, v157
    v_fma_f32 v74, -v49, v65, v145
    v_fma_f32 v75, v49, v64, v161
    v_fma_f32 v76, -v53, v67, v149
    v_fma_f32 v77, v53, v66, v165
    v_fma_f32 v60, v40, v60, v70
    v_fma_f32 v61, v40, v61, v71
    v_fma_f32 v62, v44, v62, v72
    v_fma_f32 v63, v44, v63, v73
    v_fma_f32 v64, v48, v64, v74
    v_fma_f32 v65, v48, v65, v75
    v_fma_f32 v66, v52, v66, v76
    v_fma_f32 v67, v52, v67, v77
    v_fma_f32 v70, -v41, v61, v138
    v_fma_f32 v71, v41, v60, v154
    v_fma_f32 v72, -v45, v63, v142
    v_fma_f32 v73, v45, v62, v158
    v_fma_f32 v74, -v49, v65, v146
    v_fma_f32 v75, v49, v64, v162
    v_fma_f32 v76, -v53, v67, v150
    v_fma_f32 v77, v53, v66, v166
    v_fma_f32 v60, v40, v60, v70
    v_fma_f32 v61, v40, v61, v71
    v_fma_f32 v62, v44, v62, v72
    v_fma_f32 v63, v44, v63, v73
    v_fma_f32 v64, v48, v64, v74
    v_fma_f32 v65, v48, v65, v75
    v_fma_f32 v66, v52, v66, v76
    v_fma_f32 v67, v52, v67, v77
    v_fma_f32 v70, -v41, v61, v139
    v_fma_f32 v71, v41, v60, v155
    v_fma_f32 v72, -v45, v63, v143
    v_fma_f32 v73, v45, v62, v159
    v_fma_f32 v74, -v49, v65, v147
    v_fma_f32 v75, v49, v64, v163
    v_fma_f32 v76, -v53, v67, v151
    v_fma_f32 v77, v53, v66, v167
    v_fma_f32 v60, v40, v60, v70
    v_fma_f32 v61, v40, v61, v71
    v_fma_f32 v62, v44, v62, v72
    v_fma_f32 v63, v44, v63, v73
    v_fma_f32 v64, v48, v64, v74
    v_fma_f32 v65, v48, v65, v75
    v_fma_f32 v66, v52, v66, v76
    v_fma_f32 v67, v52, v67, v77
    v_fma_f32 v70, -v41, v61, v168
    v_fma_f32 v71, v41, v60, v184
    v_fma_f32 v72, -v45, v63, v172
    v_fma_f32 v73, v45, v62, v188
    v_fma_f32 v74, -v49, v65, v176
    v_fma_f32 v75, v49, v64, v192
    v_fma_f32 v76, -v53, v67, v180
    v_fma_f32 v77, v53, v66, v196
    v_fma_f32 v60, v40, v60, v70
    v_fma_f32 v61, v40, v61, v71
    v_fma_f32 v62, v44, v62, v72
    v_fma_f32 v63, v44, v63, v73
    v_fma_f32 v64, v48, v64, v74
    v_fma_f32 v65, v48, v65, v75
    v_fma_f32 v66, v52, v66, v76
    v_fma_f32 v67, v52, v67, v77
    v_fma_f32 v70, -v41, v61, v169
    v_fma_f32 v71, v41, v60, v185
    v_fma_f32 v72, -v45, v63, v173
    v_fma_f32 v73, v45, v62, v189
    v_fma_f32 v74, -v49, v65, v177
    v_fma_f32 v75, v49, v64, v193
    v_fma_f32 v76, -v53, v67, v181
    v_fma_f32 v77, v53, v66, v197
    v_fma_f32 v60, v40, v60, v70
    v_fma_f32 v61, v40, v61, v71
    v_fma_f32 v62, v44, v62, v72
    v_fma_f32 v63, v44, v63, v73
    v_fma_f32 v64, v48, v64, v74
    v_fma_f32 v65, v48, v65, v75
    v_fma_f32 v66, v52, v66, v76
    v_fma_f32 v67, v52, v67, v77
    v_fma_f32 v70, -v41, v61, v170
    v_fma_f32 v71, v41, v60, v186
    v_fma_f32 v72, -v45, v63, v174
    v_fma_f32 v73, v45, v62, v190
    v_fma_f32 v74, -v49, v65, v178
    v_fma_f32 v75, v49, v64, v194
    v_fma_f32 v76, -v53, v67, v182
    v_fma_f32 v77, v53, v66, v198
    v_fma_f32 v60, v40, v60, v70
    v_fma_f32 v61, v40, v61, v71
    v_fma_f32 v62, v44, v62, v72
    v_fma_f32 v63, v44, v63, v73
    v_fma_f32 v64, v48, v64, v74
    v_fma_f32 v65, v48, v65, v75
    v_fma_f32 v66, v52, v66, v76
    v_fma_f32 v67, v52, v67, v77
    v_fma_f32 v70, -v41, v61, v171
    v_fma_f32 v71, v41, v60, v187
    v_fma_f32 v72, -v45, v63, v175
    v_fma_f32 v73, v45, v62, v191
    v_fma_f32 v74, -v49, v65, v179
    v_fma_f32 v75, v49, v64, v195
    v_fma_f32 v76, -v53, v67, v183
    v_fma_f32 v77, v53, v66, v199
    v_fma_f32 v60, v40, v60, v70
    v_fma_f32 v61, v40, v61, v71
    v_fma_f32 v62, v44, v62, v72
    v_fma_f32 v63, v44, v63, v73
    v_fma_f32 v64, v48, v64, v74
    v_fma_f32 v65, v48, v65, v75
    v_fma_f32 v66, v52, v66, v76
    v_fma_f32 v67, v52, v67, v77
    s_lshl_b32 s37, s32, 2
    v_add_u32 v80, s37, v4
    v_mul_u32_u24 v80, 64, v80
    v_add_u32 v80, v80, v3
    v_lshlrev_b32 v80, 3, v80
    v_add_u32 v81, 65536, v80
    ds_write_b64 v81, v[60:61] offset:0
    ds_write_b64 v81, v[62:63] offset:128
    ds_write_b64 v81, v[64:65] offset:256
    ds_write_b64 v81, v[66:67] offset:384
    s_waitcnt lgkmcnt(0)
    s_barrier
    s_cmp_lg_u32 s32, 0
    s_cbranch_scc1 k1s_nocomb
    v_lshlrev_b32 v82, 5, v0
    v_add_u32 v82, 131072, v82
    ds_read_b128 v[116:119], v82 offset:16
    v_lshlrev_b32 v82, 3, v0
    v_add_u32 v83, 65536, v82
    ds_read_b64 v[84:85], v83 offset:0
    ds_read_b64 v[86:87], v83 offset:512
    ds_read_b64 v[88:89], v83 offset:1024
    ds_read_b64 v[90:91], v83 offset:1536
    ds_read_b64 v[92:93], v83 offset:2048
    ds_read_b64 v[94:95], v83 offset:2560
    ds_read_b64 v[96:97], v83 offset:3072
    ds_read_b64 v[98:99], v83 offset:3584
    ds_read_b64 v[100:101], v83 offset:4096
    ds_read_b64 v[102:103], v83 offset:4608
    ds_read_b64 v[104:105], v83 offset:5120
    ds_read_b64 v[106:107], v83 offset:5632
    ds_read_b64 v[108:109], v83 offset:6144
    ds_read_b64 v[110:111], v83 offset:6656
    ds_read_b64 v[112:113], v83 offset:7168
    ds_read_b64 v[114:115], v83 offset:7680
    s_waitcnt lgkmcnt(0)
    v_mov_b32 v120, v84
    v_mov_b32 v121, v85
    v_fma_f32 v122, -v117, v121, v86
    v_fma_f32 v123, v117, v120, v87
    v_fma_f32 v120, v116, v120, v122
    v_fma_f32 v121, v116, v121, v123
    v_fma_f32 v122, -v117, v121, v88
    v_fma_f32 v123, v117, v120, v89
    v_fma_f32 v120, v116, v120, v122
    v_fma_f32 v121, v116, v121, v123
    v_fma_f32 v122, -v117, v121, v90
    v_fma_f32 v123, v117, v120, v91
    v_fma_f32 v120, v116, v120, v122
    v_fma_f32 v121, v116, v121, v123
    v_fma_f32 v122, -v117, v121, v92
    v_fma_f32 v123, v117, v120, v93
    v_fma_f32 v120, v116, v120, v122
    v_fma_f32 v121, v116, v121, v123
    v_fma_f32 v122, -v117, v121, v94
    v_fma_f32 v123, v117, v120, v95
    v_fma_f32 v120, v116, v120, v122
    v_fma_f32 v121, v116, v121, v123
    v_fma_f32 v122, -v117, v121, v96
    v_fma_f32 v123, v117, v120, v97
    v_fma_f32 v120, v116, v120, v122
    v_fma_f32 v121, v116, v121, v123
    v_fma_f32 v122, -v117, v121, v98
    v_fma_f32 v123, v117, v120, v99
    v_fma_f32 v120, v116, v120, v122
    v_fma_f32 v121, v116, v121, v123
    v_fma_f32 v122, -v117, v121, v100
    v_fma_f32 v123, v117, v120, v101
    v_fma_f32 v120, v116, v120, v122
    v_fma_f32 v121, v116, v121, v123
    v_fma_f32 v122, -v117, v121, v102
    v_fma_f32 v123, v117, v120, v103
    v_fma_f32 v120, v116, v120, v122
    v_fma_f32 v121, v116, v121, v123
    v_fma_f32 v122, -v117, v121, v104
    v_fma_f32 v123, v117, v120, v105
    v_fma_f32 v120, v116, v120, v122
    v_fma_f32 v121, v116, v121, v123
    v_fma_f32 v122, -v117, v121, v106
    v_fma_f32 v123, v117, v120, v107
    v_fma_f32 v120, v116, v120, v122
    v_fma_f32 v121, v116, v121, v123
    v_fma_f32 v122, -v117, v121, v108
    v_fma_f32 v123, v117, v120, v109
    v_fma_f32 v120, v116, v120, v122
    v_fma_f32 v121, v116, v121, v123
    v_fma_f32 v122, -v117, v121, v110
    v_fma_f32 v123, v117, v120, v111
    v_fma_f32 v120, v116, v120, v122
    v_fma_f32 v121, v116, v121, v123
    v_fma_f32 v122, -v117, v121, v112
    v_fma_f32 v123, v117, v120, v113
    v_fma_f32 v120, v116, v120, v122
    v_fma_f32 v121, v116, v121, v123
    v_fma_f32 v122, -v117, v121, v114
    v_fma_f32 v123, v117, v120, v115
    v_fma_f32 v120, v116, v120, v122
    v_fma_f32 v121, v116, v121, v123
    s_mul_i32 s37, s30, 64
    v_add_u32 v124, s37, v0
    v_lshlrev_b32 v124, 3, v124
    v_add_u32 v124, 21970944, v124
    s_mul_i32 s37, s31, 5120
    buffer_store_dwordx2 v[120:121], v124, s[8:11], s37 offen sc1
    s_nop 1
    v_mov_b32 v120, 0
    v_mov_b32 v121, 0
    s_cmp_eq_u32 s31, 0
    s_cbranch_scc1 k1s_nocarry
    s_mov_b32 s52, 0
k1s_poll:
    v_mov_b32 v125, v124
    buffer_load_dwordx2 v[216:217], v125, s[8:11], 0 offen sc1
    v_add_u32 v125, 5120, v125
    buffer_load_dwordx2 v[218:219], v125, s[8:11], 0 offen sc1
    v_add_u32 v125, 5120, v125
    buffer_load_dwordx2 v[220:221], v125, s[8:11], 0 offen sc1
    v_add_u32 v125, 5120, v125
    buffer_load_dwordx2 v[222:223], v125, s[8:11], 0 offen sc1
    v_add_u32 v125, 5120, v125
    buffer_load_dwordx2 v[224:225], v125, s[8:11], 0 offen sc1
    v_add_u32 v125, 5120, v125
    buffer_load_dwordx2 v[226:227], v125, s[8:11], 0 offen sc1
    v_add_u32 v125, 5120, v125
    buffer_load_dwordx2 v[228:229], v125, s[8:11], 0 offen sc1
    v_add_u32 v125, 5120, v125
    buffer_load_dwordx2 v[230:231], v125, s[8:11], 0 offen sc1
    v_add_u32 v125, 5120, v125
    buffer_load_dwordx2 v[232:233], v125, s[8:11], 0 offen sc1
    v_add_u32 v125, 5120, v125
    buffer_load_dwordx2 v[234:235], v125, s[8:11], 0 offen sc1
    v_add_u32 v125, 5120, v125
    buffer_load_dwordx2 v[236:237], v125, s[8:11], 0 offen sc1
    v_add_u32 v125, 5120, v125
    buffer_load_dwordx2 v[238:239], v125, s[8:11], 0 offen sc1
    v_add_u32 v125, 5120, v125
    buffer_load_dwordx2 v[240:241], v125, s[8:11], 0 offen sc1
    v_add_u32 v125, 5120, v125
    buffer_load_dwordx2 v[242:243], v125, s[8:11], 0 offen sc1
    v_add_u32 v125, 5120, v125
    buffer_load_dwordx2 v[244:245], v125, s[8:11], 0 offen sc1
    s_waitcnt vmcnt(0)
    s_mov_b64 s[54:55], 0
    s_cmp_gt_u32 s31, 0
    s_cbranch_scc0 k1s_chk
    v_cmp_eq_u32 vcc, -1, v216
    s_or_b64 s[54:55], s[54:55], vcc
    v_cmp_eq_u32 vcc, -1, v217
    s_or_b64 s[54:55], s[54:55], vcc
    s_cmp_gt_u32 s31, 1
    s_cbranch_scc0 k1s_chk
    v_cmp_eq_u32 vcc, -1, v218
    s_or_b64 s[54:55], s[54:55], vcc
    v_cmp_eq_u32 vcc, -1, v219
    s_or_b64 s[54:55], s[54:55], vcc
    s_cmp_gt_u32 s31, 2
    s_cbranch_scc0 k1s_chk
    v_cmp_eq_u32 vcc, -1, v220
    s_or_b64 s[54:55], s[54:55], vcc
    v_cmp_eq_u32 vcc, -1, v221
    s_or_b64 s[54:55], s[54:55], vcc
    s_cmp_gt_u32 s31, 3
    s_cbranch_scc0 k1s_chk
    v_cmp_eq_u32 vcc, -1, v222
    s_or_b64 s[54:55], s[54:55], vcc
    v_cmp_eq_u32 vcc, -1, v223
    s_or_b64 s[54:55], s[54:55], vcc
    s_cmp_gt_u32 s31, 4
    s_cbranch_scc0 k1s_chk
    v_cmp_eq_u32 vcc, -1, v224
    s_or_b64 s[54:55], s[54:55], vcc
    v_cmp_eq_u32 vcc, -1, v225
    s_or_b64 s[54:55], s[54:55], vcc
    s_cmp_gt_u32 s31, 5
    s_cbranch_scc0 k1s_chk
    v_cmp_eq_u32 vcc, -1, v226
    s_or_b64 s[54:55], s[54:55], vcc
    v_cmp_eq_u32 vcc, -1, v227
    s_or_b64 s[54:55], s[54:55], vcc
    s_cmp_gt_u32 s31, 6
    s_cbranch_scc0 k1s_chk
    v_cmp_eq_u32 vcc, -1, v228
    s_or_b64 s[54:55], s[54:55], vcc
    v_cmp_eq_u32 vcc, -1, v229
    s_or_b64 s[54:55], s[54:55], vcc
    s_cmp_gt_u32 s31, 7
    s_cbranch_scc0 k1s_chk
    v_cmp_eq_u32 vcc, -1, v230
    s_or_b64 s[54:55], s[54:55], vcc
    v_cmp_eq_u32 vcc, -1, v231
    s_or_b64 s[54:55], s[54:55], vcc
    s_cmp_gt_u32 s31, 8
    s_cbranch_scc0 k1s_chk
    v_cmp_eq_u32 vcc, -1, v232
    s_or_b64 s[54:55], s[54:55], vcc
    v_cmp_eq_u32 vcc, -1, v233
    s_or_b64 s[54:55], s[54:55], vcc
    s_cmp_gt_u32 s31, 9
    s_cbranch_scc0 k1s_chk
    v_cmp_eq_u32 vcc, -1, v234
    s_or_b64 s[54:55], s[54:55], vcc
    v_cmp_eq_u32 vcc, -1, v235
    s_or_b64 s[54:55], s[54:55], vcc
    s_cmp_gt_u32 s31, 10
    s_cbranch_scc0 k1s_chk
    v_cmp_eq_u32 vcc, -1, v236
    s_or_b64 s[54:55], s[54:55], vcc
    v_cmp_eq_u32 vcc, -1, v237
    s_or_b64 s[54:55], s[54:55], vcc
    s_cmp_gt_u32 s31, 11
    s_cbranch_scc0 k1s_chk
    v_cmp_eq_u32 vcc, -1, v238
    s_or_b64 s[54:55], s[54:55], vcc
    v_cmp_eq_u32 vcc, -1, v239
    s_or_b64 s[54:55], s[54:55], vcc
    s_cmp_gt_u32 s31, 12
    s_cbranch_scc0 k1s_chk
    v_cmp_eq_u32 vcc, -1, v240
    s_or_b64 s[54:55], s[54:55], vcc
    v_cmp_eq_u32 vcc, -1, v241
    s_or_b64 s[54:55], s[54:55], vcc
    s_cmp_gt_u32 s31, 13
    s_cbranch_scc0 k1s_chk
    v_cmp_eq_u32 vcc, -1, v242
    s_or_b64 s[54:55], s[54:55], vcc
    v_cmp_eq_u32 vcc, -1, v243
    s_or_b64 s[54:55], s[54:55], vcc
    s_cmp_gt_u32 s31, 14
    s_cbranch_scc0 k1s_chk
    v_cmp_eq_u32 vcc, -1, v244
    s_or_b64 s[54:55], s[54:55], vcc
    v_cmp_eq_u32 vcc, -1, v245
    s_or_b64 s[54:55], s[54:55], vcc
k1s_chk:
    s_cmp_eq_u64 s[54:55], 0
    s_cbranch_scc1 k1s_polled
    s_sleep 4
    s_add_u32 s52, s52, 1
    s_cmp_lt_u32 s52, 0x40000
    s_cbranch_scc1 k1s_poll
k1s_polled:
    s_cmp_gt_u32 s31, 0
    s_cbranch_scc0 k1s_nocarry
    v_fma_f32 v122, -v119, v121, v216
    v_fma_f32 v123, v119, v120, v217
    v_fma_f32 v120, v118, v120, v122
    v_fma_f32 v121, v118, v121, v123
    s_cmp_gt_u32 s31, 1
    s_cbranch_scc0 k1s_nocarry
    v_fma_f32 v122, -v119, v121, v218
    v_fma_f32 v123, v119, v120, v219
    v_fma_f32 v120, v118, v120, v122
    v_fma_f32 v121, v118, v121, v123
    s_cmp_gt_u32 s31, 2
    s_cbranch_scc0 k1s_nocarry
    v_fma_f32 v122, -v119, v121, v220
    v_fma_f32 v123, v119, v120, v221
    v_fma_f32 v120, v118, v120, v122
    v_fma_f32 v121, v118, v121, v123
    s_cmp_gt_u32 s31, 3
    s_cbranch_scc0 k1s_nocarry
    v_fma_f32 v122, -v119, v121, v222
    v_fma_f32 v123, v119, v120, v223
    v_fma_f32 v120, v118, v120, v122
    v_fma_f32 v121, v118, v121, v123
    s_cmp_gt_u32 s31, 4
    s_cbranch_scc0 k1s_nocarry
    v_fma_f32 v122, -v119, v121, v224
    v_fma_f32 v123, v119, v120, v225
    v_fma_f32 v120, v118, v120, v122
    v_fma_f32 v121, v118, v121, v123
    s_cmp_gt_u32 s31, 5
    s_cbranch_scc0 k1s_nocarry
    v_fma_f32 v122, -v119, v121, v226
    v_fma_f32 v123, v119, v120, v227
    v_fma_f32 v120, v118, v120, v122
    v_fma_f32 v121, v118, v121, v123
    s_cmp_gt_u32 s31, 6
    s_cbranch_scc0 k1s_nocarry
    v_fma_f32 v122, -v119, v121, v228
    v_fma_f32 v123, v119, v120, v229
    v_fma_f32 v120, v118, v120, v122
    v_fma_f32 v121, v118, v121, v123
    s_cmp_gt_u32 s31, 7
    s_cbranch_scc0 k1s_nocarry
    v_fma_f32 v122, -v119, v121, v230
    v_fma_f32 v123, v119, v120, v231
    v_fma_f32 v120, v118, v120, v122
    v_fma_f32 v121, v118, v121, v123
    s_cmp_gt_u32 s31, 8
    s_cbranch_scc0 k1s_nocarry
    v_fma_f32 v122, -v119, v121, v232
    v_fma_f32 v123, v119, v120, v233
    v_fma_f32 v120, v118, v120, v122
    v_fma_f32 v121, v118, v121, v123
    s_cmp_gt_u32 s31, 9
    s_cbranch_scc0 k1s_nocarry
    v_fma_f32 v122, -v119, v121, v234
    v_fma_f32 v123, v119, v120, v235
    v_fma_f32 v120, v118, v120, v122
    v_fma_f32 v121, v118, v121, v123
    s_cmp_gt_u32 s31, 10
    s_cbranch_scc0 k1s_nocarry
    v_fma_f32 v122, -v119, v121, v236
    v_fma_f32 v123, v119, v120, v237
    v_fma_f32 v120, v118, v120, v122
    v_fma_f32 v121, v118, v121, v123
    s_cmp_gt_u32 s31, 11
    s_cbranch_scc0 k1s_nocarry
    v_fma_f32 v122, -v119, v121, v238
    v_fma_f32 v123, v119, v120, v239
    v_fma_f32 v120, v118, v120, v122
    v_fma_f32 v121, v118, v121, v123
    s_cmp_gt_u32 s31, 12
    s_cbranch_scc0 k1s_nocarry
    v_fma_f32 v122, -v119, v121, v240
    v_fma_f32 v123, v119, v120, v241
    v_fma_f32 v120, v118, v120, v122
    v_fma_f32 v121, v118, v121, v123
    s_cmp_gt_u32 s31, 13
    s_cbranch_scc0 k1s_nocarry
    v_fma_f32 v122, -v119, v121, v242
    v_fma_f32 v123, v119, v120, v243
    v_fma_f32 v120, v118, v120, v122
    v_fma_f32 v121, v118, v121, v123
    s_cmp_gt_u32 s31, 14
    s_cbranch_scc0 k1s_nocarry
    v_fma_f32 v122, -v119, v121, v244
    v_fma_f32 v123, v119, v120, v245
    v_fma_f32 v120, v118, v120, v122
    v_fma_f32 v121, v118, v121, v123
k1s_nocarry:
    v_add_u32 v83, 73728, v82
    ds_write_b64 v83, v[120:121] offset:0
    v_fma_f32 v122, -v117, v121, v84
    v_fma_f32 v123, v117, v120, v85
    v_fma_f32 v120, v116, v120, v122
    v_fma_f32 v121, v116, v121, v123
    ds_write_b64 v83, v[120:121] offset:512
    v_fma_f32 v122, -v117, v121, v86
    v_fma_f32 v123, v117, v120, v87
    v_fma_f32 v120, v116, v120, v122
    v_fma_f32 v121, v116, v121, v123
    ds_write_b64 v83, v[120:121] offset:1024
    v_fma_f32 v122, -v117, v121, v88
    v_fma_f32 v123, v117, v120, v89
    v_fma_f32 v120, v116, v120, v122
    v_fma_f32 v121, v116, v121, v123
    ds_write_b64 v83, v[120:121] offset:1536
    v_fma_f32 v122, -v117, v121, v90
    v_fma_f32 v123, v117, v120, v91
    v_fma_f32 v120, v116, v120, v122
    v_fma_f32 v121, v116, v121, v123
    ds_write_b64 v83, v[120:121] offset:2048
    v_fma_f32 v122, -v117, v121, v92
    v_fma_f32 v123, v117, v120, v93
    v_fma_f32 v120, v116, v120, v122
    v_fma_f32 v121, v116, v121, v123
    ds_write_b64 v83, v[120:121] offset:2560
    v_fma_f32 v122, -v117, v121, v94
    v_fma_f32 v123, v117, v120, v95
    v_fma_f32 v120, v116, v120, v122
    v_fma_f32 v121, v116, v121, v123
    ds_write_b64 v83, v[120:121] offset:3072
    v_fma_f32 v122, -v117, v121, v96
    v_fma_f32 v123, v117, v120, v97
    v_fma_f32 v120, v116, v120, v122
    v_fma_f32 v121, v116, v121, v123
    ds_write_b64 v83, v[120:121] offset:3584
    v_fma_f32 v122, -v117, v121, v98
    v_fma_f32 v123, v117, v120, v99
    v_fma_f32 v120, v116, v120, v122
    v_fma_f32 v121, v116, v121, v123
    ds_write_b64 v83, v[120:121] offset:4096
    v_fma_f32 v122, -v117, v121, v100
    v_fma_f32 v123, v117, v120, v101
    v_fma_f32 v120, v116, v120, v122
    v_fma_f32 v121, v116, v121, v123
    ds_write_b64 v83, v[120:121] offset:4608
    v_fma_f32 v122, -v117, v121, v102
    v_fma_f32 v123, v117, v120, v103
    v_fma_f32 v120, v116, v120, v122
    v_fma_f32 v121, v116, v121, v123
    ds_write_b64 v83, v[120:121] offset:5120
    v_fma_f32 v122, -v117, v121, v104
    v_fma_f32 v123, v117, v120, v105
    v_fma_f32 v120, v116, v120, v122
    v_fma_f32 v121, v116, v121, v123
    ds_write_b64 v83, v[120:121] offset:5632
    v_fma_f32 v122, -v117, v121, v106
    v_fma_f32 v123, v117, v120, v107
    v_fma_f32 v120, v116, v120, v122
    v_fma_f32 v121, v116, v121, v123
    ds_write_b64 v83, v[120:121] offset:6144
    v_fma_f32 v122, -v117, v121, v108
    v_fma_f32 v123, v117, v120, v109
    v_fma_f32 v120, v116, v120, v122
    v_fma_f32 v121, v116, v121, v123
    ds_write_b64 v83, v[120:121] offset:6656
    v_fma_f32 v122, -v117, v121, v110
    v_fma_f32 v123, v117, v120, v111
    v_fma_f32 v120, v116, v120, v122
    v_fma_f32 v121, v116, v121, v123
    ds_write_b64 v83, v[120:121] offset:7168
    v_fma_f32 v122, -v117, v121, v112
    v_fma_f32 v123, v117, v120, v113
    v_fma_f32 v120, v116, v120, v122
    v_fma_f32 v121, v116, v121, v123
    ds_write_b64 v83, v[120:121] offset:7680
k1s_nocomb:
    s_mul_i32 s37, s32, 8832
    s_add_u32 s37, s37, 98304
    v_mul_u32_u24 v126, 272, v4
    v_lshl_add_u32 v126, v3, 4, v126
    v_add_u32 v126, s37, v126
    s_lshl_b32 s39, s31, 7
    s_lshl_b32 s40, s32, 5
    s_add_u32 s39, s39, s40
    v_add_u32 v127, s39, v4
    s_movk_i32 s41, 5760
    v_mul_lo_u32 v127, v127, s41
    v_lshl_add_u32 v127, v3, 4, v127
    v_cmp_lt_u32 vcc, 7, v3
    v_mov_b32 v128, 0
    v_mov_b32 v129, 1152
    v_cndmask_b32 v128, v128, v129, vcc
    s_mul_i32 s40, s30, 128
    s_add_u32 s40, s40, 4931584
    v_add3_u32 v127, v127, v128, s40
    v_mul_u32_u24 v82, 2208, v4
    v_lshl_add_u32 v82, v3, 1, v82
    v_add_u32 v82, s37, v82
    s_waitcnt lgkmcnt(0)
    s_barrier
    v_add_u32 v81, 73728, v80
    ds_read_b64 v[60:61], v81 offset:0
    ds_read_b64 v[62:63], v81 offset:128
    ds_read_b64 v[64:65], v81 offset:256
    ds_read_b64 v[66:67], v81 offset:384
    s_waitcnt lgkmcnt(0)
    v_fma_f32 v70, -v41, v61, v136
    v_fma_f32 v71, v41, v60, v152
    v_fma_f32 v72, -v45, v63, v140
    v_fma_f32 v73, v45, v62, v156
    v_fma_f32 v74, -v49, v65, v144
    v_fma_f32 v75, v49, v64, v160
    v_fma_f32 v76, -v53, v67, v148
    v_fma_f32 v77, v53, v66, v164
    v_fma_f32 v60, v40, v60, v70
    v_fma_f32 v61, v40, v61, v71
    v_fma_f32 v62, v44, v62, v72
    v_fma_f32 v63, v44, v63, v73
    v_fma_f32 v64, v48, v64, v74
    v_fma_f32 v65, v48, v65, v75
    v_fma_f32 v66, v52, v66, v76
    v_fma_f32 v67, v52, v67, v77
    v_mul_f32 v136, v42, v60
    v_mul_f32 v152, -v42, v61
    v_mul_f32 v140, v46, v62
    v_mul_f32 v156, -v46, v63
    v_mul_f32 v144, v50, v64
    v_mul_f32 v160, -v50, v65
    v_mul_f32 v148, v54, v66
    v_mul_f32 v164, -v54, v67
    v_fma_f32 v136, -v43, v61, v136
    v_fma_f32 v152, -v43, v60, v152
    v_fma_f32 v140, -v47, v63, v140
    v_fma_f32 v156, -v47, v62, v156
    v_fma_f32 v144, -v51, v65, v144
    v_fma_f32 v160, -v51, v64, v160
    v_fma_f32 v148, -v55, v67, v148
    v_fma_f32 v164, -v55, v66, v164
    v_fma_f32 v70, -v41, v61, v137
    v_fma_f32 v71, v41, v60, v153
    v_fma_f32 v72, -v45, v63, v141
    v_fma_f32 v73, v45, v62, v157
    v_fma_f32 v74, -v49, v65, v145
    v_fma_f32 v75, v49, v64, v161
    v_fma_f32 v76, -v53, v67, v149
    v_fma_f32 v77, v53, v66, v165
    v_fma_f32 v60, v40, v60, v70
    v_fma_f32 v61, v40, v61, v71
    v_fma_f32 v62, v44, v62, v72
    v_fma_f32 v63, v44, v63, v73
    v_fma_f32 v64, v48, v64, v74
    v_fma_f32 v65, v48, v65, v75
    v_fma_f32 v66, v52, v66, v76
    v_fma_f32 v67, v52, v67, v77
    v_mul_f32 v137, v42, v60
    v_mul_f32 v153, -v42, v61
    v_mul_f32 v141, v46, v62
    v_mul_f32 v157, -v46, v63
    v_mul_f32 v145, v50, v64
    v_mul_f32 v161, -v50, v65
    v_mul_f32 v149, v54, v66
    v_mul_f32 v165, -v54, v67
    v_fma_f32 v137, -v43, v61, v137
    v_fma_f32 v153, -v43, v60, v153
    v_fma_f32 v141, -v47, v63, v141
    v_fma_f32 v157, -v47, v62, v157
    v_fma_f32 v145, -v51, v65, v145
    v_fma_f32 v161, -v51, v64, v161
    v_fma_f32 v149, -v55, v67, v149
    v_fma_f32 v165, -v55, v66, v165
    v_fma_f32 v70, -v41, v61, v138
    v_fma_f32 v71, v41, v60, v154
    v_fma_f32 v72, -v45, v63, v142
    v_fma_f32 v73, v45, v62, v158
    v_fma_f32 v74, -v49, v65, v146
    v_fma_f32 v75, v49, v64, v162
    v_fma_f32 v76, -v53, v67, v150
    v_fma_f32 v77, v53, v66, v166
    v_fma_f32 v60, v40, v60, v70
    v_fma_f32 v61, v40, v61, v71
    v_fma_f32 v62, v44, v62, v72
    v_fma_f32 v63, v44, v63, v73
    v_fma_f32 v64, v48, v64, v74
    v_fma_f32 v65, v48, v65, v75
    v_fma_f32 v66, v52, v66, v76
    v_fma_f32 v67, v52, v67, v77
    v_mul_f32 v138, v42, v60
    v_mul_f32 v154, -v42, v61
    v_mul_f32 v142, v46, v62
    v_mul_f32 v158, -v46, v63
    v_mul_f32 v146, v50, v64
    v_mul_f32 v162, -v50, v65
    v_mul_f32 v150, v54, v66
    v_mul_f32 v166, -v54, v67
    v_fma_f32 v138, -v43, v61, v138
    v_fma_f32 v154, -v43, v60, v154
    v_fma_f32 v142, -v47, v63, v142
    v_fma_f32 v158, -v47, v62, v158
    v_fma_f32 v146, -v51, v65, v146
    v_fma_f32 v162, -v51, v64, v162
    v_fma_f32 v150, -v55, v67, v150
    v_fma_f32 v166, -v55, v66, v166
    v_fma_f32 v70, -v41, v61, v139
    v_fma_f32 v71, v41, v60, v155
    v_fma_f32 v72, -v45, v63, v143
    v_fma_f32 v73, v45, v62, v159
    v_fma_f32 v74, -v49, v65, v147
    v_fma_f32 v75, v49, v64, v163
    v_fma_f32 v76, -v53, v67, v151
    v_fma_f32 v77, v53, v66, v167
    v_fma_f32 v60, v40, v60, v70
    v_fma_f32 v61, v40, v61, v71
    v_fma_f32 v62, v44, v62, v72
    v_fma_f32 v63, v44, v63, v73
    v_fma_f32 v64, v48, v64, v74
    v_fma_f32 v65, v48, v65, v75
    v_fma_f32 v66, v52, v66, v76
    v_fma_f32 v67, v52, v67, v77
    v_mul_f32 v139, v42, v60
    v_mul_f32 v155, -v42, v61
    v_mul_f32 v143, v46, v62
    v_mul_f32 v159, -v46, v63
    v_mul_f32 v147, v50, v64
    v_mul_f32 v163, -v50, v65
    v_mul_f32 v151, v54, v66
    v_mul_f32 v167, -v54, v67
    v_fma_f32 v139, -v43, v61, v139
    v_fma_f32 v155, -v43, v60, v155
    v_fma_f32 v143, -v47, v63, v143
    v_fma_f32 v159, -v47, v62, v159
    v_fma_f32 v147, -v51, v65, v147
    v_fma_f32 v163, -v51, v64, v163
    v_fma_f32 v151, -v55, v67, v151
    v_fma_f32 v167, -v55, v66, v167
    v_fma_f32 v70, -v41, v61, v168
    v_fma_f32 v71, v41, v60, v184
    v_fma_f32 v72, -v45, v63, v172
    v_fma_f32 v73, v45, v62, v188
    v_fma_f32 v74, -v49, v65, v176
    v_fma_f32 v75, v49, v64, v192
    v_fma_f32 v76, -v53, v67, v180
    v_fma_f32 v77, v53, v66, v196
    v_fma_f32 v60, v40, v60, v70
    v_fma_f32 v61, v40, v61, v71
    v_fma_f32 v62, v44, v62, v72
    v_fma_f32 v63, v44, v63, v73
    v_fma_f32 v64, v48, v64, v74
    v_fma_f32 v65, v48, v65, v75
    v_fma_f32 v66, v52, v66, v76
    v_fma_f32 v67, v52, v67, v77
    v_mul_f32 v168, v42, v60
    v_mul_f32 v184, -v42, v61
    v_mul_f32 v172, v46, v62
    v_mul_f32 v188, -v46, v63
    v_mul_f32 v176, v50, v64
    v_mul_f32 v192, -v50, v65
    v_mul_f32 v180, v54, v66
    v_mul_f32 v196, -v54, v67
    v_fma_f32 v168, -v43, v61, v168
    v_fma_f32 v184, -v43, v60, v184
    v_fma_f32 v172, -v47, v63, v172
    v_fma_f32 v188, -v47, v62, v188
    v_fma_f32 v176, -v51, v65, v176
    v_fma_f32 v192, -v51, v64, v192
    v_fma_f32 v180, -v55, v67, v180
    v_fma_f32 v196, -v55, v66, v196
    v_fma_f32 v70, -v41, v61, v169
    v_fma_f32 v71, v41, v60, v185
    v_fma_f32 v72, -v45, v63, v173
    v_fma_f32 v73, v45, v62, v189
    v_fma_f32 v74, -v49, v65, v177
    v_fma_f32 v75, v49, v64, v193
    v_fma_f32 v76, -v53, v67, v181
    v_fma_f32 v77, v53, v66, v197
    v_fma_f32 v60, v40, v60, v70
    v_fma_f32 v61, v40, v61, v71
    v_fma_f32 v62, v44, v62, v72
    v_fma_f32 v63, v44, v63, v73
    v_fma_f32 v64, v48, v64, v74
    v_fma_f32 v65, v48, v65, v75
    v_fma_f32 v66, v52, v66, v76
    v_fma_f32 v67, v52, v67, v77
    v_mul_f32 v169, v42, v60
    v_mul_f32 v185, -v42, v61
    v_mul_f32 v173, v46, v62
    v_mul_f32 v189, -v46, v63
    v_mul_f32 v177, v50, v64
    v_mul_f32 v193, -v50, v65
    v_mul_f32 v181, v54, v66
    v_mul_f32 v197, -v54, v67
    v_fma_f32 v169, -v43, v61, v169
    v_fma_f32 v185, -v43, v60, v185
    v_fma_f32 v173, -v47, v63, v173
    v_fma_f32 v189, -v47, v62, v189
    v_fma_f32 v177, -v51, v65, v177
    v_fma_f32 v193, -v51, v64, v193
    v_fma_f32 v181, -v55, v67, v181
    v_fma_f32 v197, -v55, v66, v197
    v_fma_f32 v70, -v41, v61, v170
    v_fma_f32 v71, v41, v60, v186
    v_fma_f32 v72, -v45, v63, v174
    v_fma_f32 v73, v45, v62, v190
    v_fma_f32 v74, -v49, v65, v178
    v_fma_f32 v75, v49, v64, v194
    v_fma_f32 v76, -v53, v67, v182
    v_fma_f32 v77, v53, v66, v198
    v_fma_f32 v60, v40, v60, v70
    v_fma_f32 v61, v40, v61, v71
    v_fma_f32 v62, v44, v62, v72
    v_fma_f32 v63, v44, v63, v73
    v_fma_f32 v64, v48, v64, v74
    v_fma_f32 v65, v48, v65, v75
    v_fma_f32 v66, v52, v66, v76
    v_fma_f32 v67, v52, v67, v77
    v_mul_f32 v170, v42, v60
    v_mul_f32 v186, -v42, v61
    v_mul_f32 v174, v46, v62
    v_mul_f32 v190, -v46, v63
    v_mul_f32 v178, v50, v64
    v_mul_f32 v194, -v50, v65
    v_mul_f32 v182, v54, v66
    v_mul_f32 v198, -v54, v67
    v_fma_f32 v170, -v43, v61, v170
    v_fma_f32 v186, -v43, v60, v186
    v_fma_f32 v174, -v47, v63, v174
    v_fma_f32 v190, -v47, v62, v190
    v_fma_f32 v178, -v51, v65, v178
    v_fma_f32 v194, -v51, v64, v194
    v_fma_f32 v182, -v55, v67, v182
    v_fma_f32 v198, -v55, v66, v198
    v_fma_f32 v70, -v41, v61, v171
    v_fma_f32 v71, v41, v60, v187
    v_fma_f32 v72, -v45, v63, v175
    v_fma_f32 v73, v45, v62, v191
    v_fma_f32 v74, -v49, v65, v179
    v_fma_f32 v75, v49, v64, v195
    v_fma_f32 v76, -v53, v67, v183
    v_fma_f32 v77, v53, v66, v199
    v_fma_f32 v60, v40, v60, v70
    v_fma_f32 v61, v40, v61, v71
    v_fma_f32 v62, v44, v62, v72
    v_fma_f32 v63, v44, v63, v73
    v_fma_f32 v64, v48, v64, v74
    v_fma_f32 v65, v48, v65, v75
    v_fma_f32 v66, v52, v66, v76
    v_fma_f32 v67, v52, v67, v77
    v_mul_f32 v171, v42, v60
    v_mul_f32 v187, -v42, v61
    v_mul_f32 v175, v46, v62
    v_mul_f32 v191, -v46, v63
    v_mul_f32 v179, v50, v64
    v_mul_f32 v195, -v50, v65
    v_mul_f32 v183, v54, v66
    v_mul_f32 v199, -v54, v67
    v_fma_f32 v171, -v43, v61, v171
    v_fma_f32 v187, -v43, v60, v187
    v_fma_f32 v175, -v47, v63, v175
    v_fma_f32 v191, -v47, v62, v191
    v_fma_f32 v179, -v51, v65, v179
    v_fma_f32 v195, -v51, v64, v195
    v_fma_f32 v183, -v55, v67, v183
    v_fma_f32 v199, -v55, v66, v199
    v_cvt_pk_bf16_f32 v84, v136, v137
    v_cvt_pk_bf16_f32 v85, v138, v139
    v_cvt_pk_bf16_f32 v86, v168, v169
    v_cvt_pk_bf16_f32 v87, v170, v171
    ds_write_b16 v82, v84 offset:0
    ds_write_b16_d16_hi v82, v84 offset:272
    ds_write_b16 v82, v85 offset:544
    ds_write_b16_d16_hi v82, v85 offset:816
    ds_write_b16 v82, v86 offset:1088
    ds_write_b16_d16_hi v82, v86 offset:1360
    ds_write_b16 v82, v87 offset:1632
    ds_write_b16_d16_hi v82, v87 offset:1904
    v_cvt_pk_bf16_f32 v88, v140, v141
    v_cvt_pk_bf16_f32 v89, v142, v143
    v_cvt_pk_bf16_f32 v90, v172, v173
    v_cvt_pk_bf16_f32 v91, v174, v175
    ds_write_b16 v82, v88 offset:32
    ds_write_b16_d16_hi v82, v88 offset:304
    ds_write_b16 v82, v89 offset:576
    ds_write_b16_d16_hi v82, v89 offset:848
    ds_write_b16 v82, v90 offset:1120
    ds_write_b16_d16_hi v82, v90 offset:1392
    ds_write_b16 v82, v91 offset:1664
    ds_write_b16_d16_hi v82, v91 offset:1936
    v_cvt_pk_bf16_f32 v92, v144, v145
    v_cvt_pk_bf16_f32 v93, v146, v147
    v_cvt_pk_bf16_f32 v94, v176, v177
    v_cvt_pk_bf16_f32 v95, v178, v179
    ds_write_b16 v82, v92 offset:64
    ds_write_b16_d16_hi v82, v92 offset:336
    ds_write_b16 v82, v93 offset:608
    ds_write_b16_d16_hi v82, v93 offset:880
    ds_write_b16 v82, v94 offset:1152
    ds_write_b16_d16_hi v82, v94 offset:1424
    ds_write_b16 v82, v95 offset:1696
    ds_write_b16_d16_hi v82, v95 offset:1968
    v_cvt_pk_bf16_f32 v96, v148, v149
    v_cvt_pk_bf16_f32 v97, v150, v151
    v_cvt_pk_bf16_f32 v98, v180, v181
    v_cvt_pk_bf16_f32 v99, v182, v183
    ds_write_b16 v82, v96 offset:96
    ds_write_b16_d16_hi v82, v96 offset:368
    ds_write_b16 v82, v97 offset:640
    ds_write_b16_d16_hi v82, v97 offset:912
    ds_write_b16 v82, v98 offset:1184
    ds_write_b16_d16_hi v82, v98 offset:1456
    ds_write_b16 v82, v99 offset:1728
    ds_write_b16_d16_hi v82, v99 offset:2000
    v_cvt_pk_bf16_f32 v100, v152, v153
    v_cvt_pk_bf16_f32 v101, v154, v155
    v_cvt_pk_bf16_f32 v102, v184, v185
    v_cvt_pk_bf16_f32 v103, v186, v187
    ds_write_b16 v82, v100 offset:128
    ds_write_b16_d16_hi v82, v100 offset:400
    ds_write_b16 v82, v101 offset:672
    ds_write_b16_d16_hi v82, v101 offset:944
    ds_write_b16 v82, v102 offset:1216
    ds_write_b16_d16_hi v82, v102 offset:1488
    ds_write_b16 v82, v103 offset:1760
    ds_write_b16_d16_hi v82, v103 offset:2032
    v_cvt_pk_bf16_f32 v104, v156, v157
    v_cvt_pk_bf16_f32 v105, v158, v159
    v_cvt_pk_bf16_f32 v106, v188, v189
    v_cvt_pk_bf16_f32 v107, v190, v191
    ds_write_b16 v82, v104 offset:160
    ds_write_b16_d16_hi v82, v104 offset:432
    ds_write_b16 v82, v105 offset:704
    ds_write_b16_d16_hi v82, v105 offset:976
    ds_write_b16 v82, v106 offset:1248
    ds_write_b16_d16_hi v82, v106 offset:1520
    ds_write_b16 v82, v107 offset:1792
    ds_write_b16_d16_hi v82, v107 offset:2064
    v_cvt_pk_bf16_f32 v108, v160, v161
    v_cvt_pk_bf16_f32 v109, v162, v163
    v_cvt_pk_bf16_f32 v110, v192, v193
    v_cvt_pk_bf16_f32 v111, v194, v195
    ds_write_b16 v82, v108 offset:192
    ds_write_b16_d16_hi v82, v108 offset:464
    ds_write_b16 v82, v109 offset:736
    ds_write_b16_d16_hi v82, v109 offset:1008
    ds_write_b16 v82, v110 offset:1280
    ds_write_b16_d16_hi v82, v110 offset:1552
    ds_write_b16 v82, v111 offset:1824
    ds_write_b16_d16_hi v82, v111 offset:2096
    v_cvt_pk_bf16_f32 v112, v164, v165
    v_cvt_pk_bf16_f32 v113, v166, v167
    v_cvt_pk_bf16_f32 v114, v196, v197
    v_cvt_pk_bf16_f32 v115, v198, v199
    ds_write_b16 v82, v112 offset:224
    ds_write_b16_d16_hi v82, v112 offset:496
    ds_write_b16 v82, v113 offset:768
    ds_write_b16_d16_hi v82, v113 offset:1040
    ds_write_b16 v82, v114 offset:1312
    ds_write_b16_d16_hi v82, v114 offset:1584
    ds_write_b16 v82, v115 offset:1856
    ds_write_b16_d16_hi v82, v115 offset:2128
    s_waitcnt lgkmcnt(0)
    ds_read_b128 v[136:139], v126 offset:0
    s_mov_b32 s40, 0
    ds_read_b128 v[140:143], v126 offset:1088
    s_mov_b32 s41, 23040
    ds_read_b128 v[144:147], v126 offset:2208
    s_mov_b32 s42, 46080
    ds_read_b128 v[148:151], v126 offset:3296
    s_mov_b32 s43, 69120
    ds_read_b128 v[152:155], v126 offset:4416
    s_mov_b32 s44, 92160
    ds_read_b128 v[156:159], v126 offset:5504
    s_mov_b32 s45, 115200
    ds_read_b128 v[160:163], v126 offset:6624
    s_mov_b32 s46, 138240
    ds_read_b128 v[164:167], v126 offset:7712
    s_mov_b32 s47, 161280
    s_waitcnt lgkmcnt(0)
    buffer_store_dwordx4 v[136:139], v127, s[8:11], s40 offen sc1
    buffer_store_dwordx4 v[140:143], v127, s[8:11], s41 offen sc1
    buffer_store_dwordx4 v[144:147], v127, s[8:11], s42 offen sc1
    buffer_store_dwordx4 v[148:151], v127, s[8:11], s43 offen sc1
    buffer_store_dwordx4 v[152:155], v127, s[8:11], s44 offen sc1
    buffer_store_dwordx4 v[156:159], v127, s[8:11], s45 offen sc1
    buffer_store_dwordx4 v[160:163], v127, s[8:11], s46 offen sc1
    buffer_store_dwordx4 v[164:167], v127, s[8:11], s47 offen sc1
    s_waitcnt vmcnt(0)
    s_endpgm
k1_ffn:
    s_sub_u32 s30, s30, 10
    s_lshr_b32 s37, s32, 1
    s_lshl_b32 s37, s37, 13
    v_mov_b32 v28, s37
    v_lshrrev_b32 v5, 1, v3
    v_or_b32 v6, 0, v4
    v_xor_b32 v5, v5, v6
    v_lshlrev_b32 v5, 4, v5
    v_lshl_add_u32 v5, v3, 7, v5
    v_add_u32 v5, v5, v28
    v_add_u32 v10, 0, v5
    v_add_u32 v11, 49152, v5
    v_add_u32 v12, 98304, v5
    v_lshrrev_b32 v5, 1, v3
    v_or_b32 v6, 4, v4
    v_xor_b32 v5, v5, v6
    v_lshlrev_b32 v5, 4, v5
    v_lshl_add_u32 v5, v3, 7, v5
    v_add_u32 v5, v5, v28
    v_add_u32 v13, 0, v5
    v_add_u32 v14, 49152, v5
    v_add_u32 v15, 98304, v5
    v_lshrrev_b32 v5, 2, v3
    v_and_b32 v6, 3, v3
    v_lshlrev_b32 v7, 12, v4
    v_lshl_add_u32 v7, v5, 7, v7
    v_lshl_add_u32 v7, v6, 3, v7
    v_lshrrev_b32 v8, 1, v5
    v_and_b32 v9, 1, v4
    v_lshl_or_b32 v8, v9, 1, v8
    s_and_b32 s37, s32, 1
    s_lshl_b32 s37, s37, 11
    s_add_u32 s37, s37, 16384
    v_add_u32 v7, s37, v7
    v_xor_b32 v5, 0, v8
    v_lshl_add_u32 v5, v5, 5, v7
    v_add_u32 v16, 0, v5
    v_add_u32 v17, 49152, v5
    v_add_u32 v18, 98304, v5
    v_xor_b32 v5, 1, v8
    v_lshl_add_u32 v5, v5, 5, v7
    v_add_u32 v19, 0, v5
    v_add_u32 v20, 49152, v5
    v_add_u32 v21, 98304, v5
    v_xor_b32 v5, 2, v8
    v_lshl_add_u32 v5, v5, 5, v7
    v_add_u32 v22, 0, v5
    v_add_u32 v23, 49152, v5
    v_add_u32 v24, 98304, v5
    v_xor_b32 v5, 3, v8
    v_lshl_add_u32 v5, v5, 5, v7
    v_add_u32 v25, 0, v5
    v_add_u32 v26, 49152, v5
    v_add_u32 v27, 98304, v5
    s_barrier
    ds_read_b128 v[28:31], v10 offset:0
    ds_read_b128 v[32:35], v10 offset:2048
    ds_read_b128 v[36:39], v10 offset:4096
    ds_read_b128 v[40:43], v10 offset:6144
    ds_read_b64_tr_b16 v[44:45], v16 offset:0
    ds_read_b64_tr_b16 v[46:47], v16 offset:512
    ds_read_b64_tr_b16 v[48:49], v19 offset:0
    ds_read_b64_tr_b16 v[50:51], v19 offset:512
    ds_read_b64_tr_b16 v[52:53], v22 offset:0
    ds_read_b64_tr_b16 v[54:55], v22 offset:512
    ds_read_b64_tr_b16 v[56:57], v25 offset:0
    ds_read_b64_tr_b16 v[58:59], v25 offset:512
    ds_read_b64_tr_b16 v[60:61], v16 offset:1024
    ds_read_b64_tr_b16 v[62:63], v16 offset:1536
    ds_read_b64_tr_b16 v[64:65], v19 offset:1024
    ds_read_b64_tr_b16 v[66:67], v19 offset:1536
    ds_read_b64_tr_b16 v[68:69], v22 offset:1024
    ds_read_b64_tr_b16 v[70:71], v22 offset:1536
    ds_read_b64_tr_b16 v[72:73], v25 offset:1024
    ds_read_b64_tr_b16 v[74:75], v25 offset:1536
    s_waitcnt lgkmcnt(0)
    v_mfma_f32_16x16x32_bf16 v[124:127], v[44:47], v[28:31], 0
    ds_read_b128 v[76:79], v13 offset:0
    v_mfma_f32_16x16x32_bf16 v[128:131], v[48:51], v[28:31], 0
    ds_read_b128 v[80:83], v13 offset:2048
    v_mfma_f32_16x16x32_bf16 v[132:135], v[52:55], v[28:31], 0
    ds_read_b128 v[84:87], v13 offset:4096
    v_mfma_f32_16x16x32_bf16 v[136:139], v[56:59], v[28:31], 0
    ds_read_b128 v[88:91], v13 offset:6144
    v_mfma_f32_16x16x32_bf16 v[140:143], v[60:63], v[28:31], 0
    ds_read_b64_tr_b16 v[92:93], v16 offset:16384
    v_mfma_f32_16x16x32_bf16 v[144:147], v[64:67], v[28:31], 0
    ds_read_b64_tr_b16 v[94:95], v16 offset:16896
    v_mfma_f32_16x16x32_bf16 v[148:151], v[68:71], v[28:31], 0
    ds_read_b64_tr_b16 v[96:97], v19 offset:16384
    v_mfma_f32_16x16x32_bf16 v[152:155], v[72:75], v[28:31], 0
    ds_read_b64_tr_b16 v[98:99], v19 offset:16896
    v_mfma_f32_16x16x32_bf16 v[156:159], v[44:47], v[32:35], 0
    ds_read_b64_tr_b16 v[100:101], v22 offset:16384
    v_mfma_f32_16x16x32_bf16 v[160:163], v[48:51], v[32:35], 0
    ds_read_b64_tr_b16 v[102:103], v22 offset:16896
    v_mfma_f32_16x16x32_bf16 v[164:167], v[52:55], v[32:35], 0
    ds_read_b64_tr_b16 v[104:105], v25 offset:16384
    v_mfma_f32_16x16x32_bf16 v[168:171], v[56:59], v[32:35], 0
    ds_read_b64_tr_b16 v[106:107], v25 offset:16896
    v_mfma_f32_16x16x32_bf16 v[172:175], v[60:63], v[32:35], 0
    ds_read_b64_tr_b16 v[108:109], v16 offset:17408
    v_mfma_f32_16x16x32_bf16 v[176:179], v[64:67], v[32:35], 0
    ds_read_b64_tr_b16 v[110:111], v16 offset:17920
    v_mfma_f32_16x16x32_bf16 v[180:183], v[68:71], v[32:35], 0
    ds_read_b64_tr_b16 v[112:113], v19 offset:17408
    v_mfma_f32_16x16x32_bf16 v[184:187], v[72:75], v[32:35], 0
    ds_read_b64_tr_b16 v[114:115], v19 offset:17920
    v_mfma_f32_16x16x32_bf16 v[188:191], v[44:47], v[36:39], 0
    ds_read_b64_tr_b16 v[116:117], v22 offset:17408
    v_mfma_f32_16x16x32_bf16 v[192:195], v[48:51], v[36:39], 0
    ds_read_b64_tr_b16 v[118:119], v22 offset:17920
    v_mfma_f32_16x16x32_bf16 v[196:199], v[52:55], v[36:39], 0
    ds_read_b64_tr_b16 v[120:121], v25 offset:17408
    v_mfma_f32_16x16x32_bf16 v[200:203], v[56:59], v[36:39], 0
    ds_read_b64_tr_b16 v[122:123], v25 offset:17920
    v_mfma_f32_16x16x32_bf16 v[204:207], v[60:63], v[36:39], 0
    v_mfma_f32_16x16x32_bf16 v[208:211], v[64:67], v[36:39], 0
    v_mfma_f32_16x16x32_bf16 v[212:215], v[68:71], v[36:39], 0
    v_mfma_f32_16x16x32_bf16 v[216:219], v[72:75], v[36:39], 0
    v_mfma_f32_16x16x32_bf16 v[220:223], v[44:47], v[40:43], 0
    v_mfma_f32_16x16x32_bf16 v[224:227], v[48:51], v[40:43], 0
    v_mfma_f32_16x16x32_bf16 v[228:231], v[52:55], v[40:43], 0
    v_mfma_f32_16x16x32_bf16 v[232:235], v[56:59], v[40:43], 0
    v_mfma_f32_16x16x32_bf16 v[236:239], v[60:63], v[40:43], 0
    v_mfma_f32_16x16x32_bf16 v[240:243], v[64:67], v[40:43], 0
    v_mfma_f32_16x16x32_bf16 v[244:247], v[68:71], v[40:43], 0
    v_mfma_f32_16x16x32_bf16 v[248:251], v[72:75], v[40:43], 0
    s_waitcnt lgkmcnt(0)
    s_barrier
    v_mfma_f32_16x16x32_bf16 v[124:127], v[92:95], v[76:79], v[124:127]
    ds_read_b128 v[28:31], v11 offset:0
    v_mfma_f32_16x16x32_bf16 v[128:131], v[96:99], v[76:79], v[128:131]
    ds_read_b128 v[32:35], v11 offset:2048
    v_mfma_f32_16x16x32_bf16 v[132:135], v[100:103], v[76:79], v[132:135]
    ds_read_b128 v[36:39], v11 offset:4096
    v_mfma_f32_16x16x32_bf16 v[136:139], v[104:107], v[76:79], v[136:139]
    ds_read_b128 v[40:43], v11 offset:6144
    v_mfma_f32_16x16x32_bf16 v[140:143], v[108:111], v[76:79], v[140:143]
    ds_read_b64_tr_b16 v[44:45], v17 offset:0
    v_mfma_f32_16x16x32_bf16 v[144:147], v[112:115], v[76:79], v[144:147]
    ds_read_b64_tr_b16 v[46:47], v17 offset:512
    v_mfma_f32_16x16x32_bf16 v[148:151], v[116:119], v[76:79], v[148:151]
    ds_read_b64_tr_b16 v[48:49], v20 offset:0
    v_mfma_f32_16x16x32_bf16 v[152:155], v[120:123], v[76:79], v[152:155]
    ds_read_b64_tr_b16 v[50:51], v20 offset:512
    v_mfma_f32_16x16x32_bf16 v[156:159], v[92:95], v[80:83], v[156:159]
    ds_read_b64_tr_b16 v[52:53], v23 offset:0
    v_mfma_f32_16x16x32_bf16 v[160:163], v[96:99], v[80:83], v[160:163]
    ds_read_b64_tr_b16 v[54:55], v23 offset:512
    v_mfma_f32_16x16x32_bf16 v[164:167], v[100:103], v[80:83], v[164:167]
    ds_read_b64_tr_b16 v[56:57], v26 offset:0
    v_mfma_f32_16x16x32_bf16 v[168:171], v[104:107], v[80:83], v[168:171]
    ds_read_b64_tr_b16 v[58:59], v26 offset:512
    v_mfma_f32_16x16x32_bf16 v[172:175], v[108:111], v[80:83], v[172:175]
    ds_read_b64_tr_b16 v[60:61], v17 offset:1024
    v_mfma_f32_16x16x32_bf16 v[176:179], v[112:115], v[80:83], v[176:179]
    ds_read_b64_tr_b16 v[62:63], v17 offset:1536
    v_mfma_f32_16x16x32_bf16 v[180:183], v[116:119], v[80:83], v[180:183]
    ds_read_b64_tr_b16 v[64:65], v20 offset:1024
    v_mfma_f32_16x16x32_bf16 v[184:187], v[120:123], v[80:83], v[184:187]
    ds_read_b64_tr_b16 v[66:67], v20 offset:1536
    v_mfma_f32_16x16x32_bf16 v[188:191], v[92:95], v[84:87], v[188:191]
    ds_read_b64_tr_b16 v[68:69], v23 offset:1024
    v_mfma_f32_16x16x32_bf16 v[192:195], v[96:99], v[84:87], v[192:195]
    ds_read_b64_tr_b16 v[70:71], v23 offset:1536
    v_mfma_f32_16x16x32_bf16 v[196:199], v[100:103], v[84:87], v[196:199]
    ds_read_b64_tr_b16 v[72:73], v26 offset:1024
    v_mfma_f32_16x16x32_bf16 v[200:203], v[104:107], v[84:87], v[200:203]
    ds_read_b64_tr_b16 v[74:75], v26 offset:1536
    v_mfma_f32_16x16x32_bf16 v[204:207], v[108:111], v[84:87], v[204:207]
    v_mfma_f32_16x16x32_bf16 v[208:211], v[112:115], v[84:87], v[208:211]
    v_mfma_f32_16x16x32_bf16 v[212:215], v[116:119], v[84:87], v[212:215]
    v_mfma_f32_16x16x32_bf16 v[216:219], v[120:123], v[84:87], v[216:219]
    v_mfma_f32_16x16x32_bf16 v[220:223], v[92:95], v[88:91], v[220:223]
    v_mfma_f32_16x16x32_bf16 v[224:227], v[96:99], v[88:91], v[224:227]
    v_mfma_f32_16x16x32_bf16 v[228:231], v[100:103], v[88:91], v[228:231]
    v_mfma_f32_16x16x32_bf16 v[232:235], v[104:107], v[88:91], v[232:235]
    v_mfma_f32_16x16x32_bf16 v[236:239], v[108:111], v[88:91], v[236:239]
    v_mfma_f32_16x16x32_bf16 v[240:243], v[112:115], v[88:91], v[240:243]
    v_mfma_f32_16x16x32_bf16 v[244:247], v[116:119], v[88:91], v[244:247]
    v_mfma_f32_16x16x32_bf16 v[248:251], v[120:123], v[88:91], v[248:251]
    s_waitcnt lgkmcnt(0)
    v_mfma_f32_16x16x32_bf16 v[124:127], v[44:47], v[28:31], v[124:127]
    ds_read_b128 v[76:79], v14 offset:0
    v_mfma_f32_16x16x32_bf16 v[128:131], v[48:51], v[28:31], v[128:131]
    ds_read_b128 v[80:83], v14 offset:2048
    v_mfma_f32_16x16x32_bf16 v[132:135], v[52:55], v[28:31], v[132:135]
    ds_read_b128 v[84:87], v14 offset:4096
    v_mfma_f32_16x16x32_bf16 v[136:139], v[56:59], v[28:31], v[136:139]
    ds_read_b128 v[88:91], v14 offset:6144
    v_mfma_f32_16x16x32_bf16 v[140:143], v[60:63], v[28:31], v[140:143]
    ds_read_b64_tr_b16 v[92:93], v17 offset:16384
    v_mfma_f32_16x16x32_bf16 v[144:147], v[64:67], v[28:31], v[144:147]
    ds_read_b64_tr_b16 v[94:95], v17 offset:16896
    v_mfma_f32_16x16x32_bf16 v[148:151], v[68:71], v[28:31], v[148:151]
    ds_read_b64_tr_b16 v[96:97], v20 offset:16384
    v_mfma_f32_16x16x32_bf16 v[152:155], v[72:75], v[28:31], v[152:155]
    ds_read_b64_tr_b16 v[98:99], v20 offset:16896
    v_mfma_f32_16x16x32_bf16 v[156:159], v[44:47], v[32:35], v[156:159]
    ds_read_b64_tr_b16 v[100:101], v23 offset:16384
    v_mfma_f32_16x16x32_bf16 v[160:163], v[48:51], v[32:35], v[160:163]
    ds_read_b64_tr_b16 v[102:103], v23 offset:16896
    v_mfma_f32_16x16x32_bf16 v[164:167], v[52:55], v[32:35], v[164:167]
    ds_read_b64_tr_b16 v[104:105], v26 offset:16384
    v_mfma_f32_16x16x32_bf16 v[168:171], v[56:59], v[32:35], v[168:171]
    ds_read_b64_tr_b16 v[106:107], v26 offset:16896
    v_mfma_f32_16x16x32_bf16 v[172:175], v[60:63], v[32:35], v[172:175]
    ds_read_b64_tr_b16 v[108:109], v17 offset:17408
    v_mfma_f32_16x16x32_bf16 v[176:179], v[64:67], v[32:35], v[176:179]
    ds_read_b64_tr_b16 v[110:111], v17 offset:17920
    v_mfma_f32_16x16x32_bf16 v[180:183], v[68:71], v[32:35], v[180:183]
    ds_read_b64_tr_b16 v[112:113], v20 offset:17408
    v_mfma_f32_16x16x32_bf16 v[184:187], v[72:75], v[32:35], v[184:187]
    ds_read_b64_tr_b16 v[114:115], v20 offset:17920
    v_mfma_f32_16x16x32_bf16 v[188:191], v[44:47], v[36:39], v[188:191]
    ds_read_b64_tr_b16 v[116:117], v23 offset:17408
    v_mfma_f32_16x16x32_bf16 v[192:195], v[48:51], v[36:39], v[192:195]
    ds_read_b64_tr_b16 v[118:119], v23 offset:17920
    v_mfma_f32_16x16x32_bf16 v[196:199], v[52:55], v[36:39], v[196:199]
    ds_read_b64_tr_b16 v[120:121], v26 offset:17408
    v_mfma_f32_16x16x32_bf16 v[200:203], v[56:59], v[36:39], v[200:203]
    ds_read_b64_tr_b16 v[122:123], v26 offset:17920
    v_mfma_f32_16x16x32_bf16 v[204:207], v[60:63], v[36:39], v[204:207]
    v_mfma_f32_16x16x32_bf16 v[208:211], v[64:67], v[36:39], v[208:211]
    v_mfma_f32_16x16x32_bf16 v[212:215], v[68:71], v[36:39], v[212:215]
    v_mfma_f32_16x16x32_bf16 v[216:219], v[72:75], v[36:39], v[216:219]
    v_mfma_f32_16x16x32_bf16 v[220:223], v[44:47], v[40:43], v[220:223]
    v_mfma_f32_16x16x32_bf16 v[224:227], v[48:51], v[40:43], v[224:227]
    v_mfma_f32_16x16x32_bf16 v[228:231], v[52:55], v[40:43], v[228:231]
    v_mfma_f32_16x16x32_bf16 v[232:235], v[56:59], v[40:43], v[232:235]
    v_mfma_f32_16x16x32_bf16 v[236:239], v[60:63], v[40:43], v[236:239]
    v_mfma_f32_16x16x32_bf16 v[240:243], v[64:67], v[40:43], v[240:243]
    v_mfma_f32_16x16x32_bf16 v[244:247], v[68:71], v[40:43], v[244:247]
    v_mfma_f32_16x16x32_bf16 v[248:251], v[72:75], v[40:43], v[248:251]
    s_waitcnt lgkmcnt(0)
    s_barrier
    v_mfma_f32_16x16x32_bf16 v[124:127], v[92:95], v[76:79], v[124:127]
    ds_read_b128 v[28:31], v12 offset:0
    v_mfma_f32_16x16x32_bf16 v[128:131], v[96:99], v[76:79], v[128:131]
    ds_read_b128 v[32:35], v12 offset:2048
    v_mfma_f32_16x16x32_bf16 v[132:135], v[100:103], v[76:79], v[132:135]
    ds_read_b128 v[36:39], v12 offset:4096
    v_mfma_f32_16x16x32_bf16 v[136:139], v[104:107], v[76:79], v[136:139]
    ds_read_b128 v[40:43], v12 offset:6144
    v_mfma_f32_16x16x32_bf16 v[140:143], v[108:111], v[76:79], v[140:143]
    ds_read_b64_tr_b16 v[44:45], v18 offset:0
    v_mfma_f32_16x16x32_bf16 v[144:147], v[112:115], v[76:79], v[144:147]
    ds_read_b64_tr_b16 v[46:47], v18 offset:512
    v_mfma_f32_16x16x32_bf16 v[148:151], v[116:119], v[76:79], v[148:151]
    ds_read_b64_tr_b16 v[48:49], v21 offset:0
    v_mfma_f32_16x16x32_bf16 v[152:155], v[120:123], v[76:79], v[152:155]
    ds_read_b64_tr_b16 v[50:51], v21 offset:512
    v_mfma_f32_16x16x32_bf16 v[156:159], v[92:95], v[80:83], v[156:159]
    ds_read_b64_tr_b16 v[52:53], v24 offset:0
    v_mfma_f32_16x16x32_bf16 v[160:163], v[96:99], v[80:83], v[160:163]
    ds_read_b64_tr_b16 v[54:55], v24 offset:512
    v_mfma_f32_16x16x32_bf16 v[164:167], v[100:103], v[80:83], v[164:167]
    ds_read_b64_tr_b16 v[56:57], v27 offset:0
    v_mfma_f32_16x16x32_bf16 v[168:171], v[104:107], v[80:83], v[168:171]
    ds_read_b64_tr_b16 v[58:59], v27 offset:512
    v_mfma_f32_16x16x32_bf16 v[172:175], v[108:111], v[80:83], v[172:175]
    ds_read_b64_tr_b16 v[60:61], v18 offset:1024
    v_mfma_f32_16x16x32_bf16 v[176:179], v[112:115], v[80:83], v[176:179]
    ds_read_b64_tr_b16 v[62:63], v18 offset:1536
    v_mfma_f32_16x16x32_bf16 v[180:183], v[116:119], v[80:83], v[180:183]
    ds_read_b64_tr_b16 v[64:65], v21 offset:1024
    v_mfma_f32_16x16x32_bf16 v[184:187], v[120:123], v[80:83], v[184:187]
    ds_read_b64_tr_b16 v[66:67], v21 offset:1536
    v_mfma_f32_16x16x32_bf16 v[188:191], v[92:95], v[84:87], v[188:191]
    ds_read_b64_tr_b16 v[68:69], v24 offset:1024
    v_mfma_f32_16x16x32_bf16 v[192:195], v[96:99], v[84:87], v[192:195]
    ds_read_b64_tr_b16 v[70:71], v24 offset:1536
    v_mfma_f32_16x16x32_bf16 v[196:199], v[100:103], v[84:87], v[196:199]
    ds_read_b64_tr_b16 v[72:73], v27 offset:1024
    v_mfma_f32_16x16x32_bf16 v[200:203], v[104:107], v[84:87], v[200:203]
    ds_read_b64_tr_b16 v[74:75], v27 offset:1536
    v_mfma_f32_16x16x32_bf16 v[204:207], v[108:111], v[84:87], v[204:207]
    v_mfma_f32_16x16x32_bf16 v[208:211], v[112:115], v[84:87], v[208:211]
    v_mfma_f32_16x16x32_bf16 v[212:215], v[116:119], v[84:87], v[212:215]
    v_mfma_f32_16x16x32_bf16 v[216:219], v[120:123], v[84:87], v[216:219]
    v_mfma_f32_16x16x32_bf16 v[220:223], v[92:95], v[88:91], v[220:223]
    v_mfma_f32_16x16x32_bf16 v[224:227], v[96:99], v[88:91], v[224:227]
    v_mfma_f32_16x16x32_bf16 v[228:231], v[100:103], v[88:91], v[228:231]
    v_mfma_f32_16x16x32_bf16 v[232:235], v[104:107], v[88:91], v[232:235]
    v_mfma_f32_16x16x32_bf16 v[236:239], v[108:111], v[88:91], v[236:239]
    v_mfma_f32_16x16x32_bf16 v[240:243], v[112:115], v[88:91], v[240:243]
    v_mfma_f32_16x16x32_bf16 v[244:247], v[116:119], v[88:91], v[244:247]
    v_mfma_f32_16x16x32_bf16 v[248:251], v[120:123], v[88:91], v[248:251]
    s_waitcnt lgkmcnt(0)
    v_mfma_f32_16x16x32_bf16 v[124:127], v[44:47], v[28:31], v[124:127]
    ds_read_b128 v[76:79], v15 offset:0
    v_mfma_f32_16x16x32_bf16 v[128:131], v[48:51], v[28:31], v[128:131]
    ds_read_b128 v[80:83], v15 offset:2048
    v_mfma_f32_16x16x32_bf16 v[132:135], v[52:55], v[28:31], v[132:135]
    ds_read_b128 v[84:87], v15 offset:4096
    v_mfma_f32_16x16x32_bf16 v[136:139], v[56:59], v[28:31], v[136:139]
    ds_read_b128 v[88:91], v15 offset:6144
    v_mfma_f32_16x16x32_bf16 v[140:143], v[60:63], v[28:31], v[140:143]
    ds_read_b64_tr_b16 v[92:93], v18 offset:16384
    v_mfma_f32_16x16x32_bf16 v[144:147], v[64:67], v[28:31], v[144:147]
    ds_read_b64_tr_b16 v[94:95], v18 offset:16896
    v_mfma_f32_16x16x32_bf16 v[148:151], v[68:71], v[28:31], v[148:151]
    ds_read_b64_tr_b16 v[96:97], v21 offset:16384
    v_mfma_f32_16x16x32_bf16 v[152:155], v[72:75], v[28:31], v[152:155]
    ds_read_b64_tr_b16 v[98:99], v21 offset:16896
    v_mfma_f32_16x16x32_bf16 v[156:159], v[44:47], v[32:35], v[156:159]
    ds_read_b64_tr_b16 v[100:101], v24 offset:16384
    v_mfma_f32_16x16x32_bf16 v[160:163], v[48:51], v[32:35], v[160:163]
    ds_read_b64_tr_b16 v[102:103], v24 offset:16896
    v_mfma_f32_16x16x32_bf16 v[164:167], v[52:55], v[32:35], v[164:167]
    ds_read_b64_tr_b16 v[104:105], v27 offset:16384
    v_mfma_f32_16x16x32_bf16 v[168:171], v[56:59], v[32:35], v[168:171]
    ds_read_b64_tr_b16 v[106:107], v27 offset:16896
    v_mfma_f32_16x16x32_bf16 v[172:175], v[60:63], v[32:35], v[172:175]
    ds_read_b64_tr_b16 v[108:109], v18 offset:17408
    v_mfma_f32_16x16x32_bf16 v[176:179], v[64:67], v[32:35], v[176:179]
    ds_read_b64_tr_b16 v[110:111], v18 offset:17920
    v_mfma_f32_16x16x32_bf16 v[180:183], v[68:71], v[32:35], v[180:183]
    ds_read_b64_tr_b16 v[112:113], v21 offset:17408
    v_mfma_f32_16x16x32_bf16 v[184:187], v[72:75], v[32:35], v[184:187]
    ds_read_b64_tr_b16 v[114:115], v21 offset:17920
    v_mfma_f32_16x16x32_bf16 v[188:191], v[44:47], v[36:39], v[188:191]
    ds_read_b64_tr_b16 v[116:117], v24 offset:17408
    v_mfma_f32_16x16x32_bf16 v[192:195], v[48:51], v[36:39], v[192:195]
    ds_read_b64_tr_b16 v[118:119], v24 offset:17920
    v_mfma_f32_16x16x32_bf16 v[196:199], v[52:55], v[36:39], v[196:199]
    ds_read_b64_tr_b16 v[120:121], v27 offset:17408
    v_mfma_f32_16x16x32_bf16 v[200:203], v[56:59], v[36:39], v[200:203]
    ds_read_b64_tr_b16 v[122:123], v27 offset:17920
    v_mfma_f32_16x16x32_bf16 v[204:207], v[60:63], v[36:39], v[204:207]
    v_mfma_f32_16x16x32_bf16 v[208:211], v[64:67], v[36:39], v[208:211]
    v_mfma_f32_16x16x32_bf16 v[212:215], v[68:71], v[36:39], v[212:215]
    v_mfma_f32_16x16x32_bf16 v[216:219], v[72:75], v[36:39], v[216:219]
    v_mfma_f32_16x16x32_bf16 v[220:223], v[44:47], v[40:43], v[220:223]
    v_mfma_f32_16x16x32_bf16 v[224:227], v[48:51], v[40:43], v[224:227]
    v_mfma_f32_16x16x32_bf16 v[228:231], v[52:55], v[40:43], v[228:231]
    v_mfma_f32_16x16x32_bf16 v[232:235], v[56:59], v[40:43], v[232:235]
    v_mfma_f32_16x16x32_bf16 v[236:239], v[60:63], v[40:43], v[236:239]
    v_mfma_f32_16x16x32_bf16 v[240:243], v[64:67], v[40:43], v[240:243]
    v_mfma_f32_16x16x32_bf16 v[244:247], v[68:71], v[40:43], v[244:247]
    v_mfma_f32_16x16x32_bf16 v[248:251], v[72:75], v[40:43], v[248:251]
    s_waitcnt lgkmcnt(0)
    s_barrier
    v_mfma_f32_16x16x32_bf16 v[124:127], v[92:95], v[76:79], v[124:127]
    ds_read_b128 v[28:31], v10 offset:0
    v_mfma_f32_16x16x32_bf16 v[128:131], v[96:99], v[76:79], v[128:131]
    ds_read_b128 v[32:35], v10 offset:2048
    v_mfma_f32_16x16x32_bf16 v[132:135], v[100:103], v[76:79], v[132:135]
    ds_read_b128 v[36:39], v10 offset:4096
    v_mfma_f32_16x16x32_bf16 v[136:139], v[104:107], v[76:79], v[136:139]
    ds_read_b128 v[40:43], v10 offset:6144
    v_mfma_f32_16x16x32_bf16 v[140:143], v[108:111], v[76:79], v[140:143]
    ds_read_b64_tr_b16 v[44:45], v16 offset:0
    v_mfma_f32_16x16x32_bf16 v[144:147], v[112:115], v[76:79], v[144:147]
    ds_read_b64_tr_b16 v[46:47], v16 offset:512
    v_mfma_f32_16x16x32_bf16 v[148:151], v[116:119], v[76:79], v[148:151]
    ds_read_b64_tr_b16 v[48:49], v19 offset:0
    v_mfma_f32_16x16x32_bf16 v[152:155], v[120:123], v[76:79], v[152:155]
    ds_read_b64_tr_b16 v[50:51], v19 offset:512
    v_mfma_f32_16x16x32_bf16 v[156:159], v[92:95], v[80:83], v[156:159]
    ds_read_b64_tr_b16 v[52:53], v22 offset:0
    v_mfma_f32_16x16x32_bf16 v[160:163], v[96:99], v[80:83], v[160:163]
    ds_read_b64_tr_b16 v[54:55], v22 offset:512
    v_mfma_f32_16x16x32_bf16 v[164:167], v[100:103], v[80:83], v[164:167]
    ds_read_b64_tr_b16 v[56:57], v25 offset:0
    v_mfma_f32_16x16x32_bf16 v[168:171], v[104:107], v[80:83], v[168:171]
    ds_read_b64_tr_b16 v[58:59], v25 offset:512
    v_mfma_f32_16x16x32_bf16 v[172:175], v[108:111], v[80:83], v[172:175]
    ds_read_b64_tr_b16 v[60:61], v16 offset:1024
    v_mfma_f32_16x16x32_bf16 v[176:179], v[112:115], v[80:83], v[176:179]
    ds_read_b64_tr_b16 v[62:63], v16 offset:1536
    v_mfma_f32_16x16x32_bf16 v[180:183], v[116:119], v[80:83], v[180:183]
    ds_read_b64_tr_b16 v[64:65], v19 offset:1024
    v_mfma_f32_16x16x32_bf16 v[184:187], v[120:123], v[80:83], v[184:187]
    ds_read_b64_tr_b16 v[66:67], v19 offset:1536
    v_mfma_f32_16x16x32_bf16 v[188:191], v[92:95], v[84:87], v[188:191]
    ds_read_b64_tr_b16 v[68:69], v22 offset:1024
    v_mfma_f32_16x16x32_bf16 v[192:195], v[96:99], v[84:87], v[192:195]
    ds_read_b64_tr_b16 v[70:71], v22 offset:1536
    v_mfma_f32_16x16x32_bf16 v[196:199], v[100:103], v[84:87], v[196:199]
    ds_read_b64_tr_b16 v[72:73], v25 offset:1024
    v_mfma_f32_16x16x32_bf16 v[200:203], v[104:107], v[84:87], v[200:203]
    ds_read_b64_tr_b16 v[74:75], v25 offset:1536
    v_mfma_f32_16x16x32_bf16 v[204:207], v[108:111], v[84:87], v[204:207]
    v_mfma_f32_16x16x32_bf16 v[208:211], v[112:115], v[84:87], v[208:211]
    v_mfma_f32_16x16x32_bf16 v[212:215], v[116:119], v[84:87], v[212:215]
    v_mfma_f32_16x16x32_bf16 v[216:219], v[120:123], v[84:87], v[216:219]
    v_mfma_f32_16x16x32_bf16 v[220:223], v[92:95], v[88:91], v[220:223]
    v_mfma_f32_16x16x32_bf16 v[224:227], v[96:99], v[88:91], v[224:227]
    v_mfma_f32_16x16x32_bf16 v[228:231], v[100:103], v[88:91], v[228:231]
    v_mfma_f32_16x16x32_bf16 v[232:235], v[104:107], v[88:91], v[232:235]
    v_mfma_f32_16x16x32_bf16 v[236:239], v[108:111], v[88:91], v[236:239]
    v_mfma_f32_16x16x32_bf16 v[240:243], v[112:115], v[88:91], v[240:243]
    v_mfma_f32_16x16x32_bf16 v[244:247], v[116:119], v[88:91], v[244:247]
    v_mfma_f32_16x16x32_bf16 v[248:251], v[120:123], v[88:91], v[248:251]
    s_waitcnt lgkmcnt(0)
    v_mfma_f32_16x16x32_bf16 v[124:127], v[44:47], v[28:31], v[124:127]
    ds_read_b128 v[76:79], v13 offset:0
    v_mfma_f32_16x16x32_bf16 v[128:131], v[48:51], v[28:31], v[128:131]
    ds_read_b128 v[80:83], v13 offset:2048
    v_mfma_f32_16x16x32_bf16 v[132:135], v[52:55], v[28:31], v[132:135]
    ds_read_b128 v[84:87], v13 offset:4096
    v_mfma_f32_16x16x32_bf16 v[136:139], v[56:59], v[28:31], v[136:139]
    ds_read_b128 v[88:91], v13 offset:6144
    v_mfma_f32_16x16x32_bf16 v[140:143], v[60:63], v[28:31], v[140:143]
    ds_read_b64_tr_b16 v[92:93], v16 offset:16384
    v_mfma_f32_16x16x32_bf16 v[144:147], v[64:67], v[28:31], v[144:147]
    ds_read_b64_tr_b16 v[94:95], v16 offset:16896
    v_mfma_f32_16x16x32_bf16 v[148:151], v[68:71], v[28:31], v[148:151]
    ds_read_b64_tr_b16 v[96:97], v19 offset:16384
    v_mfma_f32_16x16x32_bf16 v[152:155], v[72:75], v[28:31], v[152:155]
    ds_read_b64_tr_b16 v[98:99], v19 offset:16896
    v_mfma_f32_16x16x32_bf16 v[156:159], v[44:47], v[32:35], v[156:159]
    ds_read_b64_tr_b16 v[100:101], v22 offset:16384
    v_mfma_f32_16x16x32_bf16 v[160:163], v[48:51], v[32:35], v[160:163]
    ds_read_b64_tr_b16 v[102:103], v22 offset:16896
    v_mfma_f32_16x16x32_bf16 v[164:167], v[52:55], v[32:35], v[164:167]
    ds_read_b64_tr_b16 v[104:105], v25 offset:16384
    v_mfma_f32_16x16x32_bf16 v[168:171], v[56:59], v[32:35], v[168:171]
    ds_read_b64_tr_b16 v[106:107], v25 offset:16896
    v_mfma_f32_16x16x32_bf16 v[172:175], v[60:63], v[32:35], v[172:175]
    ds_read_b64_tr_b16 v[108:109], v16 offset:17408
    v_mfma_f32_16x16x32_bf16 v[176:179], v[64:67], v[32:35], v[176:179]
    ds_read_b64_tr_b16 v[110:111], v16 offset:17920
    v_mfma_f32_16x16x32_bf16 v[180:183], v[68:71], v[32:35], v[180:183]
    ds_read_b64_tr_b16 v[112:113], v19 offset:17408
    v_mfma_f32_16x16x32_bf16 v[184:187], v[72:75], v[32:35], v[184:187]
    ds_read_b64_tr_b16 v[114:115], v19 offset:17920
    v_mfma_f32_16x16x32_bf16 v[188:191], v[44:47], v[36:39], v[188:191]
    ds_read_b64_tr_b16 v[116:117], v22 offset:17408
    v_mfma_f32_16x16x32_bf16 v[192:195], v[48:51], v[36:39], v[192:195]
    ds_read_b64_tr_b16 v[118:119], v22 offset:17920
    v_mfma_f32_16x16x32_bf16 v[196:199], v[52:55], v[36:39], v[196:199]
    ds_read_b64_tr_b16 v[120:121], v25 offset:17408
    v_mfma_f32_16x16x32_bf16 v[200:203], v[56:59], v[36:39], v[200:203]
    ds_read_b64_tr_b16 v[122:123], v25 offset:17920
    v_mfma_f32_16x16x32_bf16 v[204:207], v[60:63], v[36:39], v[204:207]
    v_mfma_f32_16x16x32_bf16 v[208:211], v[64:67], v[36:39], v[208:211]
    v_mfma_f32_16x16x32_bf16 v[212:215], v[68:71], v[36:39], v[212:215]
    v_mfma_f32_16x16x32_bf16 v[216:219], v[72:75], v[36:39], v[216:219]
    v_mfma_f32_16x16x32_bf16 v[220:223], v[44:47], v[40:43], v[220:223]
    v_mfma_f32_16x16x32_bf16 v[224:227], v[48:51], v[40:43], v[224:227]
    v_mfma_f32_16x16x32_bf16 v[228:231], v[52:55], v[40:43], v[228:231]
    v_mfma_f32_16x16x32_bf16 v[232:235], v[56:59], v[40:43], v[232:235]
    v_mfma_f32_16x16x32_bf16 v[236:239], v[60:63], v[40:43], v[236:239]
    v_mfma_f32_16x16x32_bf16 v[240:243], v[64:67], v[40:43], v[240:243]
    v_mfma_f32_16x16x32_bf16 v[244:247], v[68:71], v[40:43], v[244:247]
    v_mfma_f32_16x16x32_bf16 v[248:251], v[72:75], v[40:43], v[248:251]
    s_waitcnt lgkmcnt(0)
    s_barrier
    v_mfma_f32_16x16x32_bf16 v[124:127], v[92:95], v[76:79], v[124:127]
    ds_read_b128 v[28:31], v11 offset:0
    v_mfma_f32_16x16x32_bf16 v[128:131], v[96:99], v[76:79], v[128:131]
    ds_read_b128 v[32:35], v11 offset:2048
    v_mfma_f32_16x16x32_bf16 v[132:135], v[100:103], v[76:79], v[132:135]
    ds_read_b128 v[36:39], v11 offset:4096
    v_mfma_f32_16x16x32_bf16 v[136:139], v[104:107], v[76:79], v[136:139]
    ds_read_b128 v[40:43], v11 offset:6144
    v_mfma_f32_16x16x32_bf16 v[140:143], v[108:111], v[76:79], v[140:143]
    ds_read_b64_tr_b16 v[44:45], v17 offset:0
    v_mfma_f32_16x16x32_bf16 v[144:147], v[112:115], v[76:79], v[144:147]
    ds_read_b64_tr_b16 v[46:47], v17 offset:512
    v_mfma_f32_16x16x32_bf16 v[148:151], v[116:119], v[76:79], v[148:151]
    ds_read_b64_tr_b16 v[48:49], v20 offset:0
    v_mfma_f32_16x16x32_bf16 v[152:155], v[120:123], v[76:79], v[152:155]
    ds_read_b64_tr_b16 v[50:51], v20 offset:512
    v_mfma_f32_16x16x32_bf16 v[156:159], v[92:95], v[80:83], v[156:159]
    ds_read_b64_tr_b16 v[52:53], v23 offset:0
    v_mfma_f32_16x16x32_bf16 v[160:163], v[96:99], v[80:83], v[160:163]
    ds_read_b64_tr_b16 v[54:55], v23 offset:512
    v_mfma_f32_16x16x32_bf16 v[164:167], v[100:103], v[80:83], v[164:167]
    ds_read_b64_tr_b16 v[56:57], v26 offset:0
    v_mfma_f32_16x16x32_bf16 v[168:171], v[104:107], v[80:83], v[168:171]
    ds_read_b64_tr_b16 v[58:59], v26 offset:512
    v_mfma_f32_16x16x32_bf16 v[172:175], v[108:111], v[80:83], v[172:175]
    ds_read_b64_tr_b16 v[60:61], v17 offset:1024
    v_mfma_f32_16x16x32_bf16 v[176:179], v[112:115], v[80:83], v[176:179]
    ds_read_b64_tr_b16 v[62:63], v17 offset:1536
    v_mfma_f32_16x16x32_bf16 v[180:183], v[116:119], v[80:83], v[180:183]
    ds_read_b64_tr_b16 v[64:65], v20 offset:1024
    v_mfma_f32_16x16x32_bf16 v[184:187], v[120:123], v[80:83], v[184:187]
    ds_read_b64_tr_b16 v[66:67], v20 offset:1536
    v_mfma_f32_16x16x32_bf16 v[188:191], v[92:95], v[84:87], v[188:191]
    ds_read_b64_tr_b16 v[68:69], v23 offset:1024
    v_mfma_f32_16x16x32_bf16 v[192:195], v[96:99], v[84:87], v[192:195]
    ds_read_b64_tr_b16 v[70:71], v23 offset:1536
    v_mfma_f32_16x16x32_bf16 v[196:199], v[100:103], v[84:87], v[196:199]
    ds_read_b64_tr_b16 v[72:73], v26 offset:1024
    v_mfma_f32_16x16x32_bf16 v[200:203], v[104:107], v[84:87], v[200:203]
    ds_read_b64_tr_b16 v[74:75], v26 offset:1536
    v_mfma_f32_16x16x32_bf16 v[204:207], v[108:111], v[84:87], v[204:207]
    v_mfma_f32_16x16x32_bf16 v[208:211], v[112:115], v[84:87], v[208:211]
    v_mfma_f32_16x16x32_bf16 v[212:215], v[116:119], v[84:87], v[212:215]
    v_mfma_f32_16x16x32_bf16 v[216:219], v[120:123], v[84:87], v[216:219]
    v_mfma_f32_16x16x32_bf16 v[220:223], v[92:95], v[88:91], v[220:223]
    v_mfma_f32_16x16x32_bf16 v[224:227], v[96:99], v[88:91], v[224:227]
    v_mfma_f32_16x16x32_bf16 v[228:231], v[100:103], v[88:91], v[228:231]
    v_mfma_f32_16x16x32_bf16 v[232:235], v[104:107], v[88:91], v[232:235]
    v_mfma_f32_16x16x32_bf16 v[236:239], v[108:111], v[88:91], v[236:239]
    v_mfma_f32_16x16x32_bf16 v[240:243], v[112:115], v[88:91], v[240:243]
    v_mfma_f32_16x16x32_bf16 v[244:247], v[116:119], v[88:91], v[244:247]
    v_mfma_f32_16x16x32_bf16 v[248:251], v[120:123], v[88:91], v[248:251]
    s_waitcnt lgkmcnt(0)
    v_mfma_f32_16x16x32_bf16 v[124:127], v[44:47], v[28:31], v[124:127]
    ds_read_b128 v[76:79], v14 offset:0
    v_mfma_f32_16x16x32_bf16 v[128:131], v[48:51], v[28:31], v[128:131]
    ds_read_b128 v[80:83], v14 offset:2048
    v_mfma_f32_16x16x32_bf16 v[132:135], v[52:55], v[28:31], v[132:135]
    ds_read_b128 v[84:87], v14 offset:4096
    v_mfma_f32_16x16x32_bf16 v[136:139], v[56:59], v[28:31], v[136:139]
    ds_read_b128 v[88:91], v14 offset:6144
    v_mfma_f32_16x16x32_bf16 v[140:143], v[60:63], v[28:31], v[140:143]
    ds_read_b64_tr_b16 v[92:93], v17 offset:16384
    v_mfma_f32_16x16x32_bf16 v[144:147], v[64:67], v[28:31], v[144:147]
    ds_read_b64_tr_b16 v[94:95], v17 offset:16896
    v_mfma_f32_16x16x32_bf16 v[148:151], v[68:71], v[28:31], v[148:151]
    ds_read_b64_tr_b16 v[96:97], v20 offset:16384
    v_mfma_f32_16x16x32_bf16 v[152:155], v[72:75], v[28:31], v[152:155]
    ds_read_b64_tr_b16 v[98:99], v20 offset:16896
    v_mfma_f32_16x16x32_bf16 v[156:159], v[44:47], v[32:35], v[156:159]
    ds_read_b64_tr_b16 v[100:101], v23 offset:16384
    v_mfma_f32_16x16x32_bf16 v[160:163], v[48:51], v[32:35], v[160:163]
    ds_read_b64_tr_b16 v[102:103], v23 offset:16896
    v_mfma_f32_16x16x32_bf16 v[164:167], v[52:55], v[32:35], v[164:167]
    ds_read_b64_tr_b16 v[104:105], v26 offset:16384
    v_mfma_f32_16x16x32_bf16 v[168:171], v[56:59], v[32:35], v[168:171]
    ds_read_b64_tr_b16 v[106:107], v26 offset:16896
    v_mfma_f32_16x16x32_bf16 v[172:175], v[60:63], v[32:35], v[172:175]
    ds_read_b64_tr_b16 v[108:109], v17 offset:17408
    v_mfma_f32_16x16x32_bf16 v[176:179], v[64:67], v[32:35], v[176:179]
    ds_read_b64_tr_b16 v[110:111], v17 offset:17920
    v_mfma_f32_16x16x32_bf16 v[180:183], v[68:71], v[32:35], v[180:183]
    ds_read_b64_tr_b16 v[112:113], v20 offset:17408
    v_mfma_f32_16x16x32_bf16 v[184:187], v[72:75], v[32:35], v[184:187]
    ds_read_b64_tr_b16 v[114:115], v20 offset:17920
    v_mfma_f32_16x16x32_bf16 v[188:191], v[44:47], v[36:39], v[188:191]
    ds_read_b64_tr_b16 v[116:117], v23 offset:17408
    v_mfma_f32_16x16x32_bf16 v[192:195], v[48:51], v[36:39], v[192:195]
    ds_read_b64_tr_b16 v[118:119], v23 offset:17920
    v_mfma_f32_16x16x32_bf16 v[196:199], v[52:55], v[36:39], v[196:199]
    ds_read_b64_tr_b16 v[120:121], v26 offset:17408
    v_mfma_f32_16x16x32_bf16 v[200:203], v[56:59], v[36:39], v[200:203]
    ds_read_b64_tr_b16 v[122:123], v26 offset:17920
    v_mfma_f32_16x16x32_bf16 v[204:207], v[60:63], v[36:39], v[204:207]
    v_mfma_f32_16x16x32_bf16 v[208:211], v[64:67], v[36:39], v[208:211]
    v_mfma_f32_16x16x32_bf16 v[212:215], v[68:71], v[36:39], v[212:215]
    v_mfma_f32_16x16x32_bf16 v[216:219], v[72:75], v[36:39], v[216:219]
    v_mfma_f32_16x16x32_bf16 v[220:223], v[44:47], v[40:43], v[220:223]
    v_mfma_f32_16x16x32_bf16 v[224:227], v[48:51], v[40:43], v[224:227]
    v_mfma_f32_16x16x32_bf16 v[228:231], v[52:55], v[40:43], v[228:231]
    v_mfma_f32_16x16x32_bf16 v[232:235], v[56:59], v[40:43], v[232:235]
    v_mfma_f32_16x16x32_bf16 v[236:239], v[60:63], v[40:43], v[236:239]
    v_mfma_f32_16x16x32_bf16 v[240:243], v[64:67], v[40:43], v[240:243]
    v_mfma_f32_16x16x32_bf16 v[244:247], v[68:71], v[40:43], v[244:247]
    v_mfma_f32_16x16x32_bf16 v[248:251], v[72:75], v[40:43], v[248:251]
    s_waitcnt lgkmcnt(0)
    s_barrier
    v_mfma_f32_16x16x32_bf16 v[124:127], v[92:95], v[76:79], v[124:127]
    ds_read_b128 v[28:31], v12 offset:0
    v_mfma_f32_16x16x32_bf16 v[128:131], v[96:99], v[76:79], v[128:131]
    ds_read_b128 v[32:35], v12 offset:2048
    v_mfma_f32_16x16x32_bf16 v[132:135], v[100:103], v[76:79], v[132:135]
    ds_read_b128 v[36:39], v12 offset:4096
    v_mfma_f32_16x16x32_bf16 v[136:139], v[104:107], v[76:79], v[136:139]
    ds_read_b128 v[40:43], v12 offset:6144
    v_mfma_f32_16x16x32_bf16 v[140:143], v[108:111], v[76:79], v[140:143]
    ds_read_b64_tr_b16 v[44:45], v18 offset:0
    v_mfma_f32_16x16x32_bf16 v[144:147], v[112:115], v[76:79], v[144:147]
    ds_read_b64_tr_b16 v[46:47], v18 offset:512
    v_mfma_f32_16x16x32_bf16 v[148:151], v[116:119], v[76:79], v[148:151]
    ds_read_b64_tr_b16 v[48:49], v21 offset:0
    v_mfma_f32_16x16x32_bf16 v[152:155], v[120:123], v[76:79], v[152:155]
    ds_read_b64_tr_b16 v[50:51], v21 offset:512
    v_mfma_f32_16x16x32_bf16 v[156:159], v[92:95], v[80:83], v[156:159]
    ds_read_b64_tr_b16 v[52:53], v24 offset:0
    v_mfma_f32_16x16x32_bf16 v[160:163], v[96:99], v[80:83], v[160:163]
    ds_read_b64_tr_b16 v[54:55], v24 offset:512
    v_mfma_f32_16x16x32_bf16 v[164:167], v[100:103], v[80:83], v[164:167]
    ds_read_b64_tr_b16 v[56:57], v27 offset:0
    v_mfma_f32_16x16x32_bf16 v[168:171], v[104:107], v[80:83], v[168:171]
    ds_read_b64_tr_b16 v[58:59], v27 offset:512
    v_mfma_f32_16x16x32_bf16 v[172:175], v[108:111], v[80:83], v[172:175]
    ds_read_b64_tr_b16 v[60:61], v18 offset:1024
    v_mfma_f32_16x16x32_bf16 v[176:179], v[112:115], v[80:83], v[176:179]
    ds_read_b64_tr_b16 v[62:63], v18 offset:1536
    v_mfma_f32_16x16x32_bf16 v[180:183], v[116:119], v[80:83], v[180:183]
    ds_read_b64_tr_b16 v[64:65], v21 offset:1024
    v_mfma_f32_16x16x32_bf16 v[184:187], v[120:123], v[80:83], v[184:187]
    ds_read_b64_tr_b16 v[66:67], v21 offset:1536
    v_mfma_f32_16x16x32_bf16 v[188:191], v[92:95], v[84:87], v[188:191]
    ds_read_b64_tr_b16 v[68:69], v24 offset:1024
    v_mfma_f32_16x16x32_bf16 v[192:195], v[96:99], v[84:87], v[192:195]
    ds_read_b64_tr_b16 v[70:71], v24 offset:1536
    v_mfma_f32_16x16x32_bf16 v[196:199], v[100:103], v[84:87], v[196:199]
    ds_read_b64_tr_b16 v[72:73], v27 offset:1024
    v_mfma_f32_16x16x32_bf16 v[200:203], v[104:107], v[84:87], v[200:203]
    ds_read_b64_tr_b16 v[74:75], v27 offset:1536
    v_mfma_f32_16x16x32_bf16 v[204:207], v[108:111], v[84:87], v[204:207]
    v_mfma_f32_16x16x32_bf16 v[208:211], v[112:115], v[84:87], v[208:211]
    v_mfma_f32_16x16x32_bf16 v[212:215], v[116:119], v[84:87], v[212:215]
    v_mfma_f32_16x16x32_bf16 v[216:219], v[120:123], v[84:87], v[216:219]
    v_mfma_f32_16x16x32_bf16 v[220:223], v[92:95], v[88:91], v[220:223]
    v_mfma_f32_16x16x32_bf16 v[224:227], v[96:99], v[88:91], v[224:227]
    v_mfma_f32_16x16x32_bf16 v[228:231], v[100:103], v[88:91], v[228:231]
    v_mfma_f32_16x16x32_bf16 v[232:235], v[104:107], v[88:91], v[232:235]
    v_mfma_f32_16x16x32_bf16 v[236:239], v[108:111], v[88:91], v[236:239]
    v_mfma_f32_16x16x32_bf16 v[240:243], v[112:115], v[88:91], v[240:243]
    v_mfma_f32_16x16x32_bf16 v[244:247], v[116:119], v[88:91], v[244:247]
    v_mfma_f32_16x16x32_bf16 v[248:251], v[120:123], v[88:91], v[248:251]
    s_waitcnt lgkmcnt(0)
    v_mfma_f32_16x16x32_bf16 v[124:127], v[44:47], v[28:31], v[124:127]
    ds_read_b128 v[76:79], v15 offset:0
    v_mfma_f32_16x16x32_bf16 v[128:131], v[48:51], v[28:31], v[128:131]
    ds_read_b128 v[80:83], v15 offset:2048
    v_mfma_f32_16x16x32_bf16 v[132:135], v[52:55], v[28:31], v[132:135]
    ds_read_b128 v[84:87], v15 offset:4096
    v_mfma_f32_16x16x32_bf16 v[136:139], v[56:59], v[28:31], v[136:139]
    ds_read_b128 v[88:91], v15 offset:6144
    v_mfma_f32_16x16x32_bf16 v[140:143], v[60:63], v[28:31], v[140:143]
    ds_read_b64_tr_b16 v[92:93], v18 offset:16384
    v_mfma_f32_16x16x32_bf16 v[144:147], v[64:67], v[28:31], v[144:147]
    ds_read_b64_tr_b16 v[94:95], v18 offset:16896
    v_mfma_f32_16x16x32_bf16 v[148:151], v[68:71], v[28:31], v[148:151]
    ds_read_b64_tr_b16 v[96:97], v21 offset:16384
    v_mfma_f32_16x16x32_bf16 v[152:155], v[72:75], v[28:31], v[152:155]
    ds_read_b64_tr_b16 v[98:99], v21 offset:16896
    v_mfma_f32_16x16x32_bf16 v[156:159], v[44:47], v[32:35], v[156:159]
    ds_read_b64_tr_b16 v[100:101], v24 offset:16384
    v_mfma_f32_16x16x32_bf16 v[160:163], v[48:51], v[32:35], v[160:163]
    ds_read_b64_tr_b16 v[102:103], v24 offset:16896
    v_mfma_f32_16x16x32_bf16 v[164:167], v[52:55], v[32:35], v[164:167]
    ds_read_b64_tr_b16 v[104:105], v27 offset:16384
    v_mfma_f32_16x16x32_bf16 v[168:171], v[56:59], v[32:35], v[168:171]
    ds_read_b64_tr_b16 v[106:107], v27 offset:16896
    v_mfma_f32_16x16x32_bf16 v[172:175], v[60:63], v[32:35], v[172:175]
    ds_read_b64_tr_b16 v[108:109], v18 offset:17408
    v_mfma_f32_16x16x32_bf16 v[176:179], v[64:67], v[32:35], v[176:179]
    ds_read_b64_tr_b16 v[110:111], v18 offset:17920
    v_mfma_f32_16x16x32_bf16 v[180:183], v[68:71], v[32:35], v[180:183]
    ds_read_b64_tr_b16 v[112:113], v21 offset:17408
    v_mfma_f32_16x16x32_bf16 v[184:187], v[72:75], v[32:35], v[184:187]
    ds_read_b64_tr_b16 v[114:115], v21 offset:17920
    v_mfma_f32_16x16x32_bf16 v[188:191], v[44:47], v[36:39], v[188:191]
    ds_read_b64_tr_b16 v[116:117], v24 offset:17408
    v_mfma_f32_16x16x32_bf16 v[192:195], v[48:51], v[36:39], v[192:195]
    ds_read_b64_tr_b16 v[118:119], v24 offset:17920
    v_mfma_f32_16x16x32_bf16 v[196:199], v[52:55], v[36:39], v[196:199]
    ds_read_b64_tr_b16 v[120:121], v27 offset:17408
    v_mfma_f32_16x16x32_bf16 v[200:203], v[56:59], v[36:39], v[200:203]
    ds_read_b64_tr_b16 v[122:123], v27 offset:17920
    v_mfma_f32_16x16x32_bf16 v[204:207], v[60:63], v[36:39], v[204:207]
    v_mfma_f32_16x16x32_bf16 v[208:211], v[64:67], v[36:39], v[208:211]
    v_mfma_f32_16x16x32_bf16 v[212:215], v[68:71], v[36:39], v[212:215]
    v_mfma_f32_16x16x32_bf16 v[216:219], v[72:75], v[36:39], v[216:219]
    v_mfma_f32_16x16x32_bf16 v[220:223], v[44:47], v[40:43], v[220:223]
    v_mfma_f32_16x16x32_bf16 v[224:227], v[48:51], v[40:43], v[224:227]
    v_mfma_f32_16x16x32_bf16 v[228:231], v[52:55], v[40:43], v[228:231]
    v_mfma_f32_16x16x32_bf16 v[232:235], v[56:59], v[40:43], v[232:235]
    v_mfma_f32_16x16x32_bf16 v[236:239], v[60:63], v[40:43], v[236:239]
    v_mfma_f32_16x16x32_bf16 v[240:243], v[64:67], v[40:43], v[240:243]
    v_mfma_f32_16x16x32_bf16 v[244:247], v[68:71], v[40:43], v[244:247]
    v_mfma_f32_16x16x32_bf16 v[248:251], v[72:75], v[40:43], v[248:251]
    s_waitcnt lgkmcnt(0)
    s_barrier
    v_mfma_f32_16x16x32_bf16 v[124:127], v[92:95], v[76:79], v[124:127]
    ds_read_b128 v[28:31], v10 offset:0
    v_mfma_f32_16x16x32_bf16 v[128:131], v[96:99], v[76:79], v[128:131]
    ds_read_b128 v[32:35], v10 offset:2048
    v_mfma_f32_16x16x32_bf16 v[132:135], v[100:103], v[76:79], v[132:135]
    ds_read_b128 v[36:39], v10 offset:4096
    v_mfma_f32_16x16x32_bf16 v[136:139], v[104:107], v[76:79], v[136:139]
    ds_read_b128 v[40:43], v10 offset:6144
    v_mfma_f32_16x16x32_bf16 v[140:143], v[108:111], v[76:79], v[140:143]
    ds_read_b64_tr_b16 v[44:45], v16 offset:0
    v_mfma_f32_16x16x32_bf16 v[144:147], v[112:115], v[76:79], v[144:147]
    ds_read_b64_tr_b16 v[46:47], v16 offset:512
    v_mfma_f32_16x16x32_bf16 v[148:151], v[116:119], v[76:79], v[148:151]
    ds_read_b64_tr_b16 v[48:49], v19 offset:0
    v_mfma_f32_16x16x32_bf16 v[152:155], v[120:123], v[76:79], v[152:155]
    ds_read_b64_tr_b16 v[50:51], v19 offset:512
    v_mfma_f32_16x16x32_bf16 v[156:159], v[92:95], v[80:83], v[156:159]
    ds_read_b64_tr_b16 v[52:53], v22 offset:0
    v_mfma_f32_16x16x32_bf16 v[160:163], v[96:99], v[80:83], v[160:163]
    ds_read_b64_tr_b16 v[54:55], v22 offset:512
    v_mfma_f32_16x16x32_bf16 v[164:167], v[100:103], v[80:83], v[164:167]
    ds_read_b64_tr_b16 v[56:57], v25 offset:0
    v_mfma_f32_16x16x32_bf16 v[168:171], v[104:107], v[80:83], v[168:171]
    ds_read_b64_tr_b16 v[58:59], v25 offset:512
    v_mfma_f32_16x16x32_bf16 v[172:175], v[108:111], v[80:83], v[172:175]
    ds_read_b64_tr_b16 v[60:61], v16 offset:1024
    v_mfma_f32_16x16x32_bf16 v[176:179], v[112:115], v[80:83], v[176:179]
    ds_read_b64_tr_b16 v[62:63], v16 offset:1536
    v_mfma_f32_16x16x32_bf16 v[180:183], v[116:119], v[80:83], v[180:183]
    ds_read_b64_tr_b16 v[64:65], v19 offset:1024
    v_mfma_f32_16x16x32_bf16 v[184:187], v[120:123], v[80:83], v[184:187]
    ds_read_b64_tr_b16 v[66:67], v19 offset:1536
    v_mfma_f32_16x16x32_bf16 v[188:191], v[92:95], v[84:87], v[188:191]
    ds_read_b64_tr_b16 v[68:69], v22 offset:1024
    v_mfma_f32_16x16x32_bf16 v[192:195], v[96:99], v[84:87], v[192:195]
    ds_read_b64_tr_b16 v[70:71], v22 offset:1536
    v_mfma_f32_16x16x32_bf16 v[196:199], v[100:103], v[84:87], v[196:199]
    ds_read_b64_tr_b16 v[72:73], v25 offset:1024
    v_mfma_f32_16x16x32_bf16 v[200:203], v[104:107], v[84:87], v[200:203]
    ds_read_b64_tr_b16 v[74:75], v25 offset:1536
    v_mfma_f32_16x16x32_bf16 v[204:207], v[108:111], v[84:87], v[204:207]
    v_mfma_f32_16x16x32_bf16 v[208:211], v[112:115], v[84:87], v[208:211]
    v_mfma_f32_16x16x32_bf16 v[212:215], v[116:119], v[84:87], v[212:215]
    v_mfma_f32_16x16x32_bf16 v[216:219], v[120:123], v[84:87], v[216:219]
    v_mfma_f32_16x16x32_bf16 v[220:223], v[92:95], v[88:91], v[220:223]
    v_mfma_f32_16x16x32_bf16 v[224:227], v[96:99], v[88:91], v[224:227]
    v_mfma_f32_16x16x32_bf16 v[228:231], v[100:103], v[88:91], v[228:231]
    v_mfma_f32_16x16x32_bf16 v[232:235], v[104:107], v[88:91], v[232:235]
    v_mfma_f32_16x16x32_bf16 v[236:239], v[108:111], v[88:91], v[236:239]
    v_mfma_f32_16x16x32_bf16 v[240:243], v[112:115], v[88:91], v[240:243]
    v_mfma_f32_16x16x32_bf16 v[244:247], v[116:119], v[88:91], v[244:247]
    v_mfma_f32_16x16x32_bf16 v[248:251], v[120:123], v[88:91], v[248:251]
    s_waitcnt lgkmcnt(0)
    v_mfma_f32_16x16x32_bf16 v[124:127], v[44:47], v[28:31], v[124:127]
    ds_read_b128 v[76:79], v13 offset:0
    v_mfma_f32_16x16x32_bf16 v[128:131], v[48:51], v[28:31], v[128:131]
    ds_read_b128 v[80:83], v13 offset:2048
    v_mfma_f32_16x16x32_bf16 v[132:135], v[52:55], v[28:31], v[132:135]
    ds_read_b128 v[84:87], v13 offset:4096
    v_mfma_f32_16x16x32_bf16 v[136:139], v[56:59], v[28:31], v[136:139]
    ds_read_b128 v[88:91], v13 offset:6144
    v_mfma_f32_16x16x32_bf16 v[140:143], v[60:63], v[28:31], v[140:143]
    ds_read_b64_tr_b16 v[92:93], v16 offset:16384
    v_mfma_f32_16x16x32_bf16 v[144:147], v[64:67], v[28:31], v[144:147]
    ds_read_b64_tr_b16 v[94:95], v16 offset:16896
    v_mfma_f32_16x16x32_bf16 v[148:151], v[68:71], v[28:31], v[148:151]
    ds_read_b64_tr_b16 v[96:97], v19 offset:16384
    v_mfma_f32_16x16x32_bf16 v[152:155], v[72:75], v[28:31], v[152:155]
    ds_read_b64_tr_b16 v[98:99], v19 offset:16896
    v_mfma_f32_16x16x32_bf16 v[156:159], v[44:47], v[32:35], v[156:159]
    ds_read_b64_tr_b16 v[100:101], v22 offset:16384
    v_mfma_f32_16x16x32_bf16 v[160:163], v[48:51], v[32:35], v[160:163]
    ds_read_b64_tr_b16 v[102:103], v22 offset:16896
    v_mfma_f32_16x16x32_bf16 v[164:167], v[52:55], v[32:35], v[164:167]
    ds_read_b64_tr_b16 v[104:105], v25 offset:16384
    v_mfma_f32_16x16x32_bf16 v[168:171], v[56:59], v[32:35], v[168:171]
    ds_read_b64_tr_b16 v[106:107], v25 offset:16896
    v_mfma_f32_16x16x32_bf16 v[172:175], v[60:63], v[32:35], v[172:175]
    ds_read_b64_tr_b16 v[108:109], v16 offset:17408
    v_mfma_f32_16x16x32_bf16 v[176:179], v[64:67], v[32:35], v[176:179]
    ds_read_b64_tr_b16 v[110:111], v16 offset:17920
    v_mfma_f32_16x16x32_bf16 v[180:183], v[68:71], v[32:35], v[180:183]
    ds_read_b64_tr_b16 v[112:113], v19 offset:17408
    v_mfma_f32_16x16x32_bf16 v[184:187], v[72:75], v[32:35], v[184:187]
    ds_read_b64_tr_b16 v[114:115], v19 offset:17920
    v_mfma_f32_16x16x32_bf16 v[188:191], v[44:47], v[36:39], v[188:191]
    ds_read_b64_tr_b16 v[116:117], v22 offset:17408
    v_mfma_f32_16x16x32_bf16 v[192:195], v[48:51], v[36:39], v[192:195]
    ds_read_b64_tr_b16 v[118:119], v22 offset:17920
    v_mfma_f32_16x16x32_bf16 v[196:199], v[52:55], v[36:39], v[196:199]
    ds_read_b64_tr_b16 v[120:121], v25 offset:17408
    v_mfma_f32_16x16x32_bf16 v[200:203], v[56:59], v[36:39], v[200:203]
    ds_read_b64_tr_b16 v[122:123], v25 offset:17920
    v_mfma_f32_16x16x32_bf16 v[204:207], v[60:63], v[36:39], v[204:207]
    v_mfma_f32_16x16x32_bf16 v[208:211], v[64:67], v[36:39], v[208:211]
    v_mfma_f32_16x16x32_bf16 v[212:215], v[68:71], v[36:39], v[212:215]
    v_mfma_f32_16x16x32_bf16 v[216:219], v[72:75], v[36:39], v[216:219]
    v_mfma_f32_16x16x32_bf16 v[220:223], v[44:47], v[40:43], v[220:223]
    v_mfma_f32_16x16x32_bf16 v[224:227], v[48:51], v[40:43], v[224:227]
    v_mfma_f32_16x16x32_bf16 v[228:231], v[52:55], v[40:43], v[228:231]
    v_mfma_f32_16x16x32_bf16 v[232:235], v[56:59], v[40:43], v[232:235]
    v_mfma_f32_16x16x32_bf16 v[236:239], v[60:63], v[40:43], v[236:239]
    v_mfma_f32_16x16x32_bf16 v[240:243], v[64:67], v[40:43], v[240:243]
    v_mfma_f32_16x16x32_bf16 v[244:247], v[68:71], v[40:43], v[244:247]
    v_mfma_f32_16x16x32_bf16 v[248:251], v[72:75], v[40:43], v[248:251]
    s_waitcnt lgkmcnt(0)
    s_barrier
    v_mfma_f32_16x16x32_bf16 v[124:127], v[92:95], v[76:79], v[124:127]
    ds_read_b128 v[28:31], v11 offset:0
    v_mfma_f32_16x16x32_bf16 v[128:131], v[96:99], v[76:79], v[128:131]
    ds_read_b128 v[32:35], v11 offset:2048
    v_mfma_f32_16x16x32_bf16 v[132:135], v[100:103], v[76:79], v[132:135]
    ds_read_b128 v[36:39], v11 offset:4096
    v_mfma_f32_16x16x32_bf16 v[136:139], v[104:107], v[76:79], v[136:139]
    ds_read_b128 v[40:43], v11 offset:6144
    v_mfma_f32_16x16x32_bf16 v[140:143], v[108:111], v[76:79], v[140:143]
    ds_read_b64_tr_b16 v[44:45], v17 offset:0
    v_mfma_f32_16x16x32_bf16 v[144:147], v[112:115], v[76:79], v[144:147]
    ds_read_b64_tr_b16 v[46:47], v17 offset:512
    v_mfma_f32_16x16x32_bf16 v[148:151], v[116:119], v[76:79], v[148:151]
    ds_read_b64_tr_b16 v[48:49], v20 offset:0
    v_mfma_f32_16x16x32_bf16 v[152:155], v[120:123], v[76:79], v[152:155]
    ds_read_b64_tr_b16 v[50:51], v20 offset:512
    v_mfma_f32_16x16x32_bf16 v[156:159], v[92:95], v[80:83], v[156:159]
    ds_read_b64_tr_b16 v[52:53], v23 offset:0
    v_mfma_f32_16x16x32_bf16 v[160:163], v[96:99], v[80:83], v[160:163]
    ds_read_b64_tr_b16 v[54:55], v23 offset:512
    v_mfma_f32_16x16x32_bf16 v[164:167], v[100:103], v[80:83], v[164:167]
    ds_read_b64_tr_b16 v[56:57], v26 offset:0
    v_mfma_f32_16x16x32_bf16 v[168:171], v[104:107], v[80:83], v[168:171]
    ds_read_b64_tr_b16 v[58:59], v26 offset:512
    v_mfma_f32_16x16x32_bf16 v[172:175], v[108:111], v[80:83], v[172:175]
    ds_read_b64_tr_b16 v[60:61], v17 offset:1024
    v_mfma_f32_16x16x32_bf16 v[176:179], v[112:115], v[80:83], v[176:179]
    ds_read_b64_tr_b16 v[62:63], v17 offset:1536
    v_mfma_f32_16x16x32_bf16 v[180:183], v[116:119], v[80:83], v[180:183]
    ds_read_b64_tr_b16 v[64:65], v20 offset:1024
    v_mfma_f32_16x16x32_bf16 v[184:187], v[120:123], v[80:83], v[184:187]
    ds_read_b64_tr_b16 v[66:67], v20 offset:1536
    v_mfma_f32_16x16x32_bf16 v[188:191], v[92:95], v[84:87], v[188:191]
    ds_read_b64_tr_b16 v[68:69], v23 offset:1024
    v_mfma_f32_16x16x32_bf16 v[192:195], v[96:99], v[84:87], v[192:195]
    ds_read_b64_tr_b16 v[70:71], v23 offset:1536
    v_mfma_f32_16x16x32_bf16 v[196:199], v[100:103], v[84:87], v[196:199]
    ds_read_b64_tr_b16 v[72:73], v26 offset:1024
    v_mfma_f32_16x16x32_bf16 v[200:203], v[104:107], v[84:87], v[200:203]
    ds_read_b64_tr_b16 v[74:75], v26 offset:1536
    v_mfma_f32_16x16x32_bf16 v[204:207], v[108:111], v[84:87], v[204:207]
    v_mfma_f32_16x16x32_bf16 v[208:211], v[112:115], v[84:87], v[208:211]
    v_mfma_f32_16x16x32_bf16 v[212:215], v[116:119], v[84:87], v[212:215]
    v_mfma_f32_16x16x32_bf16 v[216:219], v[120:123], v[84:87], v[216:219]
    v_mfma_f32_16x16x32_bf16 v[220:223], v[92:95], v[88:91], v[220:223]
    v_mfma_f32_16x16x32_bf16 v[224:227], v[96:99], v[88:91], v[224:227]
    v_mfma_f32_16x16x32_bf16 v[228:231], v[100:103], v[88:91], v[228:231]
    v_mfma_f32_16x16x32_bf16 v[232:235], v[104:107], v[88:91], v[232:235]
    v_mfma_f32_16x16x32_bf16 v[236:239], v[108:111], v[88:91], v[236:239]
    v_mfma_f32_16x16x32_bf16 v[240:243], v[112:115], v[88:91], v[240:243]
    v_mfma_f32_16x16x32_bf16 v[244:247], v[116:119], v[88:91], v[244:247]
    v_mfma_f32_16x16x32_bf16 v[248:251], v[120:123], v[88:91], v[248:251]
    s_waitcnt lgkmcnt(0)
    v_mfma_f32_16x16x32_bf16 v[124:127], v[44:47], v[28:31], v[124:127]
    ds_read_b128 v[76:79], v14 offset:0
    v_mfma_f32_16x16x32_bf16 v[128:131], v[48:51], v[28:31], v[128:131]
    ds_read_b128 v[80:83], v14 offset:2048
    v_mfma_f32_16x16x32_bf16 v[132:135], v[52:55], v[28:31], v[132:135]
    ds_read_b128 v[84:87], v14 offset:4096
    v_mfma_f32_16x16x32_bf16 v[136:139], v[56:59], v[28:31], v[136:139]
    ds_read_b128 v[88:91], v14 offset:6144
    v_mfma_f32_16x16x32_bf16 v[140:143], v[60:63], v[28:31], v[140:143]
    ds_read_b64_tr_b16 v[92:93], v17 offset:16384
    v_mfma_f32_16x16x32_bf16 v[144:147], v[64:67], v[28:31], v[144:147]
    ds_read_b64_tr_b16 v[94:95], v17 offset:16896
    v_mfma_f32_16x16x32_bf16 v[148:151], v[68:71], v[28:31], v[148:151]
    ds_read_b64_tr_b16 v[96:97], v20 offset:16384
    v_mfma_f32_16x16x32_bf16 v[152:155], v[72:75], v[28:31], v[152:155]
    ds_read_b64_tr_b16 v[98:99], v20 offset:16896
    v_mfma_f32_16x16x32_bf16 v[156:159], v[44:47], v[32:35], v[156:159]
    ds_read_b64_tr_b16 v[100:101], v23 offset:16384
    v_mfma_f32_16x16x32_bf16 v[160:163], v[48:51], v[32:35], v[160:163]
    ds_read_b64_tr_b16 v[102:103], v23 offset:16896
    v_mfma_f32_16x16x32_bf16 v[164:167], v[52:55], v[32:35], v[164:167]
    ds_read_b64_tr_b16 v[104:105], v26 offset:16384
    v_mfma_f32_16x16x32_bf16 v[168:171], v[56:59], v[32:35], v[168:171]
    ds_read_b64_tr_b16 v[106:107], v26 offset:16896
    v_mfma_f32_16x16x32_bf16 v[172:175], v[60:63], v[32:35], v[172:175]
    ds_read_b64_tr_b16 v[108:109], v17 offset:17408
    v_mfma_f32_16x16x32_bf16 v[176:179], v[64:67], v[32:35], v[176:179]
    ds_read_b64_tr_b16 v[110:111], v17 offset:17920
    v_mfma_f32_16x16x32_bf16 v[180:183], v[68:71], v[32:35], v[180:183]
    ds_read_b64_tr_b16 v[112:113], v20 offset:17408
    v_mfma_f32_16x16x32_bf16 v[184:187], v[72:75], v[32:35], v[184:187]
    ds_read_b64_tr_b16 v[114:115], v20 offset:17920
    v_mfma_f32_16x16x32_bf16 v[188:191], v[44:47], v[36:39], v[188:191]
    ds_read_b64_tr_b16 v[116:117], v23 offset:17408
    v_mfma_f32_16x16x32_bf16 v[192:195], v[48:51], v[36:39], v[192:195]
    ds_read_b64_tr_b16 v[118:119], v23 offset:17920
    v_mfma_f32_16x16x32_bf16 v[196:199], v[52:55], v[36:39], v[196:199]
    ds_read_b64_tr_b16 v[120:121], v26 offset:17408
    v_mfma_f32_16x16x32_bf16 v[200:203], v[56:59], v[36:39], v[200:203]
    ds_read_b64_tr_b16 v[122:123], v26 offset:17920
    v_mfma_f32_16x16x32_bf16 v[204:207], v[60:63], v[36:39], v[204:207]
    v_mfma_f32_16x16x32_bf16 v[208:211], v[64:67], v[36:39], v[208:211]
    v_mfma_f32_16x16x32_bf16 v[212:215], v[68:71], v[36:39], v[212:215]
    v_mfma_f32_16x16x32_bf16 v[216:219], v[72:75], v[36:39], v[216:219]
    v_mfma_f32_16x16x32_bf16 v[220:223], v[44:47], v[40:43], v[220:223]
    v_mfma_f32_16x16x32_bf16 v[224:227], v[48:51], v[40:43], v[224:227]
    v_mfma_f32_16x16x32_bf16 v[228:231], v[52:55], v[40:43], v[228:231]
    v_mfma_f32_16x16x32_bf16 v[232:235], v[56:59], v[40:43], v[232:235]
    v_mfma_f32_16x16x32_bf16 v[236:239], v[60:63], v[40:43], v[236:239]
    v_mfma_f32_16x16x32_bf16 v[240:243], v[64:67], v[40:43], v[240:243]
    v_mfma_f32_16x16x32_bf16 v[244:247], v[68:71], v[40:43], v[244:247]
    v_mfma_f32_16x16x32_bf16 v[248:251], v[72:75], v[40:43], v[248:251]
    s_waitcnt lgkmcnt(0)
    s_barrier
    v_mfma_f32_16x16x32_bf16 v[124:127], v[92:95], v[76:79], v[124:127]
    ds_read_b128 v[28:31], v12 offset:0
    v_mfma_f32_16x16x32_bf16 v[128:131], v[96:99], v[76:79], v[128:131]
    ds_read_b128 v[32:35], v12 offset:2048
    v_mfma_f32_16x16x32_bf16 v[132:135], v[100:103], v[76:79], v[132:135]
    ds_read_b128 v[36:39], v12 offset:4096
    v_mfma_f32_16x16x32_bf16 v[136:139], v[104:107], v[76:79], v[136:139]
    ds_read_b128 v[40:43], v12 offset:6144
    v_mfma_f32_16x16x32_bf16 v[140:143], v[108:111], v[76:79], v[140:143]
    ds_read_b64_tr_b16 v[44:45], v18 offset:0
    v_mfma_f32_16x16x32_bf16 v[144:147], v[112:115], v[76:79], v[144:147]
    ds_read_b64_tr_b16 v[46:47], v18 offset:512
    v_mfma_f32_16x16x32_bf16 v[148:151], v[116:119], v[76:79], v[148:151]
    ds_read_b64_tr_b16 v[48:49], v21 offset:0
    v_mfma_f32_16x16x32_bf16 v[152:155], v[120:123], v[76:79], v[152:155]
    ds_read_b64_tr_b16 v[50:51], v21 offset:512
    v_mfma_f32_16x16x32_bf16 v[156:159], v[92:95], v[80:83], v[156:159]
    ds_read_b64_tr_b16 v[52:53], v24 offset:0
    v_mfma_f32_16x16x32_bf16 v[160:163], v[96:99], v[80:83], v[160:163]
    ds_read_b64_tr_b16 v[54:55], v24 offset:512
    v_mfma_f32_16x16x32_bf16 v[164:167], v[100:103], v[80:83], v[164:167]
    ds_read_b64_tr_b16 v[56:57], v27 offset:0
    v_mfma_f32_16x16x32_bf16 v[168:171], v[104:107], v[80:83], v[168:171]
    ds_read_b64_tr_b16 v[58:59], v27 offset:512
    v_mfma_f32_16x16x32_bf16 v[172:175], v[108:111], v[80:83], v[172:175]
    ds_read_b64_tr_b16 v[60:61], v18 offset:1024
    v_mfma_f32_16x16x32_bf16 v[176:179], v[112:115], v[80:83], v[176:179]
    ds_read_b64_tr_b16 v[62:63], v18 offset:1536
    v_mfma_f32_16x16x32_bf16 v[180:183], v[116:119], v[80:83], v[180:183]
    ds_read_b64_tr_b16 v[64:65], v21 offset:1024
    v_mfma_f32_16x16x32_bf16 v[184:187], v[120:123], v[80:83], v[184:187]
    ds_read_b64_tr_b16 v[66:67], v21 offset:1536
    v_mfma_f32_16x16x32_bf16 v[188:191], v[92:95], v[84:87], v[188:191]
    ds_read_b64_tr_b16 v[68:69], v24 offset:1024
    v_mfma_f32_16x16x32_bf16 v[192:195], v[96:99], v[84:87], v[192:195]
    ds_read_b64_tr_b16 v[70:71], v24 offset:1536
    v_mfma_f32_16x16x32_bf16 v[196:199], v[100:103], v[84:87], v[196:199]
    ds_read_b64_tr_b16 v[72:73], v27 offset:1024
    v_mfma_f32_16x16x32_bf16 v[200:203], v[104:107], v[84:87], v[200:203]
    ds_read_b64_tr_b16 v[74:75], v27 offset:1536
    v_mfma_f32_16x16x32_bf16 v[204:207], v[108:111], v[84:87], v[204:207]
    v_mfma_f32_16x16x32_bf16 v[208:211], v[112:115], v[84:87], v[208:211]
    v_mfma_f32_16x16x32_bf16 v[212:215], v[116:119], v[84:87], v[212:215]
    v_mfma_f32_16x16x32_bf16 v[216:219], v[120:123], v[84:87], v[216:219]
    v_mfma_f32_16x16x32_bf16 v[220:223], v[92:95], v[88:91], v[220:223]
    v_mfma_f32_16x16x32_bf16 v[224:227], v[96:99], v[88:91], v[224:227]
    v_mfma_f32_16x16x32_bf16 v[228:231], v[100:103], v[88:91], v[228:231]
    v_mfma_f32_16x16x32_bf16 v[232:235], v[104:107], v[88:91], v[232:235]
    v_mfma_f32_16x16x32_bf16 v[236:239], v[108:111], v[88:91], v[236:239]
    v_mfma_f32_16x16x32_bf16 v[240:243], v[112:115], v[88:91], v[240:243]
    v_mfma_f32_16x16x32_bf16 v[244:247], v[116:119], v[88:91], v[244:247]
    v_mfma_f32_16x16x32_bf16 v[248:251], v[120:123], v[88:91], v[248:251]
    s_waitcnt lgkmcnt(0)
    v_mfma_f32_16x16x32_bf16 v[124:127], v[44:47], v[28:31], v[124:127]
    ds_read_b128 v[76:79], v15 offset:0
    v_mfma_f32_16x16x32_bf16 v[128:131], v[48:51], v[28:31], v[128:131]
    ds_read_b128 v[80:83], v15 offset:2048
    v_mfma_f32_16x16x32_bf16 v[132:135], v[52:55], v[28:31], v[132:135]
    ds_read_b128 v[84:87], v15 offset:4096
    v_mfma_f32_16x16x32_bf16 v[136:139], v[56:59], v[28:31], v[136:139]
    ds_read_b128 v[88:91], v15 offset:6144
    v_mfma_f32_16x16x32_bf16 v[140:143], v[60:63], v[28:31], v[140:143]
    ds_read_b64_tr_b16 v[92:93], v18 offset:16384
    v_mfma_f32_16x16x32_bf16 v[144:147], v[64:67], v[28:31], v[144:147]
    ds_read_b64_tr_b16 v[94:95], v18 offset:16896
    v_mfma_f32_16x16x32_bf16 v[148:151], v[68:71], v[28:31], v[148:151]
    ds_read_b64_tr_b16 v[96:97], v21 offset:16384
    v_mfma_f32_16x16x32_bf16 v[152:155], v[72:75], v[28:31], v[152:155]
    ds_read_b64_tr_b16 v[98:99], v21 offset:16896
    v_mfma_f32_16x16x32_bf16 v[156:159], v[44:47], v[32:35], v[156:159]
    ds_read_b64_tr_b16 v[100:101], v24 offset:16384
    v_mfma_f32_16x16x32_bf16 v[160:163], v[48:51], v[32:35], v[160:163]
    ds_read_b64_tr_b16 v[102:103], v24 offset:16896
    v_mfma_f32_16x16x32_bf16 v[164:167], v[52:55], v[32:35], v[164:167]
    ds_read_b64_tr_b16 v[104:105], v27 offset:16384
    v_mfma_f32_16x16x32_bf16 v[168:171], v[56:59], v[32:35], v[168:171]
    ds_read_b64_tr_b16 v[106:107], v27 offset:16896
    v_mfma_f32_16x16x32_bf16 v[172:175], v[60:63], v[32:35], v[172:175]
    ds_read_b64_tr_b16 v[108:109], v18 offset:17408
    v_mfma_f32_16x16x32_bf16 v[176:179], v[64:67], v[32:35], v[176:179]
    ds_read_b64_tr_b16 v[110:111], v18 offset:17920
    v_mfma_f32_16x16x32_bf16 v[180:183], v[68:71], v[32:35], v[180:183]
    ds_read_b64_tr_b16 v[112:113], v21 offset:17408
    v_mfma_f32_16x16x32_bf16 v[184:187], v[72:75], v[32:35], v[184:187]
    ds_read_b64_tr_b16 v[114:115], v21 offset:17920
    v_mfma_f32_16x16x32_bf16 v[188:191], v[44:47], v[36:39], v[188:191]
    ds_read_b64_tr_b16 v[116:117], v24 offset:17408
    v_mfma_f32_16x16x32_bf16 v[192:195], v[48:51], v[36:39], v[192:195]
    ds_read_b64_tr_b16 v[118:119], v24 offset:17920
    v_mfma_f32_16x16x32_bf16 v[196:199], v[52:55], v[36:39], v[196:199]
    ds_read_b64_tr_b16 v[120:121], v27 offset:17408
    v_mfma_f32_16x16x32_bf16 v[200:203], v[56:59], v[36:39], v[200:203]
    ds_read_b64_tr_b16 v[122:123], v27 offset:17920
    v_mfma_f32_16x16x32_bf16 v[204:207], v[60:63], v[36:39], v[204:207]
    v_mfma_f32_16x16x32_bf16 v[208:211], v[64:67], v[36:39], v[208:211]
    v_mfma_f32_16x16x32_bf16 v[212:215], v[68:71], v[36:39], v[212:215]
    v_mfma_f32_16x16x32_bf16 v[216:219], v[72:75], v[36:39], v[216:219]
    v_mfma_f32_16x16x32_bf16 v[220:223], v[44:47], v[40:43], v[220:223]
    v_mfma_f32_16x16x32_bf16 v[224:227], v[48:51], v[40:43], v[224:227]
    v_mfma_f32_16x16x32_bf16 v[228:231], v[52:55], v[40:43], v[228:231]
    v_mfma_f32_16x16x32_bf16 v[232:235], v[56:59], v[40:43], v[232:235]
    v_mfma_f32_16x16x32_bf16 v[236:239], v[60:63], v[40:43], v[236:239]
    v_mfma_f32_16x16x32_bf16 v[240:243], v[64:67], v[40:43], v[240:243]
    v_mfma_f32_16x16x32_bf16 v[244:247], v[68:71], v[40:43], v[244:247]
    v_mfma_f32_16x16x32_bf16 v[248:251], v[72:75], v[40:43], v[248:251]
    s_waitcnt lgkmcnt(0)
    s_barrier
    v_mfma_f32_16x16x32_bf16 v[124:127], v[92:95], v[76:79], v[124:127]
    ds_read_b128 v[28:31], v10 offset:0
    v_mfma_f32_16x16x32_bf16 v[128:131], v[96:99], v[76:79], v[128:131]
    ds_read_b128 v[32:35], v10 offset:2048
    v_mfma_f32_16x16x32_bf16 v[132:135], v[100:103], v[76:79], v[132:135]
    ds_read_b128 v[36:39], v10 offset:4096
    v_mfma_f32_16x16x32_bf16 v[136:139], v[104:107], v[76:79], v[136:139]
    ds_read_b128 v[40:43], v10 offset:6144
    v_mfma_f32_16x16x32_bf16 v[140:143], v[108:111], v[76:79], v[140:143]
    ds_read_b64_tr_b16 v[44:45], v16 offset:0
    v_mfma_f32_16x16x32_bf16 v[144:147], v[112:115], v[76:79], v[144:147]
    ds_read_b64_tr_b16 v[46:47], v16 offset:512
    v_mfma_f32_16x16x32_bf16 v[148:151], v[116:119], v[76:79], v[148:151]
    ds_read_b64_tr_b16 v[48:49], v19 offset:0
    v_mfma_f32_16x16x32_bf16 v[152:155], v[120:123], v[76:79], v[152:155]
    ds_read_b64_tr_b16 v[50:51], v19 offset:512
    v_mfma_f32_16x16x32_bf16 v[156:159], v[92:95], v[80:83], v[156:159]
    ds_read_b64_tr_b16 v[52:53], v22 offset:0
    v_mfma_f32_16x16x32_bf16 v[160:163], v[96:99], v[80:83], v[160:163]
    ds_read_b64_tr_b16 v[54:55], v22 offset:512
    v_mfma_f32_16x16x32_bf16 v[164:167], v[100:103], v[80:83], v[164:167]
    ds_read_b64_tr_b16 v[56:57], v25 offset:0
    v_mfma_f32_16x16x32_bf16 v[168:171], v[104:107], v[80:83], v[168:171]
    ds_read_b64_tr_b16 v[58:59], v25 offset:512
    v_mfma_f32_16x16x32_bf16 v[172:175], v[108:111], v[80:83], v[172:175]
    ds_read_b64_tr_b16 v[60:61], v16 offset:1024
    v_mfma_f32_16x16x32_bf16 v[176:179], v[112:115], v[80:83], v[176:179]
    ds_read_b64_tr_b16 v[62:63], v16 offset:1536
    v_mfma_f32_16x16x32_bf16 v[180:183], v[116:119], v[80:83], v[180:183]
    ds_read_b64_tr_b16 v[64:65], v19 offset:1024
    v_mfma_f32_16x16x32_bf16 v[184:187], v[120:123], v[80:83], v[184:187]
    ds_read_b64_tr_b16 v[66:67], v19 offset:1536
    v_mfma_f32_16x16x32_bf16 v[188:191], v[92:95], v[84:87], v[188:191]
    ds_read_b64_tr_b16 v[68:69], v22 offset:1024
    v_mfma_f32_16x16x32_bf16 v[192:195], v[96:99], v[84:87], v[192:195]
    ds_read_b64_tr_b16 v[70:71], v22 offset:1536
    v_mfma_f32_16x16x32_bf16 v[196:199], v[100:103], v[84:87], v[196:199]
    ds_read_b64_tr_b16 v[72:73], v25 offset:1024
    v_mfma_f32_16x16x32_bf16 v[200:203], v[104:107], v[84:87], v[200:203]
    ds_read_b64_tr_b16 v[74:75], v25 offset:1536
    v_mfma_f32_16x16x32_bf16 v[204:207], v[108:111], v[84:87], v[204:207]
    v_mfma_f32_16x16x32_bf16 v[208:211], v[112:115], v[84:87], v[208:211]
    v_mfma_f32_16x16x32_bf16 v[212:215], v[116:119], v[84:87], v[212:215]
    v_mfma_f32_16x16x32_bf16 v[216:219], v[120:123], v[84:87], v[216:219]
    v_mfma_f32_16x16x32_bf16 v[220:223], v[92:95], v[88:91], v[220:223]
    v_mfma_f32_16x16x32_bf16 v[224:227], v[96:99], v[88:91], v[224:227]
    v_mfma_f32_16x16x32_bf16 v[228:231], v[100:103], v[88:91], v[228:231]
    v_mfma_f32_16x16x32_bf16 v[232:235], v[104:107], v[88:91], v[232:235]
    v_mfma_f32_16x16x32_bf16 v[236:239], v[108:111], v[88:91], v[236:239]
    v_mfma_f32_16x16x32_bf16 v[240:243], v[112:115], v[88:91], v[240:243]
    v_mfma_f32_16x16x32_bf16 v[244:247], v[116:119], v[88:91], v[244:247]
    v_mfma_f32_16x16x32_bf16 v[248:251], v[120:123], v[88:91], v[248:251]
    s_waitcnt lgkmcnt(0)
    v_mfma_f32_16x16x32_bf16 v[124:127], v[44:47], v[28:31], v[124:127]
    ds_read_b128 v[76:79], v13 offset:0
    v_mfma_f32_16x16x32_bf16 v[128:131], v[48:51], v[28:31], v[128:131]
    ds_read_b128 v[80:83], v13 offset:2048
    v_mfma_f32_16x16x32_bf16 v[132:135], v[52:55], v[28:31], v[132:135]
    ds_read_b128 v[84:87], v13 offset:4096
    v_mfma_f32_16x16x32_bf16 v[136:139], v[56:59], v[28:31], v[136:139]
    ds_read_b128 v[88:91], v13 offset:6144
    v_mfma_f32_16x16x32_bf16 v[140:143], v[60:63], v[28:31], v[140:143]
    ds_read_b64_tr_b16 v[92:93], v16 offset:16384
    v_mfma_f32_16x16x32_bf16 v[144:147], v[64:67], v[28:31], v[144:147]
    ds_read_b64_tr_b16 v[94:95], v16 offset:16896
    v_mfma_f32_16x16x32_bf16 v[148:151], v[68:71], v[28:31], v[148:151]
    ds_read_b64_tr_b16 v[96:97], v19 offset:16384
    v_mfma_f32_16x16x32_bf16 v[152:155], v[72:75], v[28:31], v[152:155]
    ds_read_b64_tr_b16 v[98:99], v19 offset:16896
    v_mfma_f32_16x16x32_bf16 v[156:159], v[44:47], v[32:35], v[156:159]
    ds_read_b64_tr_b16 v[100:101], v22 offset:16384
    v_mfma_f32_16x16x32_bf16 v[160:163], v[48:51], v[32:35], v[160:163]
    ds_read_b64_tr_b16 v[102:103], v22 offset:16896
    v_mfma_f32_16x16x32_bf16 v[164:167], v[52:55], v[32:35], v[164:167]
    ds_read_b64_tr_b16 v[104:105], v25 offset:16384
    v_mfma_f32_16x16x32_bf16 v[168:171], v[56:59], v[32:35], v[168:171]
    ds_read_b64_tr_b16 v[106:107], v25 offset:16896
    v_mfma_f32_16x16x32_bf16 v[172:175], v[60:63], v[32:35], v[172:175]
    ds_read_b64_tr_b16 v[108:109], v16 offset:17408
    v_mfma_f32_16x16x32_bf16 v[176:179], v[64:67], v[32:35], v[176:179]
    ds_read_b64_tr_b16 v[110:111], v16 offset:17920
    v_mfma_f32_16x16x32_bf16 v[180:183], v[68:71], v[32:35], v[180:183]
    ds_read_b64_tr_b16 v[112:113], v19 offset:17408
    v_mfma_f32_16x16x32_bf16 v[184:187], v[72:75], v[32:35], v[184:187]
    ds_read_b64_tr_b16 v[114:115], v19 offset:17920
    v_mfma_f32_16x16x32_bf16 v[188:191], v[44:47], v[36:39], v[188:191]
    ds_read_b64_tr_b16 v[116:117], v22 offset:17408
    v_mfma_f32_16x16x32_bf16 v[192:195], v[48:51], v[36:39], v[192:195]
    ds_read_b64_tr_b16 v[118:119], v22 offset:17920
    v_mfma_f32_16x16x32_bf16 v[196:199], v[52:55], v[36:39], v[196:199]
    ds_read_b64_tr_b16 v[120:121], v25 offset:17408
    v_mfma_f32_16x16x32_bf16 v[200:203], v[56:59], v[36:39], v[200:203]
    ds_read_b64_tr_b16 v[122:123], v25 offset:17920
    v_mfma_f32_16x16x32_bf16 v[204:207], v[60:63], v[36:39], v[204:207]
    v_mfma_f32_16x16x32_bf16 v[208:211], v[64:67], v[36:39], v[208:211]
    v_mfma_f32_16x16x32_bf16 v[212:215], v[68:71], v[36:39], v[212:215]
    v_mfma_f32_16x16x32_bf16 v[216:219], v[72:75], v[36:39], v[216:219]
    v_mfma_f32_16x16x32_bf16 v[220:223], v[44:47], v[40:43], v[220:223]
    v_mfma_f32_16x16x32_bf16 v[224:227], v[48:51], v[40:43], v[224:227]
    v_mfma_f32_16x16x32_bf16 v[228:231], v[52:55], v[40:43], v[228:231]
    v_mfma_f32_16x16x32_bf16 v[232:235], v[56:59], v[40:43], v[232:235]
    v_mfma_f32_16x16x32_bf16 v[236:239], v[60:63], v[40:43], v[236:239]
    v_mfma_f32_16x16x32_bf16 v[240:243], v[64:67], v[40:43], v[240:243]
    v_mfma_f32_16x16x32_bf16 v[244:247], v[68:71], v[40:43], v[244:247]
    v_mfma_f32_16x16x32_bf16 v[248:251], v[72:75], v[40:43], v[248:251]
    s_waitcnt lgkmcnt(0)
    v_mfma_f32_16x16x32_bf16 v[124:127], v[92:95], v[76:79], v[124:127]
    v_mfma_f32_16x16x32_bf16 v[128:131], v[96:99], v[76:79], v[128:131]
    v_mfma_f32_16x16x32_bf16 v[132:135], v[100:103], v[76:79], v[132:135]
    v_mfma_f32_16x16x32_bf16 v[136:139], v[104:107], v[76:79], v[136:139]
    v_mfma_f32_16x16x32_bf16 v[140:143], v[108:111], v[76:79], v[140:143]
    v_mfma_f32_16x16x32_bf16 v[144:147], v[112:115], v[76:79], v[144:147]
    v_mfma_f32_16x16x32_bf16 v[148:151], v[116:119], v[76:79], v[148:151]
    v_mfma_f32_16x16x32_bf16 v[152:155], v[120:123], v[76:79], v[152:155]
    v_mfma_f32_16x16x32_bf16 v[156:159], v[92:95], v[80:83], v[156:159]
    v_mfma_f32_16x16x32_bf16 v[160:163], v[96:99], v[80:83], v[160:163]
    v_mfma_f32_16x16x32_bf16 v[164:167], v[100:103], v[80:83], v[164:167]
    v_mfma_f32_16x16x32_bf16 v[168:171], v[104:107], v[80:83], v[168:171]
    v_mfma_f32_16x16x32_bf16 v[172:175], v[108:111], v[80:83], v[172:175]
    v_mfma_f32_16x16x32_bf16 v[176:179], v[112:115], v[80:83], v[176:179]
    v_mfma_f32_16x16x32_bf16 v[180:183], v[116:119], v[80:83], v[180:183]
    v_mfma_f32_16x16x32_bf16 v[184:187], v[120:123], v[80:83], v[184:187]
    v_mfma_f32_16x16x32_bf16 v[188:191], v[92:95], v[84:87], v[188:191]
    v_mfma_f32_16x16x32_bf16 v[192:195], v[96:99], v[84:87], v[192:195]
    v_mfma_f32_16x16x32_bf16 v[196:199], v[100:103], v[84:87], v[196:199]
    v_mfma_f32_16x16x32_bf16 v[200:203], v[104:107], v[84:87], v[200:203]
    v_mfma_f32_16x16x32_bf16 v[204:207], v[108:111], v[84:87], v[204:207]
    v_mfma_f32_16x16x32_bf16 v[208:211], v[112:115], v[84:87], v[208:211]
    v_mfma_f32_16x16x32_bf16 v[212:215], v[116:119], v[84:87], v[212:215]
    v_mfma_f32_16x16x32_bf16 v[216:219], v[120:123], v[84:87], v[216:219]
    v_mfma_f32_16x16x32_bf16 v[220:223], v[92:95], v[88:91], v[220:223]
    v_mfma_f32_16x16x32_bf16 v[224:227], v[96:99], v[88:91], v[224:227]
    v_mfma_f32_16x16x32_bf16 v[228:231], v[100:103], v[88:91], v[228:231]
    v_mfma_f32_16x16x32_bf16 v[232:235], v[104:107], v[88:91], v[232:235]
    v_mfma_f32_16x16x32_bf16 v[236:239], v[108:111], v[88:91], v[236:239]
    v_mfma_f32_16x16x32_bf16 v[240:243], v[112:115], v[88:91], v[240:243]
    v_mfma_f32_16x16x32_bf16 v[244:247], v[116:119], v[88:91], v[244:247]
    v_mfma_f32_16x16x32_bf16 v[248:251], v[120:123], v[88:91], v[248:251]
    s_barrier
    s_mul_i32 s37, s32, 17408
    v_mul_u32_u24 v10, 272, v3
    v_lshl_add_u32 v10, v4, 3, v10
    v_add_u32 v10, s37, v10
    s_mov_b32 s48, 0xbfb8aa3b
    s_mov_b32 s49, 0xbfb8aa3b
    s_mov_b32 s50, 1.0
    s_mov_b32 s51, 1.0
    s_nop 3
    v_cvt_pk_bf16_f32 v44, v124, v125
    v_cvt_pk_bf16_f32 v45, v126, v127
    v_cvt_pk_bf16_f32 v46, v128, v129
    v_cvt_pk_bf16_f32 v47, v130, v131
    v_lshlrev_b32 v28, 16, v44
    v_and_b32 v29, 0xffff0000, v44
    v_lshlrev_b32 v30, 16, v45
    v_and_b32 v31, 0xffff0000, v45
    v_lshlrev_b32 v32, 16, v46
    v_and_b32 v33, 0xffff0000, v46
    v_lshlrev_b32 v34, 16, v47
    v_and_b32 v35, 0xffff0000, v47
    v_mul_f32 v36, s48, v28
    v_mul_f32 v37, s48, v29
    v_mul_f32 v38, s48, v30
    v_mul_f32 v39, s48, v31
    v_mul_f32 v40, s48, v32
    v_mul_f32 v41, s48, v33
    v_mul_f32 v42, s48, v34
    v_mul_f32 v43, s48, v35
    v_exp_f32 v36, v36
    v_exp_f32 v37, v37
    v_exp_f32 v38, v38
    v_exp_f32 v39, v39
    v_exp_f32 v40, v40
    v_exp_f32 v41, v41
    v_exp_f32 v42, v42
    v_exp_f32 v43, v43
    v_add_f32 v36, 1.0, v36
    v_add_f32 v37, 1.0, v37
    v_add_f32 v38, 1.0, v38
    v_add_f32 v39, 1.0, v39
    v_add_f32 v40, 1.0, v40
    v_add_f32 v41, 1.0, v41
    v_add_f32 v42, 1.0, v42
    v_add_f32 v43, 1.0, v43
    v_rcp_f32 v36, v36
    v_rcp_f32 v37, v37
    v_rcp_f32 v38, v38
    v_rcp_f32 v39, v39
    v_rcp_f32 v40, v40
    v_rcp_f32 v41, v41
    v_rcp_f32 v42, v42
    v_rcp_f32 v43, v43
    v_mul_f32 v28, v28, v36
    v_mul_f32 v29, v29, v37
    v_mul_f32 v30, v30, v38
    v_mul_f32 v31, v31, v39
    v_mul_f32 v32, v32, v40
    v_mul_f32 v33, v33, v41
    v_mul_f32 v34, v34, v42
    v_mul_f32 v35, v35, v43
    v_cvt_pk_bf16_f32 v48, v28, v29
    v_cvt_pk_bf16_f32 v49, v30, v31
    v_cvt_pk_bf16_f32 v50, v32, v33
    v_cvt_pk_bf16_f32 v51, v34, v35
    ds_write_b64 v10, v[48:49] offset:0
    ds_write_b64 v10, v[50:51] offset:32
    v_cvt_pk_bf16_f32 v68, v132, v133
    v_cvt_pk_bf16_f32 v69, v134, v135
    v_cvt_pk_bf16_f32 v70, v136, v137
    v_cvt_pk_bf16_f32 v71, v138, v139
    v_lshlrev_b32 v52, 16, v68
    v_and_b32 v53, 0xffff0000, v68
    v_lshlrev_b32 v54, 16, v69
    v_and_b32 v55, 0xffff0000, v69
    v_lshlrev_b32 v56, 16, v70
    v_and_b32 v57, 0xffff0000, v70
    v_lshlrev_b32 v58, 16, v71
    v_and_b32 v59, 0xffff0000, v71
    v_mul_f32 v60, s48, v52
    v_mul_f32 v61, s48, v53
    v_mul_f32 v62, s48, v54
    v_mul_f32 v63, s48, v55
    v_mul_f32 v64, s48, v56
    v_mul_f32 v65, s48, v57
    v_mul_f32 v66, s48, v58
    v_mul_f32 v67, s48, v59
    v_exp_f32 v60, v60
    v_exp_f32 v61, v61
    v_exp_f32 v62, v62
    v_exp_f32 v63, v63
    v_exp_f32 v64, v64
    v_exp_f32 v65, v65
    v_exp_f32 v66, v66
    v_exp_f32 v67, v67
    v_add_f32 v60, 1.0, v60
    v_add_f32 v61, 1.0, v61
    v_add_f32 v62, 1.0, v62
    v_add_f32 v63, 1.0, v63
    v_add_f32 v64, 1.0, v64
    v_add_f32 v65, 1.0, v65
    v_add_f32 v66, 1.0, v66
    v_add_f32 v67, 1.0, v67
    v_rcp_f32 v60, v60
    v_rcp_f32 v61, v61
    v_rcp_f32 v62, v62
    v_rcp_f32 v63, v63
    v_rcp_f32 v64, v64
    v_rcp_f32 v65, v65
    v_rcp_f32 v66, v66
    v_rcp_f32 v67, v67
    v_mul_f32 v52, v52, v60
    v_mul_f32 v53, v53, v61
    v_mul_f32 v54, v54, v62
    v_mul_f32 v55, v55, v63
    v_mul_f32 v56, v56, v64
    v_mul_f32 v57, v57, v65
    v_mul_f32 v58, v58, v66
    v_mul_f32 v59, v59, v67
    v_cvt_pk_bf16_f32 v72, v52, v53
    v_cvt_pk_bf16_f32 v73, v54, v55
    v_cvt_pk_bf16_f32 v74, v56, v57
    v_cvt_pk_bf16_f32 v75, v58, v59
    ds_write_b64 v10, v[72:73] offset:64
    ds_write_b64 v10, v[74:75] offset:96
    v_cvt_pk_bf16_f32 v44, v140, v141
    v_cvt_pk_bf16_f32 v45, v142, v143
    v_cvt_pk_bf16_f32 v46, v144, v145
    v_cvt_pk_bf16_f32 v47, v146, v147
    v_lshlrev_b32 v28, 16, v44
    v_and_b32 v29, 0xffff0000, v44
    v_lshlrev_b32 v30, 16, v45
    v_and_b32 v31, 0xffff0000, v45
    v_lshlrev_b32 v32, 16, v46
    v_and_b32 v33, 0xffff0000, v46
    v_lshlrev_b32 v34, 16, v47
    v_and_b32 v35, 0xffff0000, v47
    v_mul_f32 v36, s48, v28
    v_mul_f32 v37, s48, v29
    v_mul_f32 v38, s48, v30
    v_mul_f32 v39, s48, v31
    v_mul_f32 v40, s48, v32
    v_mul_f32 v41, s48, v33
    v_mul_f32 v42, s48, v34
    v_mul_f32 v43, s48, v35
    v_exp_f32 v36, v36
    v_exp_f32 v37, v37
    v_exp_f32 v38, v38
    v_exp_f32 v39, v39
    v_exp_f32 v40, v40
    v_exp_f32 v41, v41
    v_exp_f32 v42, v42
    v_exp_f32 v43, v43
    v_add_f32 v36, 1.0, v36
    v_add_f32 v37, 1.0, v37
    v_add_f32 v38, 1.0, v38
    v_add_f32 v39, 1.0, v39
    v_add_f32 v40, 1.0, v40
    v_add_f32 v41, 1.0, v41
    v_add_f32 v42, 1.0, v42
    v_add_f32 v43, 1.0, v43
    v_rcp_f32 v36, v36
    v_rcp_f32 v37, v37
    v_rcp_f32 v38, v38
    v_rcp_f32 v39, v39
    v_rcp_f32 v40, v40
    v_rcp_f32 v41, v41
    v_rcp_f32 v42, v42
    v_rcp_f32 v43, v43
    v_mul_f32 v28, v28, v36
    v_mul_f32 v29, v29, v37
    v_mul_f32 v30, v30, v38
    v_mul_f32 v31, v31, v39
    v_mul_f32 v32, v32, v40
    v_mul_f32 v33, v33, v41
    v_mul_f32 v34, v34, v42
    v_mul_f32 v35, v35, v43
    v_cvt_pk_bf16_f32 v48, v28, v29
    v_cvt_pk_bf16_f32 v49, v30, v31
    v_cvt_pk_bf16_f32 v50, v32, v33
    v_cvt_pk_bf16_f32 v51, v34, v35
    ds_write_b64 v10, v[48:49] offset:128
    ds_write_b64 v10, v[50:51] offset:160
    v_cvt_pk_bf16_f32 v68, v148, v149
    v_cvt_pk_bf16_f32 v69, v150, v151
    v_cvt_pk_bf16_f32 v70, v152, v153
    v_cvt_pk_bf16_f32 v71, v154, v155
    v_lshlrev_b32 v52, 16, v68
    v_and_b32 v53, 0xffff0000, v68
    v_lshlrev_b32 v54, 16, v69
    v_and_b32 v55, 0xffff0000, v69
    v_lshlrev_b32 v56, 16, v70
    v_and_b32 v57, 0xffff0000, v70
    v_lshlrev_b32 v58, 16, v71
    v_and_b32 v59, 0xffff0000, v71
    v_mul_f32 v60, s48, v52
    v_mul_f32 v61, s48, v53
    v_mul_f32 v62, s48, v54
    v_mul_f32 v63, s48, v55
    v_mul_f32 v64, s48, v56
    v_mul_f32 v65, s48, v57
    v_mul_f32 v66, s48, v58
    v_mul_f32 v67, s48, v59
    v_exp_f32 v60, v60
    v_exp_f32 v61, v61
    v_exp_f32 v62, v62
    v_exp_f32 v63, v63
    v_exp_f32 v64, v64
    v_exp_f32 v65, v65
    v_exp_f32 v66, v66
    v_exp_f32 v67, v67
    v_add_f32 v60, 1.0, v60
    v_add_f32 v61, 1.0, v61
    v_add_f32 v62, 1.0, v62
    v_add_f32 v63, 1.0, v63
    v_add_f32 v64, 1.0, v64
    v_add_f32 v65, 1.0, v65
    v_add_f32 v66, 1.0, v66
    v_add_f32 v67, 1.0, v67
    v_rcp_f32 v60, v60
    v_rcp_f32 v61, v61
    v_rcp_f32 v62, v62
    v_rcp_f32 v63, v63
    v_rcp_f32 v64, v64
    v_rcp_f32 v65, v65
    v_rcp_f32 v66, v66
    v_rcp_f32 v67, v67
    v_mul_f32 v52, v52, v60
    v_mul_f32 v53, v53, v61
    v_mul_f32 v54, v54, v62
    v_mul_f32 v55, v55, v63
    v_mul_f32 v56, v56, v64
    v_mul_f32 v57, v57, v65
    v_mul_f32 v58, v58, v66
    v_mul_f32 v59, v59, v67
    v_cvt_pk_bf16_f32 v72, v52, v53
    v_cvt_pk_bf16_f32 v73, v54, v55
    v_cvt_pk_bf16_f32 v74, v56, v57
    v_cvt_pk_bf16_f32 v75, v58, v59
    ds_write_b64 v10, v[72:73] offset:192
    ds_write_b64 v10, v[74:75] offset:224
    v_mul_u32_u24 v11, 272, v4
    v_lshl_add_u32 v11, v3, 4, v11
    v_add_u32 v11, s37, v11
    s_lshl_b32 s39, s31, 7
    s_lshr_b32 s40, s32, 1
    s_lshl_b32 s40, s40, 6
    s_add_u32 s39, s39, s40
    v_add_u32 v12, s39, v4
    s_movk_i32 s41, 5760
    v_mul_lo_u32 v12, v12, s41
    v_lshl_add_u32 v12, v3, 4, v12
    s_lshl_b32 s40, s30, 9
    s_and_b32 s41, s32, 1
    s_lshl_b32 s41, s41, 8
    s_add_u32 s40, s40, s41
    s_add_u32 s40, s40, 4934144
    v_add_u32 v12, s40, v12
    ds_read_b128 v[124:127], v11 offset:0
    ds_read_b128 v[128:131], v11 offset:1088
    ds_read_b128 v[132:135], v11 offset:2176
    ds_read_b128 v[136:139], v11 offset:3264
    v_cvt_pk_bf16_f32 v44, v156, v157
    v_cvt_pk_bf16_f32 v45, v158, v159
    v_cvt_pk_bf16_f32 v46, v160, v161
    v_cvt_pk_bf16_f32 v47, v162, v163
    v_lshlrev_b32 v28, 16, v44
    v_and_b32 v29, 0xffff0000, v44
    v_lshlrev_b32 v30, 16, v45
    v_and_b32 v31, 0xffff0000, v45
    v_lshlrev_b32 v32, 16, v46
    v_and_b32 v33, 0xffff0000, v46
    v_lshlrev_b32 v34, 16, v47
    v_and_b32 v35, 0xffff0000, v47
    v_mul_f32 v36, s48, v28
    v_mul_f32 v37, s48, v29
    v_mul_f32 v38, s48, v30
    v_mul_f32 v39, s48, v31
    v_mul_f32 v40, s48, v32
    v_mul_f32 v41, s48, v33
    v_mul_f32 v42, s48, v34
    v_mul_f32 v43, s48, v35
    v_exp_f32 v36, v36
    v_exp_f32 v37, v37
    v_exp_f32 v38, v38
    v_exp_f32 v39, v39
    v_exp_f32 v40, v40
    v_exp_f32 v41, v41
    v_exp_f32 v42, v42
    v_exp_f32 v43, v43
    v_add_f32 v36, 1.0, v36
    v_add_f32 v37, 1.0, v37
    v_add_f32 v38, 1.0, v38
    v_add_f32 v39, 1.0, v39
    v_add_f32 v40, 1.0, v40
    v_add_f32 v41, 1.0, v41
    v_add_f32 v42, 1.0, v42
    v_add_f32 v43, 1.0, v43
    v_rcp_f32 v36, v36
    v_rcp_f32 v37, v37
    v_rcp_f32 v38, v38
    v_rcp_f32 v39, v39
    v_rcp_f32 v40, v40
    v_rcp_f32 v41, v41
    v_rcp_f32 v42, v42
    v_rcp_f32 v43, v43
    v_mul_f32 v28, v28, v36
    v_mul_f32 v29, v29, v37
    v_mul_f32 v30, v30, v38
    v_mul_f32 v31, v31, v39
    v_mul_f32 v32, v32, v40
    v_mul_f32 v33, v33, v41
    v_mul_f32 v34, v34, v42
    v_mul_f32 v35, v35, v43
    v_cvt_pk_bf16_f32 v48, v28, v29
    v_cvt_pk_bf16_f32 v49, v30, v31
    v_cvt_pk_bf16_f32 v50, v32, v33
    v_cvt_pk_bf16_f32 v51, v34, v35
    ds_write_b64 v10, v[48:49] offset:4352
    ds_write_b64 v10, v[50:51] offset:4384
    v_cvt_pk_bf16_f32 v68, v164, v165
    v_cvt_pk_bf16_f32 v69, v166, v167
    v_cvt_pk_bf16_f32 v70, v168, v169
    v_cvt_pk_bf16_f32 v71, v170, v171
    v_lshlrev_b32 v52, 16, v68
    v_and_b32 v53, 0xffff0000, v68
    v_lshlrev_b32 v54, 16, v69
    v_and_b32 v55, 0xffff0000, v69
    v_lshlrev_b32 v56, 16, v70
    v_and_b32 v57, 0xffff0000, v70
    v_lshlrev_b32 v58, 16, v71
    v_and_b32 v59, 0xffff0000, v71
    v_mul_f32 v60, s48, v52
    v_mul_f32 v61, s48, v53
    v_mul_f32 v62, s48, v54
    v_mul_f32 v63, s48, v55
    v_mul_f32 v64, s48, v56
    v_mul_f32 v65, s48, v57
    v_mul_f32 v66, s48, v58
    v_mul_f32 v67, s48, v59
    v_exp_f32 v60, v60
    v_exp_f32 v61, v61
    v_exp_f32 v62, v62
    v_exp_f32 v63, v63
    v_exp_f32 v64, v64
    v_exp_f32 v65, v65
    v_exp_f32 v66, v66
    v_exp_f32 v67, v67
    v_add_f32 v60, 1.0, v60
    v_add_f32 v61, 1.0, v61
    v_add_f32 v62, 1.0, v62
    v_add_f32 v63, 1.0, v63
    v_add_f32 v64, 1.0, v64
    v_add_f32 v65, 1.0, v65
    v_add_f32 v66, 1.0, v66
    v_add_f32 v67, 1.0, v67
    v_rcp_f32 v60, v60
    v_rcp_f32 v61, v61
    v_rcp_f32 v62, v62
    v_rcp_f32 v63, v63
    v_rcp_f32 v64, v64
    v_rcp_f32 v65, v65
    v_rcp_f32 v66, v66
    v_rcp_f32 v67, v67
    v_mul_f32 v52, v52, v60
    v_mul_f32 v53, v53, v61
    v_mul_f32 v54, v54, v62
    v_mul_f32 v55, v55, v63
    v_mul_f32 v56, v56, v64
    v_mul_f32 v57, v57, v65
    v_mul_f32 v58, v58, v66
    v_mul_f32 v59, v59, v67
    v_cvt_pk_bf16_f32 v72, v52, v53
    v_cvt_pk_bf16_f32 v73, v54, v55
    v_cvt_pk_bf16_f32 v74, v56, v57
    v_cvt_pk_bf16_f32 v75, v58, v59
    ds_write_b64 v10, v[72:73] offset:4416
    ds_write_b64 v10, v[74:75] offset:4448
    v_cvt_pk_bf16_f32 v44, v172, v173
    v_cvt_pk_bf16_f32 v45, v174, v175
    v_cvt_pk_bf16_f32 v46, v176, v177
    v_cvt_pk_bf16_f32 v47, v178, v179
    v_lshlrev_b32 v28, 16, v44
    v_and_b32 v29, 0xffff0000, v44
    v_lshlrev_b32 v30, 16, v45
    v_and_b32 v31, 0xffff0000, v45
    v_lshlrev_b32 v32, 16, v46
    v_and_b32 v33, 0xffff0000, v46
    v_lshlrev_b32 v34, 16, v47
    v_and_b32 v35, 0xffff0000, v47
    v_mul_f32 v36, s48, v28
    v_mul_f32 v37, s48, v29
    v_mul_f32 v38, s48, v30
    v_mul_f32 v39, s48, v31
    v_mul_f32 v40, s48, v32
    v_mul_f32 v41, s48, v33
    v_mul_f32 v42, s48, v34
    v_mul_f32 v43, s48, v35
    v_exp_f32 v36, v36
    v_exp_f32 v37, v37
    v_exp_f32 v38, v38
    v_exp_f32 v39, v39
    v_exp_f32 v40, v40
    v_exp_f32 v41, v41
    v_exp_f32 v42, v42
    v_exp_f32 v43, v43
    v_add_f32 v36, 1.0, v36
    v_add_f32 v37, 1.0, v37
    v_add_f32 v38, 1.0, v38
    v_add_f32 v39, 1.0, v39
    v_add_f32 v40, 1.0, v40
    v_add_f32 v41, 1.0, v41
    v_add_f32 v42, 1.0, v42
    v_add_f32 v43, 1.0, v43
    v_rcp_f32 v36, v36
    v_rcp_f32 v37, v37
    v_rcp_f32 v38, v38
    v_rcp_f32 v39, v39
    v_rcp_f32 v40, v40
    v_rcp_f32 v41, v41
    v_rcp_f32 v42, v42
    v_rcp_f32 v43, v43
    v_mul_f32 v28, v28, v36
    v_mul_f32 v29, v29, v37
    v_mul_f32 v30, v30, v38
    v_mul_f32 v31, v31, v39
    v_mul_f32 v32, v32, v40
    v_mul_f32 v33, v33, v41
    v_mul_f32 v34, v34, v42
    v_mul_f32 v35, v35, v43
    v_cvt_pk_bf16_f32 v48, v28, v29
    v_cvt_pk_bf16_f32 v49, v30, v31
    v_cvt_pk_bf16_f32 v50, v32, v33
    v_cvt_pk_bf16_f32 v51, v34, v35
    ds_write_b64 v10, v[48:49] offset:4480
    ds_write_b64 v10, v[50:51] offset:4512
    v_cvt_pk_bf16_f32 v68, v180, v181
    v_cvt_pk_bf16_f32 v69, v182, v183
    v_cvt_pk_bf16_f32 v70, v184, v185
    v_cvt_pk_bf16_f32 v71, v186, v187
    v_lshlrev_b32 v52, 16, v68
    v_and_b32 v53, 0xffff0000, v68
    v_lshlrev_b32 v54, 16, v69
    v_and_b32 v55, 0xffff0000, v69
    v_lshlrev_b32 v56, 16, v70
    v_and_b32 v57, 0xffff0000, v70
    v_lshlrev_b32 v58, 16, v71
    v_and_b32 v59, 0xffff0000, v71
    v_mul_f32 v60, s48, v52
    v_mul_f32 v61, s48, v53
    v_mul_f32 v62, s48, v54
    v_mul_f32 v63, s48, v55
    v_mul_f32 v64, s48, v56
    v_mul_f32 v65, s48, v57
    v_mul_f32 v66, s48, v58
    v_mul_f32 v67, s48, v59
    v_exp_f32 v60, v60
    v_exp_f32 v61, v61
    v_exp_f32 v62, v62
    v_exp_f32 v63, v63
    v_exp_f32 v64, v64
    v_exp_f32 v65, v65
    v_exp_f32 v66, v66
    v_exp_f32 v67, v67
    v_add_f32 v60, 1.0, v60
    v_add_f32 v61, 1.0, v61
    v_add_f32 v62, 1.0, v62
    v_add_f32 v63, 1.0, v63
    v_add_f32 v64, 1.0, v64
    v_add_f32 v65, 1.0, v65
    v_add_f32 v66, 1.0, v66
    v_add_f32 v67, 1.0, v67
    v_rcp_f32 v60, v60
    v_rcp_f32 v61, v61
    v_rcp_f32 v62, v62
    v_rcp_f32 v63, v63
    v_rcp_f32 v64, v64
    v_rcp_f32 v65, v65
    v_rcp_f32 v66, v66
    v_rcp_f32 v67, v67
    v_mul_f32 v52, v52, v60
    v_mul_f32 v53, v53, v61
    v_mul_f32 v54, v54, v62
    v_mul_f32 v55, v55, v63
    v_mul_f32 v56, v56, v64
    v_mul_f32 v57, v57, v65
    v_mul_f32 v58, v58, v66
    v_mul_f32 v59, v59, v67
    v_cvt_pk_bf16_f32 v72, v52, v53
    v_cvt_pk_bf16_f32 v73, v54, v55
    v_cvt_pk_bf16_f32 v74, v56, v57
    v_cvt_pk_bf16_f32 v75, v58, v59
    ds_write_b64 v10, v[72:73] offset:4544
    ds_write_b64 v10, v[74:75] offset:4576
    s_waitcnt lgkmcnt(0)
    s_mov_b32 s40, 0
    s_mov_b32 s41, 23040
    s_mov_b32 s42, 46080
    s_mov_b32 s43, 69120
    buffer_store_dwordx4 v[124:127], v12, s[8:11], s40 offen sc1
    buffer_store_dwordx4 v[128:131], v12, s[8:11], s41 offen sc1
    buffer_store_dwordx4 v[132:135], v12, s[8:11], s42 offen sc1
    buffer_store_dwordx4 v[136:139], v12, s[8:11], s43 offen sc1
    ds_read_b128 v[156:159], v11 offset:4352
    ds_read_b128 v[160:163], v11 offset:5440
    ds_read_b128 v[164:167], v11 offset:6528
    ds_read_b128 v[168:171], v11 offset:7616
    v_cvt_pk_bf16_f32 v44, v188, v189
    v_cvt_pk_bf16_f32 v45, v190, v191
    v_cvt_pk_bf16_f32 v46, v192, v193
    v_cvt_pk_bf16_f32 v47, v194, v195
    v_lshlrev_b32 v28, 16, v44
    v_and_b32 v29, 0xffff0000, v44
    v_lshlrev_b32 v30, 16, v45
    v_and_b32 v31, 0xffff0000, v45
    v_lshlrev_b32 v32, 16, v46
    v_and_b32 v33, 0xffff0000, v46
    v_lshlrev_b32 v34, 16, v47
    v_and_b32 v35, 0xffff0000, v47
    v_mul_f32 v36, s48, v28
    v_mul_f32 v37, s48, v29
    v_mul_f32 v38, s48, v30
    v_mul_f32 v39, s48, v31
    v_mul_f32 v40, s48, v32
    v_mul_f32 v41, s48, v33
    v_mul_f32 v42, s48, v34
    v_mul_f32 v43, s48, v35
    v_exp_f32 v36, v36
    v_exp_f32 v37, v37
    v_exp_f32 v38, v38
    v_exp_f32 v39, v39
    v_exp_f32 v40, v40
    v_exp_f32 v41, v41
    v_exp_f32 v42, v42
    v_exp_f32 v43, v43
    v_add_f32 v36, 1.0, v36
    v_add_f32 v37, 1.0, v37
    v_add_f32 v38, 1.0, v38
    v_add_f32 v39, 1.0, v39
    v_add_f32 v40, 1.0, v40
    v_add_f32 v41, 1.0, v41
    v_add_f32 v42, 1.0, v42
    v_add_f32 v43, 1.0, v43
    v_rcp_f32 v36, v36
    v_rcp_f32 v37, v37
    v_rcp_f32 v38, v38
    v_rcp_f32 v39, v39
    v_rcp_f32 v40, v40
    v_rcp_f32 v41, v41
    v_rcp_f32 v42, v42
    v_rcp_f32 v43, v43
    v_mul_f32 v28, v28, v36
    v_mul_f32 v29, v29, v37
    v_mul_f32 v30, v30, v38
    v_mul_f32 v31, v31, v39
    v_mul_f32 v32, v32, v40
    v_mul_f32 v33, v33, v41
    v_mul_f32 v34, v34, v42
    v_mul_f32 v35, v35, v43
    v_cvt_pk_bf16_f32 v48, v28, v29
    v_cvt_pk_bf16_f32 v49, v30, v31
    v_cvt_pk_bf16_f32 v50, v32, v33
    v_cvt_pk_bf16_f32 v51, v34, v35
    ds_write_b64 v10, v[48:49] offset:8704
    ds_write_b64 v10, v[50:51] offset:8736
    v_cvt_pk_bf16_f32 v68, v196, v197
    v_cvt_pk_bf16_f32 v69, v198, v199
    v_cvt_pk_bf16_f32 v70, v200, v201
    v_cvt_pk_bf16_f32 v71, v202, v203
    v_lshlrev_b32 v52, 16, v68
    v_and_b32 v53, 0xffff0000, v68
    v_lshlrev_b32 v54, 16, v69
    v_and_b32 v55, 0xffff0000, v69
    v_lshlrev_b32 v56, 16, v70
    v_and_b32 v57, 0xffff0000, v70
    v_lshlrev_b32 v58, 16, v71
    v_and_b32 v59, 0xffff0000, v71
    v_mul_f32 v60, s48, v52
    v_mul_f32 v61, s48, v53
    v_mul_f32 v62, s48, v54
    v_mul_f32 v63, s48, v55
    v_mul_f32 v64, s48, v56
    v_mul_f32 v65, s48, v57
    v_mul_f32 v66, s48, v58
    v_mul_f32 v67, s48, v59
    v_exp_f32 v60, v60
    v_exp_f32 v61, v61
    v_exp_f32 v62, v62
    v_exp_f32 v63, v63
    v_exp_f32 v64, v64
    v_exp_f32 v65, v65
    v_exp_f32 v66, v66
    v_exp_f32 v67, v67
    v_add_f32 v60, 1.0, v60
    v_add_f32 v61, 1.0, v61
    v_add_f32 v62, 1.0, v62
    v_add_f32 v63, 1.0, v63
    v_add_f32 v64, 1.0, v64
    v_add_f32 v65, 1.0, v65
    v_add_f32 v66, 1.0, v66
    v_add_f32 v67, 1.0, v67
    v_rcp_f32 v60, v60
    v_rcp_f32 v61, v61
    v_rcp_f32 v62, v62
    v_rcp_f32 v63, v63
    v_rcp_f32 v64, v64
    v_rcp_f32 v65, v65
    v_rcp_f32 v66, v66
    v_rcp_f32 v67, v67
    v_mul_f32 v52, v52, v60
    v_mul_f32 v53, v53, v61
    v_mul_f32 v54, v54, v62
    v_mul_f32 v55, v55, v63
    v_mul_f32 v56, v56, v64
    v_mul_f32 v57, v57, v65
    v_mul_f32 v58, v58, v66
    v_mul_f32 v59, v59, v67
    v_cvt_pk_bf16_f32 v72, v52, v53
    v_cvt_pk_bf16_f32 v73, v54, v55
    v_cvt_pk_bf16_f32 v74, v56, v57
    v_cvt_pk_bf16_f32 v75, v58, v59
    ds_write_b64 v10, v[72:73] offset:8768
    ds_write_b64 v10, v[74:75] offset:8800
    v_cvt_pk_bf16_f32 v44, v204, v205
    v_cvt_pk_bf16_f32 v45, v206, v207
    v_cvt_pk_bf16_f32 v46, v208, v209
    v_cvt_pk_bf16_f32 v47, v210, v211
    v_lshlrev_b32 v28, 16, v44
    v_and_b32 v29, 0xffff0000, v44
    v_lshlrev_b32 v30, 16, v45
    v_and_b32 v31, 0xffff0000, v45
    v_lshlrev_b32 v32, 16, v46
    v_and_b32 v33, 0xffff0000, v46
    v_lshlrev_b32 v34, 16, v47
    v_and_b32 v35, 0xffff0000, v47
    v_mul_f32 v36, s48, v28
    v_mul_f32 v37, s48, v29
    v_mul_f32 v38, s48, v30
    v_mul_f32 v39, s48, v31
    v_mul_f32 v40, s48, v32
    v_mul_f32 v41, s48, v33
    v_mul_f32 v42, s48, v34
    v_mul_f32 v43, s48, v35
    v_exp_f32 v36, v36
    v_exp_f32 v37, v37
    v_exp_f32 v38, v38
    v_exp_f32 v39, v39
    v_exp_f32 v40, v40
    v_exp_f32 v41, v41
    v_exp_f32 v42, v42
    v_exp_f32 v43, v43
    v_add_f32 v36, 1.0, v36
    v_add_f32 v37, 1.0, v37
    v_add_f32 v38, 1.0, v38
    v_add_f32 v39, 1.0, v39
    v_add_f32 v40, 1.0, v40
    v_add_f32 v41, 1.0, v41
    v_add_f32 v42, 1.0, v42
    v_add_f32 v43, 1.0, v43
    v_rcp_f32 v36, v36
    v_rcp_f32 v37, v37
    v_rcp_f32 v38, v38
    v_rcp_f32 v39, v39
    v_rcp_f32 v40, v40
    v_rcp_f32 v41, v41
    v_rcp_f32 v42, v42
    v_rcp_f32 v43, v43
    v_mul_f32 v28, v28, v36
    v_mul_f32 v29, v29, v37
    v_mul_f32 v30, v30, v38
    v_mul_f32 v31, v31, v39
    v_mul_f32 v32, v32, v40
    v_mul_f32 v33, v33, v41
    v_mul_f32 v34, v34, v42
    v_mul_f32 v35, v35, v43
    v_cvt_pk_bf16_f32 v48, v28, v29
    v_cvt_pk_bf16_f32 v49, v30, v31
    v_cvt_pk_bf16_f32 v50, v32, v33
    v_cvt_pk_bf16_f32 v51, v34, v35
    ds_write_b64 v10, v[48:49] offset:8832
    ds_write_b64 v10, v[50:51] offset:8864
    v_cvt_pk_bf16_f32 v68, v212, v213
    v_cvt_pk_bf16_f32 v69, v214, v215
    v_cvt_pk_bf16_f32 v70, v216, v217
    v_cvt_pk_bf16_f32 v71, v218, v219
    v_lshlrev_b32 v52, 16, v68
    v_and_b32 v53, 0xffff0000, v68
    v_lshlrev_b32 v54, 16, v69
    v_and_b32 v55, 0xffff0000, v69
    v_lshlrev_b32 v56, 16, v70
    v_and_b32 v57, 0xffff0000, v70
    v_lshlrev_b32 v58, 16, v71
    v_and_b32 v59, 0xffff0000, v71
    v_mul_f32 v60, s48, v52
    v_mul_f32 v61, s48, v53
    v_mul_f32 v62, s48, v54
    v_mul_f32 v63, s48, v55
    v_mul_f32 v64, s48, v56
    v_mul_f32 v65, s48, v57
    v_mul_f32 v66, s48, v58
    v_mul_f32 v67, s48, v59
    v_exp_f32 v60, v60
    v_exp_f32 v61, v61
    v_exp_f32 v62, v62
    v_exp_f32 v63, v63
    v_exp_f32 v64, v64
    v_exp_f32 v65, v65
    v_exp_f32 v66, v66
    v_exp_f32 v67, v67
    v_add_f32 v60, 1.0, v60
    v_add_f32 v61, 1.0, v61
    v_add_f32 v62, 1.0, v62
    v_add_f32 v63, 1.0, v63
    v_add_f32 v64, 1.0, v64
    v_add_f32 v65, 1.0, v65
    v_add_f32 v66, 1.0, v66
    v_add_f32 v67, 1.0, v67
    v_rcp_f32 v60, v60
    v_rcp_f32 v61, v61
    v_rcp_f32 v62, v62
    v_rcp_f32 v63, v63
    v_rcp_f32 v64, v64
    v_rcp_f32 v65, v65
    v_rcp_f32 v66, v66
    v_rcp_f32 v67, v67
    v_mul_f32 v52, v52, v60
    v_mul_f32 v53, v53, v61
    v_mul_f32 v54, v54, v62
    v_mul_f32 v55, v55, v63
    v_mul_f32 v56, v56, v64
    v_mul_f32 v57, v57, v65
    v_mul_f32 v58, v58, v66
    v_mul_f32 v59, v59, v67
    v_cvt_pk_bf16_f32 v72, v52, v53
    v_cvt_pk_bf16_f32 v73, v54, v55
    v_cvt_pk_bf16_f32 v74, v56, v57
    v_cvt_pk_bf16_f32 v75, v58, v59
    ds_write_b64 v10, v[72:73] offset:8896
    ds_write_b64 v10, v[74:75] offset:8928
    s_waitcnt lgkmcnt(0)
    s_mov_b32 s40, 92160
    s_mov_b32 s41, 115200
    s_mov_b32 s42, 138240
    s_mov_b32 s43, 161280
    buffer_store_dwordx4 v[156:159], v12, s[8:11], s40 offen sc1
    buffer_store_dwordx4 v[160:163], v12, s[8:11], s41 offen sc1
    buffer_store_dwordx4 v[164:167], v12, s[8:11], s42 offen sc1
    buffer_store_dwordx4 v[168:171], v12, s[8:11], s43 offen sc1
    ds_read_b128 v[188:191], v11 offset:8704
    ds_read_b128 v[192:195], v11 offset:9792
    ds_read_b128 v[196:199], v11 offset:10880
    ds_read_b128 v[200:203], v11 offset:11968
    v_cvt_pk_bf16_f32 v44, v220, v221
    v_cvt_pk_bf16_f32 v45, v222, v223
    v_cvt_pk_bf16_f32 v46, v224, v225
    v_cvt_pk_bf16_f32 v47, v226, v227
    v_lshlrev_b32 v28, 16, v44
    v_and_b32 v29, 0xffff0000, v44
    v_lshlrev_b32 v30, 16, v45
    v_and_b32 v31, 0xffff0000, v45
    v_lshlrev_b32 v32, 16, v46
    v_and_b32 v33, 0xffff0000, v46
    v_lshlrev_b32 v34, 16, v47
    v_and_b32 v35, 0xffff0000, v47
    v_mul_f32 v36, s48, v28
    v_mul_f32 v37, s48, v29
    v_mul_f32 v38, s48, v30
    v_mul_f32 v39, s48, v31
    v_mul_f32 v40, s48, v32
    v_mul_f32 v41, s48, v33
    v_mul_f32 v42, s48, v34
    v_mul_f32 v43, s48, v35
    v_exp_f32 v36, v36
    v_exp_f32 v37, v37
    v_exp_f32 v38, v38
    v_exp_f32 v39, v39
    v_exp_f32 v40, v40
    v_exp_f32 v41, v41
    v_exp_f32 v42, v42
    v_exp_f32 v43, v43
    v_add_f32 v36, 1.0, v36
    v_add_f32 v37, 1.0, v37
    v_add_f32 v38, 1.0, v38
    v_add_f32 v39, 1.0, v39
    v_add_f32 v40, 1.0, v40
    v_add_f32 v41, 1.0, v41
    v_add_f32 v42, 1.0, v42
    v_add_f32 v43, 1.0, v43
    v_rcp_f32 v36, v36
    v_rcp_f32 v37, v37
    v_rcp_f32 v38, v38
    v_rcp_f32 v39, v39
    v_rcp_f32 v40, v40
    v_rcp_f32 v41, v41
    v_rcp_f32 v42, v42
    v_rcp_f32 v43, v43
    v_mul_f32 v28, v28, v36
    v_mul_f32 v29, v29, v37
    v_mul_f32 v30, v30, v38
    v_mul_f32 v31, v31, v39
    v_mul_f32 v32, v32, v40
    v_mul_f32 v33, v33, v41
    v_mul_f32 v34, v34, v42
    v_mul_f32 v35, v35, v43
    v_cvt_pk_bf16_f32 v48, v28, v29
    v_cvt_pk_bf16_f32 v49, v30, v31
    v_cvt_pk_bf16_f32 v50, v32, v33
    v_cvt_pk_bf16_f32 v51, v34, v35
    ds_write_b64 v10, v[48:49] offset:13056
    ds_write_b64 v10, v[50:51] offset:13088
    v_cvt_pk_bf16_f32 v68, v228, v229
    v_cvt_pk_bf16_f32 v69, v230, v231
    v_cvt_pk_bf16_f32 v70, v232, v233
    v_cvt_pk_bf16_f32 v71, v234, v235
    v_lshlrev_b32 v52, 16, v68
    v_and_b32 v53, 0xffff0000, v68
    v_lshlrev_b32 v54, 16, v69
    v_and_b32 v55, 0xffff0000, v69
    v_lshlrev_b32 v56, 16, v70
    v_and_b32 v57, 0xffff0000, v70
    v_lshlrev_b32 v58, 16, v71
    v_and_b32 v59, 0xffff0000, v71
    v_mul_f32 v60, s48, v52
    v_mul_f32 v61, s48, v53
    v_mul_f32 v62, s48, v54
    v_mul_f32 v63, s48, v55
    v_mul_f32 v64, s48, v56
    v_mul_f32 v65, s48, v57
    v_mul_f32 v66, s48, v58
    v_mul_f32 v67, s48, v59
    v_exp_f32 v60, v60
    v_exp_f32 v61, v61
    v_exp_f32 v62, v62
    v_exp_f32 v63, v63
    v_exp_f32 v64, v64
    v_exp_f32 v65, v65
    v_exp_f32 v66, v66
    v_exp_f32 v67, v67
    v_add_f32 v60, 1.0, v60
    v_add_f32 v61, 1.0, v61
    v_add_f32 v62, 1.0, v62
    v_add_f32 v63, 1.0, v63
    v_add_f32 v64, 1.0, v64
    v_add_f32 v65, 1.0, v65
    v_add_f32 v66, 1.0, v66
    v_add_f32 v67, 1.0, v67
    v_rcp_f32 v60, v60
    v_rcp_f32 v61, v61
    v_rcp_f32 v62, v62
    v_rcp_f32 v63, v63
    v_rcp_f32 v64, v64
    v_rcp_f32 v65, v65
    v_rcp_f32 v66, v66
    v_rcp_f32 v67, v67
    v_mul_f32 v52, v52, v60
    v_mul_f32 v53, v53, v61
    v_mul_f32 v54, v54, v62
    v_mul_f32 v55, v55, v63
    v_mul_f32 v56, v56, v64
    v_mul_f32 v57, v57, v65
    v_mul_f32 v58, v58, v66
    v_mul_f32 v59, v59, v67
    v_cvt_pk_bf16_f32 v72, v52, v53
    v_cvt_pk_bf16_f32 v73, v54, v55
    v_cvt_pk_bf16_f32 v74, v56, v57
    v_cvt_pk_bf16_f32 v75, v58, v59
    ds_write_b64 v10, v[72:73] offset:13120
    ds_write_b64 v10, v[74:75] offset:13152
    v_cvt_pk_bf16_f32 v44, v236, v237
    v_cvt_pk_bf16_f32 v45, v238, v239
    v_cvt_pk_bf16_f32 v46, v240, v241
    v_cvt_pk_bf16_f32 v47, v242, v243
    v_lshlrev_b32 v28, 16, v44
    v_and_b32 v29, 0xffff0000, v44
    v_lshlrev_b32 v30, 16, v45
    v_and_b32 v31, 0xffff0000, v45
    v_lshlrev_b32 v32, 16, v46
    v_and_b32 v33, 0xffff0000, v46
    v_lshlrev_b32 v34, 16, v47
    v_and_b32 v35, 0xffff0000, v47
    v_mul_f32 v36, s48, v28
    v_mul_f32 v37, s48, v29
    v_mul_f32 v38, s48, v30
    v_mul_f32 v39, s48, v31
    v_mul_f32 v40, s48, v32
    v_mul_f32 v41, s48, v33
    v_mul_f32 v42, s48, v34
    v_mul_f32 v43, s48, v35
    v_exp_f32 v36, v36
    v_exp_f32 v37, v37
    v_exp_f32 v38, v38
    v_exp_f32 v39, v39
    v_exp_f32 v40, v40
    v_exp_f32 v41, v41
    v_exp_f32 v42, v42
    v_exp_f32 v43, v43
    v_add_f32 v36, 1.0, v36
    v_add_f32 v37, 1.0, v37
    v_add_f32 v38, 1.0, v38
    v_add_f32 v39, 1.0, v39
    v_add_f32 v40, 1.0, v40
    v_add_f32 v41, 1.0, v41
    v_add_f32 v42, 1.0, v42
    v_add_f32 v43, 1.0, v43
    v_rcp_f32 v36, v36
    v_rcp_f32 v37, v37
    v_rcp_f32 v38, v38
    v_rcp_f32 v39, v39
    v_rcp_f32 v40, v40
    v_rcp_f32 v41, v41
    v_rcp_f32 v42, v42
    v_rcp_f32 v43, v43
    v_mul_f32 v28, v28, v36
    v_mul_f32 v29, v29, v37
    v_mul_f32 v30, v30, v38
    v_mul_f32 v31, v31, v39
    v_mul_f32 v32, v32, v40
    v_mul_f32 v33, v33, v41
    v_mul_f32 v34, v34, v42
    v_mul_f32 v35, v35, v43
    v_cvt_pk_bf16_f32 v48, v28, v29
    v_cvt_pk_bf16_f32 v49, v30, v31
    v_cvt_pk_bf16_f32 v50, v32, v33
    v_cvt_pk_bf16_f32 v51, v34, v35
    ds_write_b64 v10, v[48:49] offset:13184
    ds_write_b64 v10, v[50:51] offset:13216
    v_cvt_pk_bf16_f32 v68, v244, v245
    v_cvt_pk_bf16_f32 v69, v246, v247
    v_cvt_pk_bf16_f32 v70, v248, v249
    v_cvt_pk_bf16_f32 v71, v250, v251
    v_lshlrev_b32 v52, 16, v68
    v_and_b32 v53, 0xffff0000, v68
    v_lshlrev_b32 v54, 16, v69
    v_and_b32 v55, 0xffff0000, v69
    v_lshlrev_b32 v56, 16, v70
    v_and_b32 v57, 0xffff0000, v70
    v_lshlrev_b32 v58, 16, v71
    v_and_b32 v59, 0xffff0000, v71
    v_mul_f32 v60, s48, v52
    v_mul_f32 v61, s48, v53
    v_mul_f32 v62, s48, v54
    v_mul_f32 v63, s48, v55
    v_mul_f32 v64, s48, v56
    v_mul_f32 v65, s48, v57
    v_mul_f32 v66, s48, v58
    v_mul_f32 v67, s48, v59
    v_exp_f32 v60, v60
    v_exp_f32 v61, v61
    v_exp_f32 v62, v62
    v_exp_f32 v63, v63
    v_exp_f32 v64, v64
    v_exp_f32 v65, v65
    v_exp_f32 v66, v66
    v_exp_f32 v67, v67
    v_add_f32 v60, 1.0, v60
    v_add_f32 v61, 1.0, v61
    v_add_f32 v62, 1.0, v62
    v_add_f32 v63, 1.0, v63
    v_add_f32 v64, 1.0, v64
    v_add_f32 v65, 1.0, v65
    v_add_f32 v66, 1.0, v66
    v_add_f32 v67, 1.0, v67
    v_rcp_f32 v60, v60
    v_rcp_f32 v61, v61
    v_rcp_f32 v62, v62
    v_rcp_f32 v63, v63
    v_rcp_f32 v64, v64
    v_rcp_f32 v65, v65
    v_rcp_f32 v66, v66
    v_rcp_f32 v67, v67
    v_mul_f32 v52, v52, v60
    v_mul_f32 v53, v53, v61
    v_mul_f32 v54, v54, v62
    v_mul_f32 v55, v55, v63
    v_mul_f32 v56, v56, v64
    v_mul_f32 v57, v57, v65
    v_mul_f32 v58, v58, v66
    v_mul_f32 v59, v59, v67
    v_cvt_pk_bf16_f32 v72, v52, v53
    v_cvt_pk_bf16_f32 v73, v54, v55
    v_cvt_pk_bf16_f32 v74, v56, v57
    v_cvt_pk_bf16_f32 v75, v58, v59
    ds_write_b64 v10, v[72:73] offset:13248
    ds_write_b64 v10, v[74:75] offset:13280
    s_waitcnt lgkmcnt(0)
    s_mov_b32 s40, 184320
    s_mov_b32 s41, 207360
    s_mov_b32 s42, 230400
    s_mov_b32 s43, 253440
    buffer_store_dwordx4 v[188:191], v12, s[8:11], s40 offen sc1
    buffer_store_dwordx4 v[192:195], v12, s[8:11], s41 offen sc1
    buffer_store_dwordx4 v[196:199], v12, s[8:11], s42 offen sc1
    buffer_store_dwordx4 v[200:203], v12, s[8:11], s43 offen sc1
    ds_read_b128 v[220:223], v11 offset:13056
    ds_read_b128 v[224:227], v11 offset:14144
    ds_read_b128 v[228:231], v11 offset:15232
    ds_read_b128 v[232:235], v11 offset:16320
    s_waitcnt lgkmcnt(0)
    s_mov_b32 s40, 276480
    s_mov_b32 s41, 299520
    s_mov_b32 s42, 322560
    s_mov_b32 s43, 345600
    buffer_store_dwordx4 v[220:223], v12, s[8:11], s40 offen sc1
    buffer_store_dwordx4 v[224:227], v12, s[8:11], s41 offen sc1
    buffer_store_dwordx4 v[228:231], v12, s[8:11], s42 offen sc1
    buffer_store_dwordx4 v[232:235], v12, s[8:11], s43 offen sc1
    s_waitcnt vmcnt(0)
k1_exit:
    s_endpgm
k1_loader:
    s_sub_u32 s39, s32, 4
    s_lshl_b32 s39, s39, 1
    s_lshl_b32 s34, s39, 10
    s_add_u32 s28, s34, 1024
    s_cmp_ge_u32 s30, 10
    s_cbranch_scc1 k1_ldf
    s_mov_b32 s12, s68
    s_and_b32 s13, s69, 0xffff
    s_mov_b32 s14, 819200
    s_mov_b32 s15, 0x00020000
    s_mov_b32 s16, s70
    s_and_b32 s17, s71, 0xffff
    s_mov_b32 s18, 819200
    s_mov_b32 s19, 0x00020000
    s_add_u32 s29, s39, 0
    s_and_b32 s37, s29, 1
    s_lshl_b32 s38, s37, 2
    v_add_u32 v5, s38, v4
    v_and_b32 v5, 7, v5
    v_and_b32 v6, 7, v2
    v_xor_b32 v5, v5, v6
    v_lshlrev_b32 v5, 4, v5
    v_lshrrev_b32 v6, 3, v2
    s_lshl_b32 s38, s29, 3
    v_add_u32 v7, s38, v6
    v_lshrrev_b32 v8, 5, v2
    s_lshl_b32 s38, s37, 1
    v_add_u32 v8, s38, v8
    v_lshlrev_b32 v8, 3, v8
    v_and_b32 v9, 3, v6
    v_add_u32 v8, v8, v9
    s_lshr_b32 s38, s29, 1
    s_lshl_b32 s38, s38, 2
    v_add_u32 v8, s38, v8
    s_lshl_b32 s37, s31, 7
    v_add_u32 v9, s37, v8
    v_mul_lo_u32 v9, v9, s36
    v_add_u32 v9, v9, v5
    v_add_u32 v10, 0, v9
    v_add_u32 v11, 45056, v9
    v_add_u32 v12, 90112, v9
    v_add_u32 v13, 135168, v9
    s_mul_i32 s37, s30, 64
    v_add_u32 v9, s37, v7
    s_movk_i32 s37, 1280
    v_mul_lo_u32 v9, v9, s37
    v_add_u32 v9, v9, v5
    v_mov_b32 v14, v9
    v_add_u32 v15, 40960, v9
    v_mov_b32 v16, v9
    v_add_u32 v17, 40960, v9
    s_add_u32 s29, s39, 1
    s_and_b32 s37, s29, 1
    s_lshl_b32 s38, s37, 2
    v_add_u32 v5, s38, v4
    v_and_b32 v5, 7, v5
    v_and_b32 v6, 7, v2
    v_xor_b32 v5, v5, v6
    v_lshlrev_b32 v5, 4, v5
    v_lshrrev_b32 v6, 3, v2
    s_lshl_b32 s38, s29, 3
    v_add_u32 v7, s38, v6
    v_lshrrev_b32 v8, 5, v2
    s_lshl_b32 s38, s37, 1
    v_add_u32 v8, s38, v8
    v_lshlrev_b32 v8, 3, v8
    v_and_b32 v9, 3, v6
    v_add_u32 v8, v8, v9
    s_lshr_b32 s38, s29, 1
    s_lshl_b32 s38, s38, 2
    v_add_u32 v8, s38, v8
    s_lshl_b32 s37, s31, 7
    v_add_u32 v9, s37, v8
    v_mul_lo_u32 v9, v9, s36
    v_add_u32 v9, v9, v5
    v_add_u32 v18, 0, v9
    v_add_u32 v19, 45056, v9
    v_add_u32 v20, 90112, v9
    v_add_u32 v21, 135168, v9
    s_mul_i32 s37, s30, 64
    v_add_u32 v9, s37, v7
    s_movk_i32 s37, 1280
    v_mul_lo_u32 v9, v9, s37
    v_add_u32 v9, v9, v5
    v_mov_b32 v22, v9
    v_add_u32 v23, 40960, v9
    v_mov_b32 v24, v9
    v_add_u32 v25, 40960, v9
    s_movk_i32 s33, 0
    s_mov_b32 s35, 0
    s_add_u32 m0, s34, 0
    s_nop 0
    buffer_load_dwordx4 v10, s[8:11], s33 offen lds
    s_add_u32 m0, s28, 0
    s_nop 0
    buffer_load_dwordx4 v18, s[8:11], s33 offen lds
    s_add_u32 m0, s34, 4096
    s_nop 0
    buffer_load_dwordx4 v11, s[8:11], s33 offen lds
    s_add_u32 m0, s28, 4096
    s_nop 0
    buffer_load_dwordx4 v19, s[8:11], s33 offen lds
    s_add_u32 m0, s34, 8192
    s_nop 0
    buffer_load_dwordx4 v12, s[8:11], s33 offen lds
    s_add_u32 m0, s28, 8192
    s_nop 0
    buffer_load_dwordx4 v20, s[8:11], s33 offen lds
    s_add_u32 m0, s34, 12288
    s_nop 0
    buffer_load_dwordx4 v13, s[8:11], s33 offen lds
    s_add_u32 m0, s28, 12288
    s_nop 0
    buffer_load_dwordx4 v21, s[8:11], s33 offen lds
    s_add_u32 m0, s34, 16384
    s_nop 0
    buffer_load_dwordx4 v14, s[12:15], s33 offen lds
    s_add_u32 m0, s28, 16384
    s_nop 0
    buffer_load_dwordx4 v22, s[12:15], s33 offen lds
    s_add_u32 m0, s34, 20480
    s_nop 0
    buffer_load_dwordx4 v15, s[12:15], s33 offen lds
    s_add_u32 m0, s28, 20480
    s_nop 0
    buffer_load_dwordx4 v23, s[12:15], s33 offen lds
    s_add_u32 m0, s34, 24576
    s_nop 0
    buffer_load_dwordx4 v16, s[16:19], s33 offen lds
    s_add_u32 m0, s28, 24576
    s_nop 0
    buffer_load_dwordx4 v24, s[16:19], s33 offen lds
    s_add_u32 m0, s34, 28672
    s_nop 0
    buffer_load_dwordx4 v17, s[16:19], s33 offen lds
    s_add_u32 m0, s28, 28672
    s_nop 0
    buffer_load_dwordx4 v25, s[16:19], s33 offen lds
    s_movk_i32 s33, 128
    s_mov_b32 s35, 196608
    s_add_u32 m0, s34, 32768
    s_nop 0
    buffer_load_dwordx4 v10, s[8:11], s33 offen lds
    s_add_u32 m0, s28, 32768
    s_nop 0
    buffer_load_dwordx4 v18, s[8:11], s33 offen lds
    s_add_u32 m0, s34, 36864
    s_nop 0
    buffer_load_dwordx4 v11, s[8:11], s33 offen lds
    s_add_u32 m0, s28, 36864
    s_nop 0
    buffer_load_dwordx4 v19, s[8:11], s33 offen lds
    s_add_u32 m0, s34, 40960
    s_nop 0
    buffer_load_dwordx4 v12, s[8:11], s33 offen lds
    s_add_u32 m0, s28, 40960
    s_nop 0
    buffer_load_dwordx4 v20, s[8:11], s33 offen lds
    s_add_u32 m0, s34, 45056
    s_nop 0
    buffer_load_dwordx4 v13, s[8:11], s33 offen lds
    s_add_u32 m0, s28, 45056
    s_nop 0
    buffer_load_dwordx4 v21, s[8:11], s33 offen lds
    s_add_u32 m0, s34, 49152
    s_nop 0
    buffer_load_dwordx4 v14, s[12:15], s33 offen lds
    s_add_u32 m0, s28, 49152
    s_nop 0
    buffer_load_dwordx4 v22, s[12:15], s33 offen lds
    s_add_u32 m0, s34, 53248
    s_nop 0
    buffer_load_dwordx4 v15, s[12:15], s33 offen lds
    s_add_u32 m0, s28, 53248
    s_nop 0
    buffer_load_dwordx4 v23, s[12:15], s33 offen lds
    s_add_u32 m0, s34, 57344
    s_nop 0
    buffer_load_dwordx4 v16, s[16:19], s33 offen lds
    s_add_u32 m0, s28, 57344
    s_nop 0
    buffer_load_dwordx4 v24, s[16:19], s33 offen lds
    s_add_u32 m0, s34, 61440
    s_nop 0
    buffer_load_dwordx4 v17, s[16:19], s33 offen lds
    s_add_u32 m0, s28, 61440
    s_nop 0
    buffer_load_dwordx4 v25, s[16:19], s33 offen lds
    s_movk_i32 s33, 256
    s_mov_b32 s35, 393216
    s_add_u32 m0, s34, 65536
    s_nop 0
    buffer_load_dwordx4 v10, s[8:11], s33 offen lds
    s_add_u32 m0, s28, 65536
    s_nop 0
    buffer_load_dwordx4 v18, s[8:11], s33 offen lds
    s_add_u32 m0, s34, 69632
    s_nop 0
    buffer_load_dwordx4 v11, s[8:11], s33 offen lds
    s_add_u32 m0, s28, 69632
    s_nop 0
    buffer_load_dwordx4 v19, s[8:11], s33 offen lds
    s_add_u32 m0, s34, 73728
    s_nop 0
    buffer_load_dwordx4 v12, s[8:11], s33 offen lds
    s_add_u32 m0, s28, 73728
    s_nop 0
    buffer_load_dwordx4 v20, s[8:11], s33 offen lds
    s_add_u32 m0, s34, 77824
    s_nop 0
    buffer_load_dwordx4 v13, s[8:11], s33 offen lds
    s_add_u32 m0, s28, 77824
    s_nop 0
    buffer_load_dwordx4 v21, s[8:11], s33 offen lds
    s_add_u32 m0, s34, 81920
    s_nop 0
    buffer_load_dwordx4 v14, s[12:15], s33 offen lds
    s_add_u32 m0, s28, 81920
    s_nop 0
    buffer_load_dwordx4 v22, s[12:15], s33 offen lds
    s_add_u32 m0, s34, 86016
    s_nop 0
    buffer_load_dwordx4 v15, s[12:15], s33 offen lds
    s_add_u32 m0, s28, 86016
    s_nop 0
    buffer_load_dwordx4 v23, s[12:15], s33 offen lds
    s_add_u32 m0, s34, 90112
    s_nop 0
    buffer_load_dwordx4 v16, s[16:19], s33 offen lds
    s_add_u32 m0, s28, 90112
    s_nop 0
    buffer_load_dwordx4 v24, s[16:19], s33 offen lds
    s_add_u32 m0, s34, 94208
    s_nop 0
    buffer_load_dwordx4 v17, s[16:19], s33 offen lds
    s_add_u32 m0, s28, 94208
    s_nop 0
    buffer_load_dwordx4 v25, s[16:19], s33 offen lds
    s_waitcnt vmcnt(47)
    s_movk_i32 s33, 384
    s_mov_b32 s35, 589824
    s_add_u32 m0, s34, 98304
    s_nop 0
    buffer_load_dwordx4 v10, s[8:11], s33 offen lds
    s_add_u32 m0, s28, 98304
    s_nop 0
    buffer_load_dwordx4 v18, s[8:11], s33 offen lds
    s_add_u32 m0, s34, 102400
    s_nop 0
    buffer_load_dwordx4 v11, s[8:11], s33 offen lds
    s_add_u32 m0, s28, 102400
    s_nop 0
    buffer_load_dwordx4 v19, s[8:11], s33 offen lds
    s_add_u32 m0, s34, 106496
    s_nop 0
    buffer_load_dwordx4 v12, s[8:11], s33 offen lds
    s_add_u32 m0, s28, 106496
    s_nop 0
    buffer_load_dwordx4 v20, s[8:11], s33 offen lds
    s_add_u32 m0, s34, 110592
    s_nop 0
    buffer_load_dwordx4 v13, s[8:11], s33 offen lds
    s_add_u32 m0, s28, 110592
    s_nop 0
    buffer_load_dwordx4 v21, s[8:11], s33 offen lds
    s_add_u32 m0, s34, 114688
    s_nop 0
    buffer_load_dwordx4 v14, s[12:15], s33 offen lds
    s_add_u32 m0, s28, 114688
    s_nop 0
    buffer_load_dwordx4 v22, s[12:15], s33 offen lds
    s_add_u32 m0, s34, 118784
    s_nop 0
    buffer_load_dwordx4 v15, s[12:15], s33 offen lds
    s_add_u32 m0, s28, 118784
    s_nop 0
    buffer_load_dwordx4 v23, s[12:15], s33 offen lds
    s_add_u32 m0, s34, 122880
    s_nop 0
    buffer_load_dwordx4 v16, s[16:19], s33 offen lds
    s_add_u32 m0, s28, 122880
    s_nop 0
    buffer_load_dwordx4 v24, s[16:19], s33 offen lds
    s_add_u32 m0, s34, 126976
    s_nop 0
    buffer_load_dwordx4 v17, s[16:19], s33 offen lds
    s_add_u32 m0, s28, 126976
    s_nop 0
    buffer_load_dwordx4 v25, s[16:19], s33 offen lds
    s_waitcnt vmcnt(48)
    s_barrier
    s_waitcnt vmcnt(32)
    s_barrier
    s_movk_i32 s33, 512
    s_mov_b32 s35, 786432
    s_add_u32 m0, s34, 0
    s_nop 0
    buffer_load_dwordx4 v10, s[8:11], s33 offen lds
    s_add_u32 m0, s28, 0
    s_nop 0
    buffer_load_dwordx4 v18, s[8:11], s33 offen lds
    s_add_u32 m0, s34, 4096
    s_nop 0
    buffer_load_dwordx4 v11, s[8:11], s33 offen lds
    s_add_u32 m0, s28, 4096
    s_nop 0
    buffer_load_dwordx4 v19, s[8:11], s33 offen lds
    s_add_u32 m0, s34, 8192
    s_nop 0
    buffer_load_dwordx4 v12, s[8:11], s33 offen lds
    s_add_u32 m0, s28, 8192
    s_nop 0
    buffer_load_dwordx4 v20, s[8:11], s33 offen lds
    s_add_u32 m0, s34, 12288
    s_nop 0
    buffer_load_dwordx4 v13, s[8:11], s33 offen lds
    s_add_u32 m0, s28, 12288
    s_nop 0
    buffer_load_dwordx4 v21, s[8:11], s33 offen lds
    s_add_u32 m0, s34, 16384
    s_nop 0
    buffer_load_dwordx4 v14, s[12:15], s33 offen lds
    s_add_u32 m0, s28, 16384
    s_nop 0
    buffer_load_dwordx4 v22, s[12:15], s33 offen lds
    s_add_u32 m0, s34, 20480
    s_nop 0
    buffer_load_dwordx4 v15, s[12:15], s33 offen lds
    s_add_u32 m0, s28, 20480
    s_nop 0
    buffer_load_dwordx4 v23, s[12:15], s33 offen lds
    s_add_u32 m0, s34, 24576
    s_nop 0
    buffer_load_dwordx4 v16, s[16:19], s33 offen lds
    s_add_u32 m0, s28, 24576
    s_nop 0
    buffer_load_dwordx4 v24, s[16:19], s33 offen lds
    s_add_u32 m0, s34, 28672
    s_nop 0
    buffer_load_dwordx4 v17, s[16:19], s33 offen lds
    s_add_u32 m0, s28, 28672
    s_nop 0
    buffer_load_dwordx4 v25, s[16:19], s33 offen lds
    s_waitcnt vmcnt(32)
    s_barrier
    s_movk_i32 s33, 640
    s_mov_b32 s35, 983040
    s_add_u32 m0, s34, 32768
    s_nop 0
    buffer_load_dwordx4 v10, s[8:11], s33 offen lds
    s_add_u32 m0, s28, 32768
    s_nop 0
    buffer_load_dwordx4 v18, s[8:11], s33 offen lds
    s_add_u32 m0, s34, 36864
    s_nop 0
    buffer_load_dwordx4 v11, s[8:11], s33 offen lds
    s_add_u32 m0, s28, 36864
    s_nop 0
    buffer_load_dwordx4 v19, s[8:11], s33 offen lds
    s_add_u32 m0, s34, 40960
    s_nop 0
    buffer_load_dwordx4 v12, s[8:11], s33 offen lds
    s_add_u32 m0, s28, 40960
    s_nop 0
    buffer_load_dwordx4 v20, s[8:11], s33 offen lds
    s_add_u32 m0, s34, 45056
    s_nop 0
    buffer_load_dwordx4 v13, s[8:11], s33 offen lds
    s_add_u32 m0, s28, 45056
    s_nop 0
    buffer_load_dwordx4 v21, s[8:11], s33 offen lds
    s_add_u32 m0, s34, 49152
    s_nop 0
    buffer_load_dwordx4 v14, s[12:15], s33 offen lds
    s_add_u32 m0, s28, 49152
    s_nop 0
    buffer_load_dwordx4 v22, s[12:15], s33 offen lds
    s_add_u32 m0, s34, 53248
    s_nop 0
    buffer_load_dwordx4 v15, s[12:15], s33 offen lds
    s_add_u32 m0, s28, 53248
    s_nop 0
    buffer_load_dwordx4 v23, s[12:15], s33 offen lds
    s_add_u32 m0, s34, 57344
    s_nop 0
    buffer_load_dwordx4 v16, s[16:19], s33 offen lds
    s_add_u32 m0, s28, 57344
    s_nop 0
    buffer_load_dwordx4 v24, s[16:19], s33 offen lds
    s_add_u32 m0, s34, 61440
    s_nop 0
    buffer_load_dwordx4 v17, s[16:19], s33 offen lds
    s_add_u32 m0, s28, 61440
    s_nop 0
    buffer_load_dwordx4 v25, s[16:19], s33 offen lds
    s_waitcnt vmcnt(32)
    s_barrier
    s_movk_i32 s33, 768
    s_mov_b32 s35, 1179648
    s_add_u32 m0, s34, 65536
    s_nop 0
    buffer_load_dwordx4 v10, s[8:11], s33 offen lds
    s_add_u32 m0, s28, 65536
    s_nop 0
    buffer_load_dwordx4 v18, s[8:11], s33 offen lds
    s_add_u32 m0, s34, 69632
    s_nop 0
    buffer_load_dwordx4 v11, s[8:11], s33 offen lds
    s_add_u32 m0, s28, 69632
    s_nop 0
    buffer_load_dwordx4 v19, s[8:11], s33 offen lds
    s_add_u32 m0, s34, 73728
    s_nop 0
    buffer_load_dwordx4 v12, s[8:11], s33 offen lds
    s_add_u32 m0, s28, 73728
    s_nop 0
    buffer_load_dwordx4 v20, s[8:11], s33 offen lds
    s_add_u32 m0, s34, 77824
    s_nop 0
    buffer_load_dwordx4 v13, s[8:11], s33 offen lds
    s_add_u32 m0, s28, 77824
    s_nop 0
    buffer_load_dwordx4 v21, s[8:11], s33 offen lds
    s_add_u32 m0, s34, 81920
    s_nop 0
    buffer_load_dwordx4 v14, s[12:15], s33 offen lds
    s_add_u32 m0, s28, 81920
    s_nop 0
    buffer_load_dwordx4 v22, s[12:15], s33 offen lds
    s_add_u32 m0, s34, 86016
    s_nop 0
    buffer_load_dwordx4 v15, s[12:15], s33 offen lds
    s_add_u32 m0, s28, 86016
    s_nop 0
    buffer_load_dwordx4 v23, s[12:15], s33 offen lds
    s_add_u32 m0, s34, 90112
    s_nop 0
    buffer_load_dwordx4 v16, s[16:19], s33 offen lds
    s_add_u32 m0, s28, 90112
    s_nop 0
    buffer_load_dwordx4 v24, s[16:19], s33 offen lds
    s_add_u32 m0, s34, 94208
    s_nop 0
    buffer_load_dwordx4 v17, s[16:19], s33 offen lds
    s_add_u32 m0, s28, 94208
    s_nop 0
    buffer_load_dwordx4 v25, s[16:19], s33 offen lds
    s_waitcnt vmcnt(32)
    s_barrier
    s_movk_i32 s33, 896
    s_mov_b32 s35, 1376256
    s_add_u32 m0, s34, 98304
    s_nop 0
    buffer_load_dwordx4 v10, s[8:11], s33 offen lds
    s_add_u32 m0, s28, 98304
    s_nop 0
    buffer_load_dwordx4 v18, s[8:11], s33 offen lds
    s_add_u32 m0, s34, 102400
    s_nop 0
    buffer_load_dwordx4 v11, s[8:11], s33 offen lds
    s_add_u32 m0, s28, 102400
    s_nop 0
    buffer_load_dwordx4 v19, s[8:11], s33 offen lds
    s_add_u32 m0, s34, 106496
    s_nop 0
    buffer_load_dwordx4 v12, s[8:11], s33 offen lds
    s_add_u32 m0, s28, 106496
    s_nop 0
    buffer_load_dwordx4 v20, s[8:11], s33 offen lds
    s_add_u32 m0, s34, 110592
    s_nop 0
    buffer_load_dwordx4 v13, s[8:11], s33 offen lds
    s_add_u32 m0, s28, 110592
    s_nop 0
    buffer_load_dwordx4 v21, s[8:11], s33 offen lds
    s_add_u32 m0, s34, 114688
    s_nop 0
    buffer_load_dwordx4 v14, s[12:15], s33 offen lds
    s_add_u32 m0, s28, 114688
    s_nop 0
    buffer_load_dwordx4 v22, s[12:15], s33 offen lds
    s_add_u32 m0, s34, 118784
    s_nop 0
    buffer_load_dwordx4 v15, s[12:15], s33 offen lds
    s_add_u32 m0, s28, 118784
    s_nop 0
    buffer_load_dwordx4 v23, s[12:15], s33 offen lds
    s_add_u32 m0, s34, 122880
    s_nop 0
    buffer_load_dwordx4 v16, s[16:19], s33 offen lds
    s_add_u32 m0, s28, 122880
    s_nop 0
    buffer_load_dwordx4 v24, s[16:19], s33 offen lds
    s_add_u32 m0, s34, 126976
    s_nop 0
    buffer_load_dwordx4 v17, s[16:19], s33 offen lds
    s_add_u32 m0, s28, 126976
    s_nop 0
    buffer_load_dwordx4 v25, s[16:19], s33 offen lds
    s_waitcnt vmcnt(32)
    s_barrier
    s_movk_i32 s33, 1024
    s_mov_b32 s35, 1572864
    s_add_u32 m0, s34, 0
    s_nop 0
    buffer_load_dwordx4 v10, s[8:11], s33 offen lds
    s_add_u32 m0, s28, 0
    s_nop 0
    buffer_load_dwordx4 v18, s[8:11], s33 offen lds
    s_add_u32 m0, s34, 4096
    s_nop 0
    buffer_load_dwordx4 v11, s[8:11], s33 offen lds
    s_add_u32 m0, s28, 4096
    s_nop 0
    buffer_load_dwordx4 v19, s[8:11], s33 offen lds
    s_add_u32 m0, s34, 8192
    s_nop 0
    buffer_load_dwordx4 v12, s[8:11], s33 offen lds
    s_add_u32 m0, s28, 8192
    s_nop 0
    buffer_load_dwordx4 v20, s[8:11], s33 offen lds
    s_add_u32 m0, s34, 12288
    s_nop 0
    buffer_load_dwordx4 v13, s[8:11], s33 offen lds
    s_add_u32 m0, s28, 12288
    s_nop 0
    buffer_load_dwordx4 v21, s[8:11], s33 offen lds
    s_add_u32 m0, s34, 16384
    s_nop 0
    buffer_load_dwordx4 v14, s[12:15], s33 offen lds
    s_add_u32 m0, s28, 16384
    s_nop 0
    buffer_load_dwordx4 v22, s[12:15], s33 offen lds
    s_add_u32 m0, s34, 20480
    s_nop 0
    buffer_load_dwordx4 v15, s[12:15], s33 offen lds
    s_add_u32 m0, s28, 20480
    s_nop 0
    buffer_load_dwordx4 v23, s[12:15], s33 offen lds
    s_add_u32 m0, s34, 24576
    s_nop 0
    buffer_load_dwordx4 v16, s[16:19], s33 offen lds
    s_add_u32 m0, s28, 24576
    s_nop 0
    buffer_load_dwordx4 v24, s[16:19], s33 offen lds
    s_add_u32 m0, s34, 28672
    s_nop 0
    buffer_load_dwordx4 v17, s[16:19], s33 offen lds
    s_add_u32 m0, s28, 28672
    s_nop 0
    buffer_load_dwordx4 v25, s[16:19], s33 offen lds
    s_waitcnt vmcnt(32)
    s_barrier
    s_movk_i32 s33, 1152
    s_mov_b32 s35, 1769472
    s_add_u32 m0, s34, 32768
    s_nop 0
    buffer_load_dwordx4 v10, s[8:11], s33 offen lds
    s_add_u32 m0, s28, 32768
    s_nop 0
    buffer_load_dwordx4 v18, s[8:11], s33 offen lds
    s_add_u32 m0, s34, 36864
    s_nop 0
    buffer_load_dwordx4 v11, s[8:11], s33 offen lds
    s_add_u32 m0, s28, 36864
    s_nop 0
    buffer_load_dwordx4 v19, s[8:11], s33 offen lds
    s_add_u32 m0, s34, 40960
    s_nop 0
    buffer_load_dwordx4 v12, s[8:11], s33 offen lds
    s_add_u32 m0, s28, 40960
    s_nop 0
    buffer_load_dwordx4 v20, s[8:11], s33 offen lds
    s_add_u32 m0, s34, 45056
    s_nop 0
    buffer_load_dwordx4 v13, s[8:11], s33 offen lds
    s_add_u32 m0, s28, 45056
    s_nop 0
    buffer_load_dwordx4 v21, s[8:11], s33 offen lds
    s_add_u32 m0, s34, 49152
    s_nop 0
    buffer_load_dwordx4 v14, s[12:15], s33 offen lds
    s_add_u32 m0, s28, 49152
    s_nop 0
    buffer_load_dwordx4 v22, s[12:15], s33 offen lds
    s_add_u32 m0, s34, 53248
    s_nop 0
    buffer_load_dwordx4 v15, s[12:15], s33 offen lds
    s_add_u32 m0, s28, 53248
    s_nop 0
    buffer_load_dwordx4 v23, s[12:15], s33 offen lds
    s_add_u32 m0, s34, 57344
    s_nop 0
    buffer_load_dwordx4 v16, s[16:19], s33 offen lds
    s_add_u32 m0, s28, 57344
    s_nop 0
    buffer_load_dwordx4 v24, s[16:19], s33 offen lds
    s_add_u32 m0, s34, 61440
    s_nop 0
    buffer_load_dwordx4 v17, s[16:19], s33 offen lds
    s_add_u32 m0, s28, 61440
    s_nop 0
    buffer_load_dwordx4 v25, s[16:19], s33 offen lds
    s_waitcnt vmcnt(32)
    s_barrier
    s_waitcnt vmcnt(16)
    s_barrier
    s_waitcnt vmcnt(0)
    s_barrier
    s_endpgm
k1_ldf:
    s_sub_u32 s30, s30, 10
    s_mov_b32 s12, s78
    s_and_b32 s13, s79, 0xffff
    s_mov_b32 s14, 1966080
    s_mov_b32 s15, 0x00020000
    s_add_u32 s29, s39, 0
    s_and_b32 s37, s29, 1
    s_lshl_b32 s38, s37, 2
    v_add_u32 v5, s38, v4
    v_and_b32 v5, 7, v5
    v_and_b32 v6, 7, v2
    v_xor_b32 v5, v5, v6
    v_lshlrev_b32 v5, 4, v5
    v_lshrrev_b32 v6, 3, v2
    s_lshl_b32 s38, s29, 3
    v_add_u32 v7, s38, v6
    v_lshrrev_b32 v8, 5, v2
    s_lshl_b32 s38, s37, 1
    v_add_u32 v8, s38, v8
    v_lshlrev_b32 v8, 3, v8
    v_and_b32 v9, 3, v6
    v_add_u32 v8, v8, v9
    s_lshr_b32 s38, s29, 1
    s_lshl_b32 s38, s38, 2
    v_add_u32 v8, s38, v8
    s_lshl_b32 s37, s31, 7
    v_add_u32 v9, s37, v7
    v_mul_lo_u32 v9, v9, s36
    v_add_u32 v9, v9, v5
    v_add_u32 v10, 0, v9
    v_add_u32 v11, 45056, v9
    v_add_u32 v12, 90112, v9
    v_add_u32 v13, 135168, v9
    v_and_b32 v7, 7, v2
    v_lshrrev_b32 v8, 1, v6
    v_and_b32 v8, 1, v8
    s_movk_i32 s37, 3072
    v_mul_lo_u32 v9, v6, s37
    s_lshl_b32 s38, s30, 9
    s_lshl_b32 s40, s29, 7
    s_add_u32 s38, s38, s40
    v_add_u32 v9, s38, v9
    v_or_b32 v5, 0, v8
    v_lshlrev_b32 v5, 1, v5
    v_xor_b32 v5, v5, v7
    v_lshl_add_u32 v5, v5, 4, v9
    v_add_u32 v14, 0, v5
    v_add_u32 v16, 49152, v5
    v_add_u32 v18, 98304, v5
    v_add_u32 v20, 147456, v5
    v_or_b32 v5, 2, v8
    v_lshlrev_b32 v5, 1, v5
    v_xor_b32 v5, v5, v7
    v_lshl_add_u32 v5, v5, 4, v9
    v_add_u32 v15, 24576, v5
    v_add_u32 v17, 73728, v5
    v_add_u32 v19, 122880, v5
    v_add_u32 v21, 172032, v5
    s_add_u32 s29, s39, 1
    s_and_b32 s37, s29, 1
    s_lshl_b32 s38, s37, 2
    v_add_u32 v5, s38, v4
    v_and_b32 v5, 7, v5
    v_and_b32 v6, 7, v2
    v_xor_b32 v5, v5, v6
    v_lshlrev_b32 v5, 4, v5
    v_lshrrev_b32 v6, 3, v2
    s_lshl_b32 s38, s29, 3
    v_add_u32 v7, s38, v6
    v_lshrrev_b32 v8, 5, v2
    s_lshl_b32 s38, s37, 1
    v_add_u32 v8, s38, v8
    v_lshlrev_b32 v8, 3, v8
    v_and_b32 v9, 3, v6
    v_add_u32 v8, v8, v9
    s_lshr_b32 s38, s29, 1
    s_lshl_b32 s38, s38, 2
    v_add_u32 v8, s38, v8
    s_lshl_b32 s37, s31, 7
    v_add_u32 v9, s37, v7
    v_mul_lo_u32 v9, v9, s36
    v_add_u32 v9, v9, v5
    v_add_u32 v22, 0, v9
    v_add_u32 v23, 45056, v9
    v_add_u32 v24, 90112, v9
    v_add_u32 v25, 135168, v9
    v_and_b32 v7, 7, v2
    v_lshrrev_b32 v8, 1, v6
    v_and_b32 v8, 1, v8
    s_movk_i32 s37, 3072
    v_mul_lo_u32 v9, v6, s37
    s_lshl_b32 s38, s30, 9
    s_lshl_b32 s40, s29, 7
    s_add_u32 s38, s38, s40
    v_add_u32 v9, s38, v9
    v_or_b32 v5, 0, v8
    v_lshlrev_b32 v5, 1, v5
    v_xor_b32 v5, v5, v7
    v_lshl_add_u32 v5, v5, 4, v9
    v_add_u32 v26, 0, v5
    v_add_u32 v28, 49152, v5
    v_add_u32 v30, 98304, v5
    v_add_u32 v32, 147456, v5
    v_or_b32 v5, 2, v8
    v_lshlrev_b32 v5, 1, v5
    v_xor_b32 v5, v5, v7
    v_lshl_add_u32 v5, v5, 4, v9
    v_add_u32 v27, 24576, v5
    v_add_u32 v29, 73728, v5
    v_add_u32 v31, 122880, v5
    v_add_u32 v33, 172032, v5
    s_movk_i32 s33, 0
    s_mov_b32 s35, 0
    s_add_u32 m0, s34, 0
    s_nop 0
    buffer_load_dwordx4 v10, s[8:11], s33 offen lds
    s_add_u32 m0, s28, 0
    s_nop 0
    buffer_load_dwordx4 v22, s[8:11], s33 offen lds
    s_add_u32 m0, s34, 4096
    s_nop 0
    buffer_load_dwordx4 v11, s[8:11], s33 offen lds
    s_add_u32 m0, s28, 4096
    s_nop 0
    buffer_load_dwordx4 v23, s[8:11], s33 offen lds
    s_add_u32 m0, s34, 8192
    s_nop 0
    buffer_load_dwordx4 v12, s[8:11], s33 offen lds
    s_add_u32 m0, s28, 8192
    s_nop 0
    buffer_load_dwordx4 v24, s[8:11], s33 offen lds
    s_add_u32 m0, s34, 12288
    s_nop 0
    buffer_load_dwordx4 v13, s[8:11], s33 offen lds
    s_add_u32 m0, s28, 12288
    s_nop 0
    buffer_load_dwordx4 v25, s[8:11], s33 offen lds
    s_add_u32 m0, s34, 16384
    s_nop 0
    buffer_load_dwordx4 v14, s[12:15], s35 offen lds
    s_add_u32 m0, s28, 16384
    s_nop 0
    buffer_load_dwordx4 v26, s[12:15], s35 offen lds
    s_add_u32 m0, s34, 20480
    s_nop 0
    buffer_load_dwordx4 v15, s[12:15], s35 offen lds
    s_add_u32 m0, s28, 20480
    s_nop 0
    buffer_load_dwordx4 v27, s[12:15], s35 offen lds
    s_add_u32 m0, s34, 24576
    s_nop 0
    buffer_load_dwordx4 v16, s[12:15], s35 offen lds
    s_add_u32 m0, s28, 24576
    s_nop 0
    buffer_load_dwordx4 v28, s[12:15], s35 offen lds
    s_add_u32 m0, s34, 28672
    s_nop 0
    buffer_load_dwordx4 v17, s[12:15], s35 offen lds
    s_add_u32 m0, s28, 28672
    s_nop 0
    buffer_load_dwordx4 v29, s[12:15], s35 offen lds
    s_add_u32 m0, s34, 32768
    s_nop 0
    buffer_load_dwordx4 v18, s[12:15], s35 offen lds
    s_add_u32 m0, s28, 32768
    s_nop 0
    buffer_load_dwordx4 v30, s[12:15], s35 offen lds
    s_add_u32 m0, s34, 36864
    s_nop 0
    buffer_load_dwordx4 v19, s[12:15], s35 offen lds
    s_add_u32 m0, s28, 36864
    s_nop 0
    buffer_load_dwordx4 v31, s[12:15], s35 offen lds
    s_add_u32 m0, s34, 40960
    s_nop 0
    buffer_load_dwordx4 v20, s[12:15], s35 offen lds
    s_add_u32 m0, s28, 40960
    s_nop 0
    buffer_load_dwordx4 v32, s[12:15], s35 offen lds
    s_add_u32 m0, s34, 45056
    s_nop 0
    buffer_load_dwordx4 v21, s[12:15], s35 offen lds
    s_add_u32 m0, s28, 45056
    s_nop 0
    buffer_load_dwordx4 v33, s[12:15], s35 offen lds
    s_movk_i32 s33, 128
    s_mov_b32 s35, 196608
    s_add_u32 m0, s34, 49152
    s_nop 0
    buffer_load_dwordx4 v10, s[8:11], s33 offen lds
    s_add_u32 m0, s28, 49152
    s_nop 0
    buffer_load_dwordx4 v22, s[8:11], s33 offen lds
    s_add_u32 m0, s34, 53248
    s_nop 0
    buffer_load_dwordx4 v11, s[8:11], s33 offen lds
    s_add_u32 m0, s28, 53248
    s_nop 0
    buffer_load_dwordx4 v23, s[8:11], s33 offen lds
    s_add_u32 m0, s34, 57344
    s_nop 0
    buffer_load_dwordx4 v12, s[8:11], s33 offen lds
    s_add_u32 m0, s28, 57344
    s_nop 0
    buffer_load_dwordx4 v24, s[8:11], s33 offen lds
    s_add_u32 m0, s34, 61440
    s_nop 0
    buffer_load_dwordx4 v13, s[8:11], s33 offen lds
    s_add_u32 m0, s28, 61440
    s_nop 0
    buffer_load_dwordx4 v25, s[8:11], s33 offen lds
    s_add_u32 m0, s34, 65536
    s_nop 0
    buffer_load_dwordx4 v14, s[12:15], s35 offen lds
    s_add_u32 m0, s28, 65536
    s_nop 0
    buffer_load_dwordx4 v26, s[12:15], s35 offen lds
    s_add_u32 m0, s34, 69632
    s_nop 0
    buffer_load_dwordx4 v15, s[12:15], s35 offen lds
    s_add_u32 m0, s28, 69632
    s_nop 0
    buffer_load_dwordx4 v27, s[12:15], s35 offen lds
    s_add_u32 m0, s34, 73728
    s_nop 0
    buffer_load_dwordx4 v16, s[12:15], s35 offen lds
    s_add_u32 m0, s28, 73728
    s_nop 0
    buffer_load_dwordx4 v28, s[12:15], s35 offen lds
    s_add_u32 m0, s34, 77824
    s_nop 0
    buffer_load_dwordx4 v17, s[12:15], s35 offen lds
    s_add_u32 m0, s28, 77824
    s_nop 0
    buffer_load_dwordx4 v29, s[12:15], s35 offen lds
    s_add_u32 m0, s34, 81920
    s_nop 0
    buffer_load_dwordx4 v18, s[12:15], s35 offen lds
    s_add_u32 m0, s28, 81920
    s_nop 0
    buffer_load_dwordx4 v30, s[12:15], s35 offen lds
    s_add_u32 m0, s34, 86016
    s_nop 0
    buffer_load_dwordx4 v19, s[12:15], s35 offen lds
    s_add_u32 m0, s28, 86016
    s_nop 0
    buffer_load_dwordx4 v31, s[12:15], s35 offen lds
    s_add_u32 m0, s34, 90112
    s_nop 0
    buffer_load_dwordx4 v20, s[12:15], s35 offen lds
    s_add_u32 m0, s28, 90112
    s_nop 0
    buffer_load_dwordx4 v32, s[12:15], s35 offen lds
    s_add_u32 m0, s34, 94208
    s_nop 0
    buffer_load_dwordx4 v21, s[12:15], s35 offen lds
    s_add_u32 m0, s28, 94208
    s_nop 0
    buffer_load_dwordx4 v33, s[12:15], s35 offen lds
    s_waitcnt vmcnt(39)
    s_movk_i32 s33, 256
    s_mov_b32 s35, 393216
    s_add_u32 m0, s34, 98304
    s_nop 0
    buffer_load_dwordx4 v10, s[8:11], s33 offen lds
    s_add_u32 m0, s28, 98304
    s_nop 0
    buffer_load_dwordx4 v22, s[8:11], s33 offen lds
    s_add_u32 m0, s34, 102400
    s_nop 0
    buffer_load_dwordx4 v11, s[8:11], s33 offen lds
    s_add_u32 m0, s28, 102400
    s_nop 0
    buffer_load_dwordx4 v23, s[8:11], s33 offen lds
    s_add_u32 m0, s34, 106496
    s_nop 0
    buffer_load_dwordx4 v12, s[8:11], s33 offen lds
    s_add_u32 m0, s28, 106496
    s_nop 0
    buffer_load_dwordx4 v24, s[8:11], s33 offen lds
    s_add_u32 m0, s34, 110592
    s_nop 0
    buffer_load_dwordx4 v13, s[8:11], s33 offen lds
    s_add_u32 m0, s28, 110592
    s_nop 0
    buffer_load_dwordx4 v25, s[8:11], s33 offen lds
    s_add_u32 m0, s34, 114688
    s_nop 0
    buffer_load_dwordx4 v14, s[12:15], s35 offen lds
    s_add_u32 m0, s28, 114688
    s_nop 0
    buffer_load_dwordx4 v26, s[12:15], s35 offen lds
    s_add_u32 m0, s34, 118784
    s_nop 0
    buffer_load_dwordx4 v15, s[12:15], s35 offen lds
    s_add_u32 m0, s28, 118784
    s_nop 0
    buffer_load_dwordx4 v27, s[12:15], s35 offen lds
    s_add_u32 m0, s34, 122880
    s_nop 0
    buffer_load_dwordx4 v16, s[12:15], s35 offen lds
    s_add_u32 m0, s28, 122880
    s_nop 0
    buffer_load_dwordx4 v28, s[12:15], s35 offen lds
    s_add_u32 m0, s34, 126976
    s_nop 0
    buffer_load_dwordx4 v17, s[12:15], s35 offen lds
    s_add_u32 m0, s28, 126976
    s_nop 0
    buffer_load_dwordx4 v29, s[12:15], s35 offen lds
    s_add_u32 m0, s34, 131072
    s_nop 0
    buffer_load_dwordx4 v18, s[12:15], s35 offen lds
    s_add_u32 m0, s28, 131072
    s_nop 0
    buffer_load_dwordx4 v30, s[12:15], s35 offen lds
    s_add_u32 m0, s34, 135168
    s_nop 0
    buffer_load_dwordx4 v19, s[12:15], s35 offen lds
    s_add_u32 m0, s28, 135168
    s_nop 0
    buffer_load_dwordx4 v31, s[12:15], s35 offen lds
    s_add_u32 m0, s34, 139264
    s_nop 0
    buffer_load_dwordx4 v20, s[12:15], s35 offen lds
    s_add_u32 m0, s28, 139264
    s_nop 0
    buffer_load_dwordx4 v32, s[12:15], s35 offen lds
    s_add_u32 m0, s34, 143360
    s_nop 0
    buffer_load_dwordx4 v21, s[12:15], s35 offen lds
    s_add_u32 m0, s28, 143360
    s_nop 0
    buffer_load_dwordx4 v33, s[12:15], s35 offen lds
    s_waitcnt vmcnt(48)
    s_barrier
    s_waitcnt vmcnt(24)
    s_barrier
    s_movk_i32 s33, 384
    s_mov_b32 s35, 589824
    s_add_u32 m0, s34, 0
    s_nop 0
    buffer_load_dwordx4 v10, s[8:11], s33 offen lds
    s_add_u32 m0, s28, 0
    s_nop 0
    buffer_load_dwordx4 v22, s[8:11], s33 offen lds
    s_add_u32 m0, s34, 4096
    s_nop 0
    buffer_load_dwordx4 v11, s[8:11], s33 offen lds
    s_add_u32 m0, s28, 4096
    s_nop 0
    buffer_load_dwordx4 v23, s[8:11], s33 offen lds
    s_add_u32 m0, s34, 8192
    s_nop 0
    buffer_load_dwordx4 v12, s[8:11], s33 offen lds
    s_add_u32 m0, s28, 8192
    s_nop 0
    buffer_load_dwordx4 v24, s[8:11], s33 offen lds
    s_add_u32 m0, s34, 12288
    s_nop 0
    buffer_load_dwordx4 v13, s[8:11], s33 offen lds
    s_add_u32 m0, s28, 12288
    s_nop 0
    buffer_load_dwordx4 v25, s[8:11], s33 offen lds
    s_add_u32 m0, s34, 16384
    s_nop 0
    buffer_load_dwordx4 v14, s[12:15], s35 offen lds
    s_add_u32 m0, s28, 16384
    s_nop 0
    buffer_load_dwordx4 v26, s[12:15], s35 offen lds
    s_add_u32 m0, s34, 20480
    s_nop 0
    buffer_load_dwordx4 v15, s[12:15], s35 offen lds
    s_add_u32 m0, s28, 20480
    s_nop 0
    buffer_load_dwordx4 v27, s[12:15], s35 offen lds
    s_add_u32 m0, s34, 24576
    s_nop 0
    buffer_load_dwordx4 v16, s[12:15], s35 offen lds
    s_add_u32 m0, s28, 24576
    s_nop 0
    buffer_load_dwordx4 v28, s[12:15], s35 offen lds
    s_add_u32 m0, s34, 28672
    s_nop 0
    buffer_load_dwordx4 v17, s[12:15], s35 offen lds
    s_add_u32 m0, s28, 28672
    s_nop 0
    buffer_load_dwordx4 v29, s[12:15], s35 offen lds
    s_add_u32 m0, s34, 32768
    s_nop 0
    buffer_load_dwordx4 v18, s[12:15], s35 offen lds
    s_add_u32 m0, s28, 32768
    s_nop 0
    buffer_load_dwordx4 v30, s[12:15], s35 offen lds
    s_add_u32 m0, s34, 36864
    s_nop 0
    buffer_load_dwordx4 v19, s[12:15], s35 offen lds
    s_add_u32 m0, s28, 36864
    s_nop 0
    buffer_load_dwordx4 v31, s[12:15], s35 offen lds
    s_add_u32 m0, s34, 40960
    s_nop 0
    buffer_load_dwordx4 v20, s[12:15], s35 offen lds
    s_add_u32 m0, s28, 40960
    s_nop 0
    buffer_load_dwordx4 v32, s[12:15], s35 offen lds
    s_add_u32 m0, s34, 45056
    s_nop 0
    buffer_load_dwordx4 v21, s[12:15], s35 offen lds
    s_add_u32 m0, s28, 45056
    s_nop 0
    buffer_load_dwordx4 v33, s[12:15], s35 offen lds
    s_waitcnt vmcnt(24)
    s_barrier
    s_movk_i32 s33, 512
    s_mov_b32 s35, 786432
    s_add_u32 m0, s34, 49152
    s_nop 0
    buffer_load_dwordx4 v10, s[8:11], s33 offen lds
    s_add_u32 m0, s28, 49152
    s_nop 0
    buffer_load_dwordx4 v22, s[8:11], s33 offen lds
    s_add_u32 m0, s34, 53248
    s_nop 0
    buffer_load_dwordx4 v11, s[8:11], s33 offen lds
    s_add_u32 m0, s28, 53248
    s_nop 0
    buffer_load_dwordx4 v23, s[8:11], s33 offen lds
    s_add_u32 m0, s34, 57344
    s_nop 0
    buffer_load_dwordx4 v12, s[8:11], s33 offen lds
    s_add_u32 m0, s28, 57344
    s_nop 0
    buffer_load_dwordx4 v24, s[8:11], s33 offen lds
    s_add_u32 m0, s34, 61440
    s_nop 0
    buffer_load_dwordx4 v13, s[8:11], s33 offen lds
    s_add_u32 m0, s28, 61440
    s_nop 0
    buffer_load_dwordx4 v25, s[8:11], s33 offen lds
    s_add_u32 m0, s34, 65536
    s_nop 0
    buffer_load_dwordx4 v14, s[12:15], s35 offen lds
    s_add_u32 m0, s28, 65536
    s_nop 0
    buffer_load_dwordx4 v26, s[12:15], s35 offen lds
    s_add_u32 m0, s34, 69632
    s_nop 0
    buffer_load_dwordx4 v15, s[12:15], s35 offen lds
    s_add_u32 m0, s28, 69632
    s_nop 0
    buffer_load_dwordx4 v27, s[12:15], s35 offen lds
    s_add_u32 m0, s34, 73728
    s_nop 0
    buffer_load_dwordx4 v16, s[12:15], s35 offen lds
    s_add_u32 m0, s28, 73728
    s_nop 0
    buffer_load_dwordx4 v28, s[12:15], s35 offen lds
    s_add_u32 m0, s34, 77824
    s_nop 0
    buffer_load_dwordx4 v17, s[12:15], s35 offen lds
    s_add_u32 m0, s28, 77824
    s_nop 0
    buffer_load_dwordx4 v29, s[12:15], s35 offen lds
    s_add_u32 m0, s34, 81920
    s_nop 0
    buffer_load_dwordx4 v18, s[12:15], s35 offen lds
    s_add_u32 m0, s28, 81920
    s_nop 0
    buffer_load_dwordx4 v30, s[12:15], s35 offen lds
    s_add_u32 m0, s34, 86016
    s_nop 0
    buffer_load_dwordx4 v19, s[12:15], s35 offen lds
    s_add_u32 m0, s28, 86016
    s_nop 0
    buffer_load_dwordx4 v31, s[12:15], s35 offen lds
    s_add_u32 m0, s34, 90112
    s_nop 0
    buffer_load_dwordx4 v20, s[12:15], s35 offen lds
    s_add_u32 m0, s28, 90112
    s_nop 0
    buffer_load_dwordx4 v32, s[12:15], s35 offen lds
    s_add_u32 m0, s34, 94208
    s_nop 0
    buffer_load_dwordx4 v21, s[12:15], s35 offen lds
    s_add_u32 m0, s28, 94208
    s_nop 0
    buffer_load_dwordx4 v33, s[12:15], s35 offen lds
    s_waitcnt vmcnt(24)
    s_barrier
    s_movk_i32 s33, 640
    s_mov_b32 s35, 983040
    s_add_u32 m0, s34, 98304
    s_nop 0
    buffer_load_dwordx4 v10, s[8:11], s33 offen lds
    s_add_u32 m0, s28, 98304
    s_nop 0
    buffer_load_dwordx4 v22, s[8:11], s33 offen lds
    s_add_u32 m0, s34, 102400
    s_nop 0
    buffer_load_dwordx4 v11, s[8:11], s33 offen lds
    s_add_u32 m0, s28, 102400
    s_nop 0
    buffer_load_dwordx4 v23, s[8:11], s33 offen lds
    s_add_u32 m0, s34, 106496
    s_nop 0
    buffer_load_dwordx4 v12, s[8:11], s33 offen lds
    s_add_u32 m0, s28, 106496
    s_nop 0
    buffer_load_dwordx4 v24, s[8:11], s33 offen lds
    s_add_u32 m0, s34, 110592
    s_nop 0
    buffer_load_dwordx4 v13, s[8:11], s33 offen lds
    s_add_u32 m0, s28, 110592
    s_nop 0
    buffer_load_dwordx4 v25, s[8:11], s33 offen lds
    s_add_u32 m0, s34, 114688
    s_nop 0
    buffer_load_dwordx4 v14, s[12:15], s35 offen lds
    s_add_u32 m0, s28, 114688
    s_nop 0
    buffer_load_dwordx4 v26, s[12:15], s35 offen lds
    s_add_u32 m0, s34, 118784
    s_nop 0
    buffer_load_dwordx4 v15, s[12:15], s35 offen lds
    s_add_u32 m0, s28, 118784
    s_nop 0
    buffer_load_dwordx4 v27, s[12:15], s35 offen lds
    s_add_u32 m0, s34, 122880
    s_nop 0
    buffer_load_dwordx4 v16, s[12:15], s35 offen lds
    s_add_u32 m0, s28, 122880
    s_nop 0
    buffer_load_dwordx4 v28, s[12:15], s35 offen lds
    s_add_u32 m0, s34, 126976
    s_nop 0
    buffer_load_dwordx4 v17, s[12:15], s35 offen lds
    s_add_u32 m0, s28, 126976
    s_nop 0
    buffer_load_dwordx4 v29, s[12:15], s35 offen lds
    s_add_u32 m0, s34, 131072
    s_nop 0
    buffer_load_dwordx4 v18, s[12:15], s35 offen lds
    s_add_u32 m0, s28, 131072
    s_nop 0
    buffer_load_dwordx4 v30, s[12:15], s35 offen lds
    s_add_u32 m0, s34, 135168
    s_nop 0
    buffer_load_dwordx4 v19, s[12:15], s35 offen lds
    s_add_u32 m0, s28, 135168
    s_nop 0
    buffer_load_dwordx4 v31, s[12:15], s35 offen lds
    s_add_u32 m0, s34, 139264
    s_nop 0
    buffer_load_dwordx4 v20, s[12:15], s35 offen lds
    s_add_u32 m0, s28, 139264
    s_nop 0
    buffer_load_dwordx4 v32, s[12:15], s35 offen lds
    s_add_u32 m0, s34, 143360
    s_nop 0
    buffer_load_dwordx4 v21, s[12:15], s35 offen lds
    s_add_u32 m0, s28, 143360
    s_nop 0
    buffer_load_dwordx4 v33, s[12:15], s35 offen lds
    s_waitcnt vmcnt(24)
    s_barrier
    s_movk_i32 s33, 768
    s_mov_b32 s35, 1179648
    s_add_u32 m0, s34, 0
    s_nop 0
    buffer_load_dwordx4 v10, s[8:11], s33 offen lds
    s_add_u32 m0, s28, 0
    s_nop 0
    buffer_load_dwordx4 v22, s[8:11], s33 offen lds
    s_add_u32 m0, s34, 4096
    s_nop 0
    buffer_load_dwordx4 v11, s[8:11], s33 offen lds
    s_add_u32 m0, s28, 4096
    s_nop 0
    buffer_load_dwordx4 v23, s[8:11], s33 offen lds
    s_add_u32 m0, s34, 8192
    s_nop 0
    buffer_load_dwordx4 v12, s[8:11], s33 offen lds
    s_add_u32 m0, s28, 8192
    s_nop 0
    buffer_load_dwordx4 v24, s[8:11], s33 offen lds
    s_add_u32 m0, s34, 12288
    s_nop 0
    buffer_load_dwordx4 v13, s[8:11], s33 offen lds
    s_add_u32 m0, s28, 12288
    s_nop 0
    buffer_load_dwordx4 v25, s[8:11], s33 offen lds
    s_add_u32 m0, s34, 16384
    s_nop 0
    buffer_load_dwordx4 v14, s[12:15], s35 offen lds
    s_add_u32 m0, s28, 16384
    s_nop 0
    buffer_load_dwordx4 v26, s[12:15], s35 offen lds
    s_add_u32 m0, s34, 20480
    s_nop 0
    buffer_load_dwordx4 v15, s[12:15], s35 offen lds
    s_add_u32 m0, s28, 20480
    s_nop 0
    buffer_load_dwordx4 v27, s[12:15], s35 offen lds
    s_add_u32 m0, s34, 24576
    s_nop 0
    buffer_load_dwordx4 v16, s[12:15], s35 offen lds
    s_add_u32 m0, s28, 24576
    s_nop 0
    buffer_load_dwordx4 v28, s[12:15], s35 offen lds
    s_add_u32 m0, s34, 28672
    s_nop 0
    buffer_load_dwordx4 v17, s[12:15], s35 offen lds
    s_add_u32 m0, s28, 28672
    s_nop 0
    buffer_load_dwordx4 v29, s[12:15], s35 offen lds
    s_add_u32 m0, s34, 32768
    s_nop 0
    buffer_load_dwordx4 v18, s[12:15], s35 offen lds
    s_add_u32 m0, s28, 32768
    s_nop 0
    buffer_load_dwordx4 v30, s[12:15], s35 offen lds
    s_add_u32 m0, s34, 36864
    s_nop 0
    buffer_load_dwordx4 v19, s[12:15], s35 offen lds
    s_add_u32 m0, s28, 36864
    s_nop 0
    buffer_load_dwordx4 v31, s[12:15], s35 offen lds
    s_add_u32 m0, s34, 40960
    s_nop 0
    buffer_load_dwordx4 v20, s[12:15], s35 offen lds
    s_add_u32 m0, s28, 40960
    s_nop 0
    buffer_load_dwordx4 v32, s[12:15], s35 offen lds
    s_add_u32 m0, s34, 45056
    s_nop 0
    buffer_load_dwordx4 v21, s[12:15], s35 offen lds
    s_add_u32 m0, s28, 45056
    s_nop 0
    buffer_load_dwordx4 v33, s[12:15], s35 offen lds
    s_waitcnt vmcnt(24)
    s_barrier
    s_movk_i32 s33, 896
    s_mov_b32 s35, 1376256
    s_add_u32 m0, s34, 49152
    s_nop 0
    buffer_load_dwordx4 v10, s[8:11], s33 offen lds
    s_add_u32 m0, s28, 49152
    s_nop 0
    buffer_load_dwordx4 v22, s[8:11], s33 offen lds
    s_add_u32 m0, s34, 53248
    s_nop 0
    buffer_load_dwordx4 v11, s[8:11], s33 offen lds
    s_add_u32 m0, s28, 53248
    s_nop 0
    buffer_load_dwordx4 v23, s[8:11], s33 offen lds
    s_add_u32 m0, s34, 57344
    s_nop 0
    buffer_load_dwordx4 v12, s[8:11], s33 offen lds
    s_add_u32 m0, s28, 57344
    s_nop 0
    buffer_load_dwordx4 v24, s[8:11], s33 offen lds
    s_add_u32 m0, s34, 61440
    s_nop 0
    buffer_load_dwordx4 v13, s[8:11], s33 offen lds
    s_add_u32 m0, s28, 61440
    s_nop 0
    buffer_load_dwordx4 v25, s[8:11], s33 offen lds
    s_add_u32 m0, s34, 65536
    s_nop 0
    buffer_load_dwordx4 v14, s[12:15], s35 offen lds
    s_add_u32 m0, s28, 65536
    s_nop 0
    buffer_load_dwordx4 v26, s[12:15], s35 offen lds
    s_add_u32 m0, s34, 69632
    s_nop 0
    buffer_load_dwordx4 v15, s[12:15], s35 offen lds
    s_add_u32 m0, s28, 69632
    s_nop 0
    buffer_load_dwordx4 v27, s[12:15], s35 offen lds
    s_add_u32 m0, s34, 73728
    s_nop 0
    buffer_load_dwordx4 v16, s[12:15], s35 offen lds
    s_add_u32 m0, s28, 73728
    s_nop 0
    buffer_load_dwordx4 v28, s[12:15], s35 offen lds
    s_add_u32 m0, s34, 77824
    s_nop 0
    buffer_load_dwordx4 v17, s[12:15], s35 offen lds
    s_add_u32 m0, s28, 77824
    s_nop 0
    buffer_load_dwordx4 v29, s[12:15], s35 offen lds
    s_add_u32 m0, s34, 81920
    s_nop 0
    buffer_load_dwordx4 v18, s[12:15], s35 offen lds
    s_add_u32 m0, s28, 81920
    s_nop 0
    buffer_load_dwordx4 v30, s[12:15], s35 offen lds
    s_add_u32 m0, s34, 86016
    s_nop 0
    buffer_load_dwordx4 v19, s[12:15], s35 offen lds
    s_add_u32 m0, s28, 86016
    s_nop 0
    buffer_load_dwordx4 v31, s[12:15], s35 offen lds
    s_add_u32 m0, s34, 90112
    s_nop 0
    buffer_load_dwordx4 v20, s[12:15], s35 offen lds
    s_add_u32 m0, s28, 90112
    s_nop 0
    buffer_load_dwordx4 v32, s[12:15], s35 offen lds
    s_add_u32 m0, s34, 94208
    s_nop 0
    buffer_load_dwordx4 v21, s[12:15], s35 offen lds
    s_add_u32 m0, s28, 94208
    s_nop 0
    buffer_load_dwordx4 v33, s[12:15], s35 offen lds
    s_waitcnt vmcnt(24)
    s_barrier
    s_movk_i32 s33, 1024
    s_mov_b32 s35, 1572864
    s_add_u32 m0, s34, 98304
    s_nop 0
    buffer_load_dwordx4 v10, s[8:11], s33 offen lds
    s_add_u32 m0, s28, 98304
    s_nop 0
    buffer_load_dwordx4 v22, s[8:11], s33 offen lds
    s_add_u32 m0, s34, 102400
    s_nop 0
    buffer_load_dwordx4 v11, s[8:11], s33 offen lds
    s_add_u32 m0, s28, 102400
    s_nop 0
    buffer_load_dwordx4 v23, s[8:11], s33 offen lds
    s_add_u32 m0, s34, 106496
    s_nop 0
    buffer_load_dwordx4 v12, s[8:11], s33 offen lds
    s_add_u32 m0, s28, 106496
    s_nop 0
    buffer_load_dwordx4 v24, s[8:11], s33 offen lds
    s_add_u32 m0, s34, 110592
    s_nop 0
    buffer_load_dwordx4 v13, s[8:11], s33 offen lds
    s_add_u32 m0, s28, 110592
    s_nop 0
    buffer_load_dwordx4 v25, s[8:11], s33 offen lds
    s_add_u32 m0, s34, 114688
    s_nop 0
    buffer_load_dwordx4 v14, s[12:15], s35 offen lds
    s_add_u32 m0, s28, 114688
    s_nop 0
    buffer_load_dwordx4 v26, s[12:15], s35 offen lds
    s_add_u32 m0, s34, 118784
    s_nop 0
    buffer_load_dwordx4 v15, s[12:15], s35 offen lds
    s_add_u32 m0, s28, 118784
    s_nop 0
    buffer_load_dwordx4 v27, s[12:15], s35 offen lds
    s_add_u32 m0, s34, 122880
    s_nop 0
    buffer_load_dwordx4 v16, s[12:15], s35 offen lds
    s_add_u32 m0, s28, 122880
    s_nop 0
    buffer_load_dwordx4 v28, s[12:15], s35 offen lds
    s_add_u32 m0, s34, 126976
    s_nop 0
    buffer_load_dwordx4 v17, s[12:15], s35 offen lds
    s_add_u32 m0, s28, 126976
    s_nop 0
    buffer_load_dwordx4 v29, s[12:15], s35 offen lds
    s_add_u32 m0, s34, 131072
    s_nop 0
    buffer_load_dwordx4 v18, s[12:15], s35 offen lds
    s_add_u32 m0, s28, 131072
    s_nop 0
    buffer_load_dwordx4 v30, s[12:15], s35 offen lds
    s_add_u32 m0, s34, 135168
    s_nop 0
    buffer_load_dwordx4 v19, s[12:15], s35 offen lds
    s_add_u32 m0, s28, 135168
    s_nop 0
    buffer_load_dwordx4 v31, s[12:15], s35 offen lds
    s_add_u32 m0, s34, 139264
    s_nop 0
    buffer_load_dwordx4 v20, s[12:15], s35 offen lds
    s_add_u32 m0, s28, 139264
    s_nop 0
    buffer_load_dwordx4 v32, s[12:15], s35 offen lds
    s_add_u32 m0, s34, 143360
    s_nop 0
    buffer_load_dwordx4 v21, s[12:15], s35 offen lds
    s_add_u32 m0, s28, 143360
    s_nop 0
    buffer_load_dwordx4 v33, s[12:15], s35 offen lds
    s_waitcnt vmcnt(24)
    s_barrier
    s_movk_i32 s33, 1152
    s_mov_b32 s35, 1769472
    s_add_u32 m0, s34, 0
    s_nop 0
    buffer_load_dwordx4 v10, s[8:11], s33 offen lds
    s_add_u32 m0, s28, 0
    s_nop 0
    buffer_load_dwordx4 v22, s[8:11], s33 offen lds
    s_add_u32 m0, s34, 4096
    s_nop 0
    buffer_load_dwordx4 v11, s[8:11], s33 offen lds
    s_add_u32 m0, s28, 4096
    s_nop 0
    buffer_load_dwordx4 v23, s[8:11], s33 offen lds
    s_add_u32 m0, s34, 8192
    s_nop 0
    buffer_load_dwordx4 v12, s[8:11], s33 offen lds
    s_add_u32 m0, s28, 8192
    s_nop 0
    buffer_load_dwordx4 v24, s[8:11], s33 offen lds
    s_add_u32 m0, s34, 12288
    s_nop 0
    buffer_load_dwordx4 v13, s[8:11], s33 offen lds
    s_add_u32 m0, s28, 12288
    s_nop 0
    buffer_load_dwordx4 v25, s[8:11], s33 offen lds
    s_add_u32 m0, s34, 16384
    s_nop 0
    buffer_load_dwordx4 v14, s[12:15], s35 offen lds
    s_add_u32 m0, s28, 16384
    s_nop 0
    buffer_load_dwordx4 v26, s[12:15], s35 offen lds
    s_add_u32 m0, s34, 20480
    s_nop 0
    buffer_load_dwordx4 v15, s[12:15], s35 offen lds
    s_add_u32 m0, s28, 20480
    s_nop 0
    buffer_load_dwordx4 v27, s[12:15], s35 offen lds
    s_add_u32 m0, s34, 24576
    s_nop 0
    buffer_load_dwordx4 v16, s[12:15], s35 offen lds
    s_add_u32 m0, s28, 24576
    s_nop 0
    buffer_load_dwordx4 v28, s[12:15], s35 offen lds
    s_add_u32 m0, s34, 28672
    s_nop 0
    buffer_load_dwordx4 v17, s[12:15], s35 offen lds
    s_add_u32 m0, s28, 28672
    s_nop 0
    buffer_load_dwordx4 v29, s[12:15], s35 offen lds
    s_add_u32 m0, s34, 32768
    s_nop 0
    buffer_load_dwordx4 v18, s[12:15], s35 offen lds
    s_add_u32 m0, s28, 32768
    s_nop 0
    buffer_load_dwordx4 v30, s[12:15], s35 offen lds
    s_add_u32 m0, s34, 36864
    s_nop 0
    buffer_load_dwordx4 v19, s[12:15], s35 offen lds
    s_add_u32 m0, s28, 36864
    s_nop 0
    buffer_load_dwordx4 v31, s[12:15], s35 offen lds
    s_add_u32 m0, s34, 40960
    s_nop 0
    buffer_load_dwordx4 v20, s[12:15], s35 offen lds
    s_add_u32 m0, s28, 40960
    s_nop 0
    buffer_load_dwordx4 v32, s[12:15], s35 offen lds
    s_add_u32 m0, s34, 45056
    s_nop 0
    buffer_load_dwordx4 v21, s[12:15], s35 offen lds
    s_add_u32 m0, s28, 45056
    s_nop 0
    buffer_load_dwordx4 v33, s[12:15], s35 offen lds
    s_waitcnt vmcnt(24)
    s_barrier
    s_waitcnt vmcnt(0)
    s_barrier
    s_endpgm
.globl k2_kernel
.p2align 8
.type k2_kernel,@function
k2_kernel:
    s_cmp_ge_u32 s2, 256
    s_cbranch_scc1 k2_exit
    s_load_dwordx2 s[34:35], s[0:1], 0
    s_load_dwordx2 s[36:37], s[0:1], 64
    s_load_dwordx2 s[38:39], s[0:1], 96
    s_load_dwordx2 s[40:41], s[0:1], 112
    s_load_dwordx4 s[44:47], s[0:1], 40
    s_load_dwordx2 s[48:49], s[0:1], 88
    v_lshrrev_b32 v1, 6, v0
    v_and_b32 v2, 63, v0
    v_readfirstlane_b32 s32, v1
    v_and_b32 v3, 15, v0
    v_lshrrev_b32 v4, 4, v2
    s_waitcnt lgkmcnt(0)
    s_mov_b32 s8, s40
    s_and_b32 s9, s41, 0xffff
    s_mov_b32 s10, 22446080
    s_mov_b32 s11, 0x00020000
    s_mov_b32 s12, s34
    s_and_b32 s13, s35, 0xffff
    s_mov_b32 s14, 2621440
    s_mov_b32 s15, 0x00020000
    s_mov_b32 s16, s36
    s_and_b32 s17, s37, 0xffff
    s_mov_b32 s18, 1280
    s_mov_b32 s19, 0x00020000
    s_mov_b32 s20, s38
    s_and_b32 s21, s39, 0xffff
    s_mov_b32 s22, 5242880
    s_mov_b32 s23, 0x00020000
    s_and_b32 s34, s2, 7
    s_lshl_b32 s34, s34, 2
    s_lshr_b32 s35, s2, 3
    s_and_b32 s35, s35, 3
    s_add_u32 s30, s34, s35
    s_lshr_b32 s31, s2, 5
    s_mul_i32 s37, s32, 1280
    s_cmp_eq_u32 s32, 3
    s_cselect_b32 s37, 4096, s37
    s_cmp_eq_u32 s32, 1
    s_cselect_b32 s24, s46, s44
    s_cselect_b32 s25, s47, s45
    s_mov_b32 s26, 819200
    s_cmp_ge_u32 s32, 2
    s_cselect_b32 s24, s40, s24
    s_cselect_b32 s25, s41, s25
    s_cselect_b32 s26, 22446080, s26
    s_and_b32 s25, s25, 0xffff
    s_mov_b32 s27, 0x00020000
    s_mul_i32 s33, s31, 102400
    s_mul_i32 s38, s31, 256000
    s_cmp_eq_u32 s32, 3
    s_cselect_b32 s39, 1536, 0
    s_add_u32 s38, s38, s39
    s_add_u32 s38, s38, 2883584
    s_cmp_ge_u32 s32, 2
    s_cselect_b32 s33, s38, s33
    s_mul_i32 s34, s30, 368640
    s_add_u32 s34, s34, s37
    s_add_u32 s34, s34, 4931584
    s_mul_i32 s35, s32, 36864
    v_lshrrev_b32 v5, 3, v2
    s_movk_i32 s37, 5760
    v_mul_lo_u32 v5, v5, s37
    v_and_b32 v6, 7, v2
    v_xor_b32 v7, v6, v4
    v_lshl_add_u32 v8, v7, 4, v5
    v_xor_b32 v7, 4, v7
    v_lshl_add_u32 v9, v7, 4, v5
    v_lshrrev_b32 v5, 1, v3
    v_or_b32 v6, 0, v4
    v_xor_b32 v5, v5, v6
    v_lshlrev_b32 v5, 4, v5
    v_lshl_add_u32 v5, v3, 7, v5
    v_add_u32 v10, s35, v5
    v_lshrrev_b32 v5, 1, v3
    v_or_b32 v6, 4, v4
    v_xor_b32 v5, v5, v6
    v_lshlrev_b32 v5, 4, v5
    v_lshl_add_u32 v5, v3, 7, v5
    v_add_u32 v11, s35, v5
    s_movk_i32 s37, 1280
    s_cmp_ge_u32 s32, 2
    s_cselect_b32 s37, 3200, s37
    v_lshrrev_b32 v5, 3, v2
    v_mul_lo_u32 v5, v5, s37
    v_and_b32 v6, 7, v2
    v_xor_b32 v7, v6, v4
    v_lshl_add_u32 v12, v7, 4, v5
    v_xor_b32 v7, 4, v7
    v_lshl_add_u32 v13, v7, 4, v5
    s_cmp_ge_u32 s32, 2
    s_cbranch_scc1 k2_ffn
    s_add_u32 m0, s35, 0
    s_add_u32 s36, s33, 0
    buffer_load_dwordx4 v12, s[24:27], s36 offen lds
    s_add_u32 m0, s35, 1024
    s_add_u32 s36, s33, 10240
    buffer_load_dwordx4 v13, s[24:27], s36 offen lds
    s_add_u32 m0, s35, 2048
    s_add_u32 s36, s33, 20480
    buffer_load_dwordx4 v12, s[24:27], s36 offen lds
    s_add_u32 m0, s35, 3072
    s_add_u32 s36, s33, 30720
    buffer_load_dwordx4 v13, s[24:27], s36 offen lds
    s_add_u32 m0, s35, 4096
    s_add_u32 s36, s33, 40960
    buffer_load_dwordx4 v12, s[24:27], s36 offen lds
    s_add_u32 m0, s35, 5120
    s_add_u32 s36, s33, 51200
    buffer_load_dwordx4 v13, s[24:27], s36 offen lds
    s_add_u32 m0, s35, 6144
    s_add_u32 s36, s33, 61440
    buffer_load_dwordx4 v12, s[24:27], s36 offen lds
    s_add_u32 m0, s35, 7168
    s_add_u32 s36, s33, 71680
    buffer_load_dwordx4 v13, s[24:27], s36 offen lds
    s_add_u32 m0, s35, 8192
    s_add_u32 s36, s33, 81920
    buffer_load_dwordx4 v12, s[24:27], s36 offen lds
    s_add_u32 m0, s35, 9216
    s_add_u32 s36, s33, 92160
    buffer_load_dwordx4 v13, s[24:27], s36 offen lds
    s_add_u32 m0, s35, 10240
    s_add_u32 s36, s34, 0
    buffer_load_dwordx4 v8, s[8:11], s36 offen lds
    s_add_u32 m0, s35, 11264
    s_add_u32 s36, s34, 46080
    buffer_load_dwordx4 v9, s[8:11], s36 offen lds
    s_add_u32 m0, s35, 12288
    s_add_u32 s36, s34, 92160
    buffer_load_dwordx4 v8, s[8:11], s36 offen lds
    s_add_u32 m0, s35, 13312
    s_add_u32 s36, s34, 138240
    buffer_load_dwordx4 v9, s[8:11], s36 offen lds
    s_add_u32 m0, s35, 14336
    s_add_u32 s36, s34, 184320
    buffer_load_dwordx4 v8, s[8:11], s36 offen lds
    s_add_u32 m0, s35, 15360
    s_add_u32 s36, s34, 230400
    buffer_load_dwordx4 v9, s[8:11], s36 offen lds
    s_add_u32 m0, s35, 16384
    s_add_u32 s36, s34, 276480
    buffer_load_dwordx4 v8, s[8:11], s36 offen lds
    s_add_u32 m0, s35, 17408
    s_add_u32 s36, s34, 322560
    buffer_load_dwordx4 v9, s[8:11], s36 offen lds
    s_add_u32 m0, s35, 18432
    s_add_u32 s36, s33, 128
    buffer_load_dwordx4 v12, s[24:27], s36 offen lds
    s_add_u32 m0, s35, 19456
    s_add_u32 s36, s33, 10368
    buffer_load_dwordx4 v13, s[24:27], s36 offen lds
    s_add_u32 m0, s35, 20480
    s_add_u32 s36, s33, 20608
    buffer_load_dwordx4 v12, s[24:27], s36 offen lds
    s_add_u32 m0, s35, 21504
    s_add_u32 s36, s33, 30848
    buffer_load_dwordx4 v13, s[24:27], s36 offen lds
    s_add_u32 m0, s35, 22528
    s_add_u32 s36, s33, 41088
    buffer_load_dwordx4 v12, s[24:27], s36 offen lds
    s_add_u32 m0, s35, 23552
    s_add_u32 s36, s33, 51328
    buffer_load_dwordx4 v13, s[24:27], s36 offen lds
    s_add_u32 m0, s35, 24576
    s_add_u32 s36, s33, 61568
    buffer_load_dwordx4 v12, s[24:27], s36 offen lds
    s_add_u32 m0, s35, 25600
    s_add_u32 s36, s33, 71808
    buffer_load_dwordx4 v13, s[24:27], s36 offen lds
    s_add_u32 m0, s35, 26624
    s_add_u32 s36, s33, 82048
    buffer_load_dwordx4 v12, s[24:27], s36 offen lds
    s_add_u32 m0, s35, 27648
    s_add_u32 s36, s33, 92288
    buffer_load_dwordx4 v13, s[24:27], s36 offen lds
    s_add_u32 m0, s35, 28672
    s_add_u32 s36, s34, 128
    buffer_load_dwordx4 v8, s[8:11], s36 offen lds
    s_add_u32 m0, s35, 29696
    s_add_u32 s36, s34, 46208
    buffer_load_dwordx4 v9, s[8:11], s36 offen lds
    s_add_u32 m0, s35, 30720
    s_add_u32 s36, s34, 92288
    buffer_load_dwordx4 v8, s[8:11], s36 offen lds
    s_add_u32 m0, s35, 31744
    s_add_u32 s36, s34, 138368
    buffer_load_dwordx4 v9, s[8:11], s36 offen lds
    s_add_u32 m0, s35, 32768
    s_add_u32 s36, s34, 184448
    buffer_load_dwordx4 v8, s[8:11], s36 offen lds
    s_add_u32 m0, s35, 33792
    s_add_u32 s36, s34, 230528
    buffer_load_dwordx4 v9, s[8:11], s36 offen lds
    s_add_u32 m0, s35, 34816
    s_add_u32 s36, s34, 276608
    buffer_load_dwordx4 v8, s[8:11], s36 offen lds
    s_add_u32 m0, s35, 35840
    s_add_u32 s36, s34, 322688
    buffer_load_dwordx4 v9, s[8:11], s36 offen lds
    s_waitcnt vmcnt(18)
    ds_read_b128 v[24:27], v10 offset:0
    ds_read_b128 v[28:31], v10 offset:2048
    ds_read_b128 v[32:35], v10 offset:4096
    ds_read_b128 v[36:39], v10 offset:6144
    ds_read_b128 v[40:43], v10 offset:8192
    ds_read_b128 v[44:47], v10 offset:10240
    ds_read_b128 v[48:51], v10 offset:12288
    ds_read_b128 v[52:55], v10 offset:14336
    ds_read_b128 v[56:59], v10 offset:16384
    ds_read_b128 v[60:63], v11 offset:0
    ds_read_b128 v[64:67], v11 offset:2048
    ds_read_b128 v[68:71], v11 offset:4096
    ds_read_b128 v[72:75], v11 offset:6144
    ds_read_b128 v[76:79], v11 offset:8192
    ds_read_b128 v[80:83], v11 offset:10240
    ds_read_b128 v[84:87], v11 offset:12288
    ds_read_b128 v[88:91], v11 offset:14336
    ds_read_b128 v[92:95], v11 offset:16384
    s_waitcnt lgkmcnt(0)
    s_add_u32 m0, s35, 0
    s_add_u32 s36, s33, 256
    buffer_load_dwordx4 v12, s[24:27], s36 offen lds
    s_add_u32 m0, s35, 1024
    s_add_u32 s36, s33, 10496
    buffer_load_dwordx4 v13, s[24:27], s36 offen lds
    s_add_u32 m0, s35, 2048
    s_add_u32 s36, s33, 20736
    buffer_load_dwordx4 v12, s[24:27], s36 offen lds
    s_add_u32 m0, s35, 3072
    s_add_u32 s36, s33, 30976
    buffer_load_dwordx4 v13, s[24:27], s36 offen lds
    s_add_u32 m0, s35, 4096
    s_add_u32 s36, s33, 41216
    buffer_load_dwordx4 v12, s[24:27], s36 offen lds
    s_add_u32 m0, s35, 5120
    s_add_u32 s36, s33, 51456
    buffer_load_dwordx4 v13, s[24:27], s36 offen lds
    s_add_u32 m0, s35, 6144
    s_add_u32 s36, s33, 61696
    buffer_load_dwordx4 v12, s[24:27], s36 offen lds
    s_add_u32 m0, s35, 7168
    s_add_u32 s36, s33, 71936
    buffer_load_dwordx4 v13, s[24:27], s36 offen lds
    s_add_u32 m0, s35, 8192
    s_add_u32 s36, s33, 82176
    buffer_load_dwordx4 v12, s[24:27], s36 offen lds
    s_add_u32 m0, s35, 9216
    s_add_u32 s36, s33, 92416
    buffer_load_dwordx4 v13, s[24:27], s36 offen lds
    s_add_u32 m0, s35, 10240
    s_add_u32 s36, s34, 256
    buffer_load_dwordx4 v8, s[8:11], s36 offen lds
    s_add_u32 m0, s35, 11264
    s_add_u32 s36, s34, 46336
    buffer_load_dwordx4 v9, s[8:11], s36 offen lds
    s_add_u32 m0, s35, 12288
    s_add_u32 s36, s34, 92416
    buffer_load_dwordx4 v8, s[8:11], s36 offen lds
    s_add_u32 m0, s35, 13312
    s_add_u32 s36, s34, 138496
    buffer_load_dwordx4 v9, s[8:11], s36 offen lds
    s_add_u32 m0, s35, 14336
    s_add_u32 s36, s34, 184576
    buffer_load_dwordx4 v8, s[8:11], s36 offen lds
    s_add_u32 m0, s35, 15360
    s_add_u32 s36, s34, 230656
    buffer_load_dwordx4 v9, s[8:11], s36 offen lds
    s_add_u32 m0, s35, 16384
    s_add_u32 s36, s34, 276736
    buffer_load_dwordx4 v8, s[8:11], s36 offen lds
    s_add_u32 m0, s35, 17408
    s_add_u32 s36, s34, 322816
    buffer_load_dwordx4 v9, s[8:11], s36 offen lds
    s_waitcnt vmcnt(18)
    v_mfma_f32_16x16x32_bf16 v[168:171], v[24:27], v[44:47], 0
    ds_read_b128 v[96:99], v10 offset:18432
    v_mfma_f32_16x16x32_bf16 v[172:175], v[24:27], v[48:51], 0
    ds_read_b128 v[100:103], v10 offset:20480
    v_mfma_f32_16x16x32_bf16 v[176:179], v[24:27], v[52:55], 0
    ds_read_b128 v[104:107], v10 offset:22528
    v_mfma_f32_16x16x32_bf16 v[180:183], v[24:27], v[56:59], 0
    ds_read_b128 v[108:111], v10 offset:24576
    v_mfma_f32_16x16x32_bf16 v[184:187], v[28:31], v[44:47], 0
    ds_read_b128 v[112:115], v10 offset:26624
    v_mfma_f32_16x16x32_bf16 v[188:191], v[28:31], v[48:51], 0
    ds_read_b128 v[116:119], v10 offset:28672
    v_mfma_f32_16x16x32_bf16 v[192:195], v[28:31], v[52:55], 0
    ds_read_b128 v[120:123], v10 offset:30720
    v_mfma_f32_16x16x32_bf16 v[196:199], v[28:31], v[56:59], 0
    ds_read_b128 v[124:127], v10 offset:32768
    v_mfma_f32_16x16x32_bf16 v[200:203], v[32:35], v[44:47], 0
    ds_read_b128 v[128:131], v10 offset:34816
    v_mfma_f32_16x16x32_bf16 v[204:207], v[32:35], v[48:51], 0
    ds_read_b128 v[132:135], v11 offset:18432
    v_mfma_f32_16x16x32_bf16 v[208:211], v[32:35], v[52:55], 0
    ds_read_b128 v[136:139], v11 offset:20480
    v_mfma_f32_16x16x32_bf16 v[212:215], v[32:35], v[56:59], 0
    ds_read_b128 v[140:143], v11 offset:22528
    v_mfma_f32_16x16x32_bf16 v[216:219], v[36:39], v[44:47], 0
    ds_read_b128 v[144:147], v11 offset:24576
    v_mfma_f32_16x16x32_bf16 v[220:223], v[36:39], v[48:51], 0
    ds_read_b128 v[148:151], v11 offset:26624
    v_mfma_f32_16x16x32_bf16 v[224:227], v[36:39], v[52:55], 0
    ds_read_b128 v[152:155], v11 offset:28672
    v_mfma_f32_16x16x32_bf16 v[228:231], v[36:39], v[56:59], 0
    ds_read_b128 v[156:159], v11 offset:30720
    v_mfma_f32_16x16x32_bf16 v[232:235], v[40:43], v[44:47], 0
    ds_read_b128 v[160:163], v11 offset:32768
    v_mfma_f32_16x16x32_bf16 v[236:239], v[40:43], v[48:51], 0
    ds_read_b128 v[164:167], v11 offset:34816
    v_mfma_f32_16x16x32_bf16 v[240:243], v[40:43], v[52:55], 0
    v_mfma_f32_16x16x32_bf16 v[244:247], v[40:43], v[56:59], 0
    v_mfma_f32_16x16x32_bf16 v[168:171], v[60:63], v[80:83], v[168:171]
    v_mfma_f32_16x16x32_bf16 v[172:175], v[60:63], v[84:87], v[172:175]
    s_waitcnt lgkmcnt(0)
    v_mfma_f32_16x16x32_bf16 v[176:179], v[60:63], v[88:91], v[176:179]
    s_add_u32 m0, s35, 18432
    s_add_u32 s36, s33, 384
    buffer_load_dwordx4 v12, s[24:27], s36 offen lds
    v_mfma_f32_16x16x32_bf16 v[180:183], v[60:63], v[92:95], v[180:183]
    s_add_u32 m0, s35, 19456
    s_add_u32 s36, s33, 10624
    buffer_load_dwordx4 v13, s[24:27], s36 offen lds
    v_mfma_f32_16x16x32_bf16 v[184:187], v[64:67], v[80:83], v[184:187]
    s_add_u32 m0, s35, 20480
    s_add_u32 s36, s33, 20864
    buffer_load_dwordx4 v12, s[24:27], s36 offen lds
    v_mfma_f32_16x16x32_bf16 v[188:191], v[64:67], v[84:87], v[188:191]
    s_add_u32 m0, s35, 21504
    s_add_u32 s36, s33, 31104
    buffer_load_dwordx4 v13, s[24:27], s36 offen lds
    v_mfma_f32_16x16x32_bf16 v[192:195], v[64:67], v[88:91], v[192:195]
    s_add_u32 m0, s35, 22528
    s_add_u32 s36, s33, 41344
    buffer_load_dwordx4 v12, s[24:27], s36 offen lds
    v_mfma_f32_16x16x32_bf16 v[196:199], v[64:67], v[92:95], v[196:199]
    s_add_u32 m0, s35, 23552
    s_add_u32 s36, s33, 51584
    buffer_load_dwordx4 v13, s[24:27], s36 offen lds
    v_mfma_f32_16x16x32_bf16 v[200:203], v[68:71], v[80:83], v[200:203]
    s_add_u32 m0, s35, 24576
    s_add_u32 s36, s33, 61824
    buffer_load_dwordx4 v12, s[24:27], s36 offen lds
    v_mfma_f32_16x16x32_bf16 v[204:207], v[68:71], v[84:87], v[204:207]
    s_add_u32 m0, s35, 25600
    s_add_u32 s36, s33, 72064
    buffer_load_dwordx4 v13, s[24:27], s36 offen lds
    v_mfma_f32_16x16x32_bf16 v[208:211], v[68:71], v[88:91], v[208:211]
    s_add_u32 m0, s35, 26624
    s_add_u32 s36, s33, 82304
    buffer_load_dwordx4 v12, s[24:27], s36 offen lds
    v_mfma_f32_16x16x32_bf16 v[212:215], v[68:71], v[92:95], v[212:215]
    s_add_u32 m0, s35, 27648
    s_add_u32 s36, s33, 92544
    buffer_load_dwordx4 v13, s[24:27], s36 offen lds
    v_mfma_f32_16x16x32_bf16 v[216:219], v[72:75], v[80:83], v[216:219]
    s_add_u32 m0, s35, 28672
    s_add_u32 s36, s34, 384
    buffer_load_dwordx4 v8, s[8:11], s36 offen lds
    v_mfma_f32_16x16x32_bf16 v[220:223], v[72:75], v[84:87], v[220:223]
    s_add_u32 m0, s35, 29696
    s_add_u32 s36, s34, 46464
    buffer_load_dwordx4 v9, s[8:11], s36 offen lds
    v_mfma_f32_16x16x32_bf16 v[224:227], v[72:75], v[88:91], v[224:227]
    s_add_u32 m0, s35, 30720
    s_add_u32 s36, s34, 92544
    buffer_load_dwordx4 v8, s[8:11], s36 offen lds
    v_mfma_f32_16x16x32_bf16 v[228:231], v[72:75], v[92:95], v[228:231]
    s_add_u32 m0, s35, 31744
    s_add_u32 s36, s34, 138624
    buffer_load_dwordx4 v9, s[8:11], s36 offen lds
    v_mfma_f32_16x16x32_bf16 v[232:235], v[76:79], v[80:83], v[232:235]
    s_add_u32 m0, s35, 32768
    s_add_u32 s36, s34, 184704
    buffer_load_dwordx4 v8, s[8:11], s36 offen lds
    v_mfma_f32_16x16x32_bf16 v[236:239], v[76:79], v[84:87], v[236:239]
    s_add_u32 m0, s35, 33792
    s_add_u32 s36, s34, 230784
    buffer_load_dwordx4 v9, s[8:11], s36 offen lds
    v_mfma_f32_16x16x32_bf16 v[240:243], v[76:79], v[88:91], v[240:243]
    s_add_u32 m0, s35, 34816
    s_add_u32 s36, s34, 276864
    buffer_load_dwordx4 v8, s[8:11], s36 offen lds
    v_mfma_f32_16x16x32_bf16 v[244:247], v[76:79], v[92:95], v[244:247]
    s_add_u32 m0, s35, 35840
    s_add_u32 s36, s34, 322944
    buffer_load_dwordx4 v9, s[8:11], s36 offen lds
    s_waitcnt lgkmcnt(0)
    s_waitcnt vmcnt(18)
    v_mfma_f32_16x16x32_bf16 v[168:171], v[96:99], v[116:119], v[168:171]
    ds_read_b128 v[24:27], v10 offset:0
    v_mfma_f32_16x16x32_bf16 v[172:175], v[96:99], v[120:123], v[172:175]
    ds_read_b128 v[28:31], v10 offset:2048
    v_mfma_f32_16x16x32_bf16 v[176:179], v[96:99], v[124:127], v[176:179]
    ds_read_b128 v[32:35], v10 offset:4096
    v_mfma_f32_16x16x32_bf16 v[180:183], v[96:99], v[128:131], v[180:183]
    ds_read_b128 v[36:39], v10 offset:6144
    v_mfma_f32_16x16x32_bf16 v[184:187], v[100:103], v[116:119], v[184:187]
    ds_read_b128 v[40:43], v10 offset:8192
    v_mfma_f32_16x16x32_bf16 v[188:191], v[100:103], v[120:123], v[188:191]
    ds_read_b128 v[44:47], v10 offset:10240
    v_mfma_f32_16x16x32_bf16 v[192:195], v[100:103], v[124:127], v[192:195]
    ds_read_b128 v[48:51], v10 offset:12288
    v_mfma_f32_16x16x32_bf16 v[196:199], v[100:103], v[128:131], v[196:199]
    ds_read_b128 v[52:55], v10 offset:14336
    v_mfma_f32_16x16x32_bf16 v[200:203], v[104:107], v[116:119], v[200:203]
    ds_read_b128 v[56:59], v10 offset:16384
    v_mfma_f32_16x16x32_bf16 v[204:207], v[104:107], v[120:123], v[204:207]
    ds_read_b128 v[60:63], v11 offset:0
    v_mfma_f32_16x16x32_bf16 v[208:211], v[104:107], v[124:127], v[208:211]
    ds_read_b128 v[64:67], v11 offset:2048
    v_mfma_f32_16x16x32_bf16 v[212:215], v[104:107], v[128:131], v[212:215]
    ds_read_b128 v[68:71], v11 offset:4096
    v_mfma_f32_16x16x32_bf16 v[216:219], v[108:111], v[116:119], v[216:219]
    ds_read_b128 v[72:75], v11 offset:6144
    v_mfma_f32_16x16x32_bf16 v[220:223], v[108:111], v[120:123], v[220:223]
    ds_read_b128 v[76:79], v11 offset:8192
    v_mfma_f32_16x16x32_bf16 v[224:227], v[108:111], v[124:127], v[224:227]
    ds_read_b128 v[80:83], v11 offset:10240
    v_mfma_f32_16x16x32_bf16 v[228:231], v[108:111], v[128:131], v[228:231]
    ds_read_b128 v[84:87], v11 offset:12288
    v_mfma_f32_16x16x32_bf16 v[232:235], v[112:115], v[116:119], v[232:235]
    ds_read_b128 v[88:91], v11 offset:14336
    v_mfma_f32_16x16x32_bf16 v[236:239], v[112:115], v[120:123], v[236:239]
    ds_read_b128 v[92:95], v11 offset:16384
    v_mfma_f32_16x16x32_bf16 v[240:243], v[112:115], v[124:127], v[240:243]
    v_mfma_f32_16x16x32_bf16 v[244:247], v[112:115], v[128:131], v[244:247]
    v_mfma_f32_16x16x32_bf16 v[168:171], v[132:135], v[152:155], v[168:171]
    v_mfma_f32_16x16x32_bf16 v[172:175], v[132:135], v[156:159], v[172:175]
    s_waitcnt lgkmcnt(0)
    v_mfma_f32_16x16x32_bf16 v[176:179], v[132:135], v[160:163], v[176:179]
    s_add_u32 m0, s35, 0
    s_add_u32 s36, s33, 512
    buffer_load_dwordx4 v12, s[24:27], s36 offen lds
    v_mfma_f32_16x16x32_bf16 v[180:183], v[132:135], v[164:167], v[180:183]
    s_add_u32 m0, s35, 1024
    s_add_u32 s36, s33, 10752
    buffer_load_dwordx4 v13, s[24:27], s36 offen lds
    v_mfma_f32_16x16x32_bf16 v[184:187], v[136:139], v[152:155], v[184:187]
    s_add_u32 m0, s35, 2048
    s_add_u32 s36, s33, 20992
    buffer_load_dwordx4 v12, s[24:27], s36 offen lds
    v_mfma_f32_16x16x32_bf16 v[188:191], v[136:139], v[156:159], v[188:191]
    s_add_u32 m0, s35, 3072
    s_add_u32 s36, s33, 31232
    buffer_load_dwordx4 v13, s[24:27], s36 offen lds
    v_mfma_f32_16x16x32_bf16 v[192:195], v[136:139], v[160:163], v[192:195]
    s_add_u32 m0, s35, 4096
    s_add_u32 s36, s33, 41472
    buffer_load_dwordx4 v12, s[24:27], s36 offen lds
    v_mfma_f32_16x16x32_bf16 v[196:199], v[136:139], v[164:167], v[196:199]
    s_add_u32 m0, s35, 5120
    s_add_u32 s36, s33, 51712
    buffer_load_dwordx4 v13, s[24:27], s36 offen lds
    v_mfma_f32_16x16x32_bf16 v[200:203], v[140:143], v[152:155], v[200:203]
    s_add_u32 m0, s35, 6144
    s_add_u32 s36, s33, 61952
    buffer_load_dwordx4 v12, s[24:27], s36 offen lds
    v_mfma_f32_16x16x32_bf16 v[204:207], v[140:143], v[156:159], v[204:207]
    s_add_u32 m0, s35, 7168
    s_add_u32 s36, s33, 72192
    buffer_load_dwordx4 v13, s[24:27], s36 offen lds
    v_mfma_f32_16x16x32_bf16 v[208:211], v[140:143], v[160:163], v[208:211]
    s_add_u32 m0, s35, 8192
    s_add_u32 s36, s33, 82432
    buffer_load_dwordx4 v12, s[24:27], s36 offen lds
    v_mfma_f32_16x16x32_bf16 v[212:215], v[140:143], v[164:167], v[212:215]
    s_add_u32 m0, s35, 9216
    s_add_u32 s36, s33, 92672
    buffer_load_dwordx4 v13, s[24:27], s36 offen lds
    v_mfma_f32_16x16x32_bf16 v[216:219], v[144:147], v[152:155], v[216:219]
    s_add_u32 m0, s35, 10240
    s_add_u32 s36, s34, 512
    buffer_load_dwordx4 v8, s[8:11], s36 offen lds
    v_mfma_f32_16x16x32_bf16 v[220:223], v[144:147], v[156:159], v[220:223]
    s_add_u32 m0, s35, 11264
    s_add_u32 s36, s34, 46592
    buffer_load_dwordx4 v9, s[8:11], s36 offen lds
    v_mfma_f32_16x16x32_bf16 v[224:227], v[144:147], v[160:163], v[224:227]
    s_add_u32 m0, s35, 12288
    s_add_u32 s36, s34, 92672
    buffer_load_dwordx4 v8, s[8:11], s36 offen lds
    v_mfma_f32_16x16x32_bf16 v[228:231], v[144:147], v[164:167], v[228:231]
    s_add_u32 m0, s35, 13312
    s_add_u32 s36, s34, 138752
    buffer_load_dwordx4 v9, s[8:11], s36 offen lds
    v_mfma_f32_16x16x32_bf16 v[232:235], v[148:151], v[152:155], v[232:235]
    s_add_u32 m0, s35, 14336
    s_add_u32 s36, s34, 184832
    buffer_load_dwordx4 v8, s[8:11], s36 offen lds
    v_mfma_f32_16x16x32_bf16 v[236:239], v[148:151], v[156:159], v[236:239]
    s_add_u32 m0, s35, 15360
    s_add_u32 s36, s34, 230912
    buffer_load_dwordx4 v9, s[8:11], s36 offen lds
    v_mfma_f32_16x16x32_bf16 v[240:243], v[148:151], v[160:163], v[240:243]
    s_add_u32 m0, s35, 16384
    s_add_u32 s36, s34, 276992
    buffer_load_dwordx4 v8, s[8:11], s36 offen lds
    v_mfma_f32_16x16x32_bf16 v[244:247], v[148:151], v[164:167], v[244:247]
    s_add_u32 m0, s35, 17408
    s_add_u32 s36, s34, 323072
    buffer_load_dwordx4 v9, s[8:11], s36 offen lds
    s_waitcnt lgkmcnt(0)
    s_waitcnt vmcnt(18)
    v_mfma_f32_16x16x32_bf16 v[168:171], v[24:27], v[44:47], v[168:171]
    ds_read_b128 v[96:99], v10 offset:18432
    v_mfma_f32_16x16x32_bf16 v[172:175], v[24:27], v[48:51], v[172:175]
    ds_read_b128 v[100:103], v10 offset:20480
    v_mfma_f32_16x16x32_bf16 v[176:179], v[24:27], v[52:55], v[176:179]
    ds_read_b128 v[104:107], v10 offset:22528
    v_mfma_f32_16x16x32_bf16 v[180:183], v[24:27], v[56:59], v[180:183]
    ds_read_b128 v[108:111], v10 offset:24576
    v_mfma_f32_16x16x32_bf16 v[184:187], v[28:31], v[44:47], v[184:187]
    ds_read_b128 v[112:115], v10 offset:26624
    v_mfma_f32_16x16x32_bf16 v[188:191], v[28:31], v[48:51], v[188:191]
    ds_read_b128 v[116:119], v10 offset:28672
    v_mfma_f32_16x16x32_bf16 v[192:195], v[28:31], v[52:55], v[192:195]
    ds_read_b128 v[120:123], v10 offset:30720
    v_mfma_f32_16x16x32_bf16 v[196:199], v[28:31], v[56:59], v[196:199]
    ds_read_b128 v[124:127], v10 offset:32768
    v_mfma_f32_16x16x32_bf16 v[200:203], v[32:35], v[44:47], v[200:203]
    ds_read_b128 v[128:131], v10 offset:34816
    v_mfma_f32_16x16x32_bf16 v[204:207], v[32:35], v[48:51], v[204:207]
    ds_read_b128 v[132:135], v11 offset:18432
    v_mfma_f32_16x16x32_bf16 v[208:211], v[32:35], v[52:55], v[208:211]
    ds_read_b128 v[136:139], v11 offset:20480
    v_mfma_f32_16x16x32_bf16 v[212:215], v[32:35], v[56:59], v[212:215]
    ds_read_b128 v[140:143], v11 offset:22528
    v_mfma_f32_16x16x32_bf16 v[216:219], v[36:39], v[44:47], v[216:219]
    ds_read_b128 v[144:147], v11 offset:24576
    v_mfma_f32_16x16x32_bf16 v[220:223], v[36:39], v[48:51], v[220:223]
    ds_read_b128 v[148:151], v11 offset:26624
    v_mfma_f32_16x16x32_bf16 v[224:227], v[36:39], v[52:55], v[224:227]
    ds_read_b128 v[152:155], v11 offset:28672
    v_mfma_f32_16x16x32_bf16 v[228:231], v[36:39], v[56:59], v[228:231]
    ds_read_b128 v[156:159], v11 offset:30720
    v_mfma_f32_16x16x32_bf16 v[232:235], v[40:43], v[44:47], v[232:235]
    ds_read_b128 v[160:163], v11 offset:32768
    v_mfma_f32_16x16x32_bf16 v[236:239], v[40:43], v[48:51], v[236:239]
    ds_read_b128 v[164:167], v11 offset:34816
    v_mfma_f32_16x16x32_bf16 v[240:243], v[40:43], v[52:55], v[240:243]
    v_mfma_f32_16x16x32_bf16 v[244:247], v[40:43], v[56:59], v[244:247]
    v_mfma_f32_16x16x32_bf16 v[168:171], v[60:63], v[80:83], v[168:171]
    v_mfma_f32_16x16x32_bf16 v[172:175], v[60:63], v[84:87], v[172:175]
    s_waitcnt lgkmcnt(0)
    v_mfma_f32_16x16x32_bf16 v[176:179], v[60:63], v[88:91], v[176:179]
    s_add_u32 m0, s35, 18432
    s_add_u32 s36, s33, 640
    buffer_load_dwordx4 v12, s[24:27], s36 offen lds
    v_mfma_f32_16x16x32_bf16 v[180:183], v[60:63], v[92:95], v[180:183]
    s_add_u32 m0, s35, 19456
    s_add_u32 s36, s33, 10880
    buffer_load_dwordx4 v13, s[24:27], s36 offen lds
    v_mfma_f32_16x16x32_bf16 v[184:187], v[64:67], v[80:83], v[184:187]
    s_add_u32 m0, s35, 20480
    s_add_u32 s36, s33, 21120
    buffer_load_dwordx4 v12, s[24:27], s36 offen lds
    v_mfma_f32_16x16x32_bf16 v[188:191], v[64:67], v[84:87], v[188:191]
    s_add_u32 m0, s35, 21504
    s_add_u32 s36, s33, 31360
    buffer_load_dwordx4 v13, s[24:27], s36 offen lds
    v_mfma_f32_16x16x32_bf16 v[192:195], v[64:67], v[88:91], v[192:195]
    s_add_u32 m0, s35, 22528
    s_add_u32 s36, s33, 41600
    buffer_load_dwordx4 v12, s[24:27], s36 offen lds
    v_mfma_f32_16x16x32_bf16 v[196:199], v[64:67], v[92:95], v[196:199]
    s_add_u32 m0, s35, 23552
    s_add_u32 s36, s33, 51840
    buffer_load_dwordx4 v13, s[24:27], s36 offen lds
    v_mfma_f32_16x16x32_bf16 v[200:203], v[68:71], v[80:83], v[200:203]
    s_add_u32 m0, s35, 24576
    s_add_u32 s36, s33, 62080
    buffer_load_dwordx4 v12, s[24:27], s36 offen lds
    v_mfma_f32_16x16x32_bf16 v[204:207], v[68:71], v[84:87], v[204:207]
    s_add_u32 m0, s35, 25600
    s_add_u32 s36, s33, 72320
    buffer_load_dwordx4 v13, s[24:27], s36 offen lds
    v_mfma_f32_16x16x32_bf16 v[208:211], v[68:71], v[88:91], v[208:211]
    s_add_u32 m0, s35, 26624
    s_add_u32 s36, s33, 82560
    buffer_load_dwordx4 v12, s[24:27], s36 offen lds
    v_mfma_f32_16x16x32_bf16 v[212:215], v[68:71], v[92:95], v[212:215]
    s_add_u32 m0, s35, 27648
    s_add_u32 s36, s33, 92800
    buffer_load_dwordx4 v13, s[24:27], s36 offen lds
    v_mfma_f32_16x16x32_bf16 v[216:219], v[72:75], v[80:83], v[216:219]
    s_add_u32 m0, s35, 28672
    s_add_u32 s36, s34, 640
    buffer_load_dwordx4 v8, s[8:11], s36 offen lds
    v_mfma_f32_16x16x32_bf16 v[220:223], v[72:75], v[84:87], v[220:223]
    s_add_u32 m0, s35, 29696
    s_add_u32 s36, s34, 46720
    buffer_load_dwordx4 v9, s[8:11], s36 offen lds
    v_mfma_f32_16x16x32_bf16 v[224:227], v[72:75], v[88:91], v[224:227]
    s_add_u32 m0, s35, 30720
    s_add_u32 s36, s34, 92800
    buffer_load_dwordx4 v8, s[8:11], s36 offen lds
    v_mfma_f32_16x16x32_bf16 v[228:231], v[72:75], v[92:95], v[228:231]
    s_add_u32 m0, s35, 31744
    s_add_u32 s36, s34, 138880
    buffer_load_dwordx4 v9, s[8:11], s36 offen lds
    v_mfma_f32_16x16x32_bf16 v[232:235], v[76:79], v[80:83], v[232:235]
    s_add_u32 m0, s35, 32768
    s_add_u32 s36, s34, 184960
    buffer_load_dwordx4 v8, s[8:11], s36 offen lds
    v_mfma_f32_16x16x32_bf16 v[236:239], v[76:79], v[84:87], v[236:239]
    s_add_u32 m0, s35, 33792
    s_add_u32 s36, s34, 231040
    buffer_load_dwordx4 v9, s[8:11], s36 offen lds
    v_mfma_f32_16x16x32_bf16 v[240:243], v[76:79], v[88:91], v[240:243]
    s_add_u32 m0, s35, 34816
    s_add_u32 s36, s34, 277120
    buffer_load_dwordx4 v8, s[8:11], s36 offen lds
    v_mfma_f32_16x16x32_bf16 v[244:247], v[76:79], v[92:95], v[244:247]
    s_add_u32 m0, s35, 35840
    s_add_u32 s36, s34, 323200
    buffer_load_dwordx4 v9, s[8:11], s36 offen lds
    s_waitcnt lgkmcnt(0)
    s_waitcnt vmcnt(18)
    v_mfma_f32_16x16x32_bf16 v[168:171], v[96:99], v[116:119], v[168:171]
    ds_read_b128 v[24:27], v10 offset:0
    v_mfma_f32_16x16x32_bf16 v[172:175], v[96:99], v[120:123], v[172:175]
    ds_read_b128 v[28:31], v10 offset:2048
    v_mfma_f32_16x16x32_bf16 v[176:179], v[96:99], v[124:127], v[176:179]
    ds_read_b128 v[32:35], v10 offset:4096
    v_mfma_f32_16x16x32_bf16 v[180:183], v[96:99], v[128:131], v[180:183]
    ds_read_b128 v[36:39], v10 offset:6144
    v_mfma_f32_16x16x32_bf16 v[184:187], v[100:103], v[116:119], v[184:187]
    ds_read_b128 v[40:43], v10 offset:8192
    v_mfma_f32_16x16x32_bf16 v[188:191], v[100:103], v[120:123], v[188:191]
    ds_read_b128 v[44:47], v10 offset:10240
    v_mfma_f32_16x16x32_bf16 v[192:195], v[100:103], v[124:127], v[192:195]
    ds_read_b128 v[48:51], v10 offset:12288
    v_mfma_f32_16x16x32_bf16 v[196:199], v[100:103], v[128:131], v[196:199]
    ds_read_b128 v[52:55], v10 offset:14336
    v_mfma_f32_16x16x32_bf16 v[200:203], v[104:107], v[116:119], v[200:203]
    ds_read_b128 v[56:59], v10 offset:16384
    v_mfma_f32_16x16x32_bf16 v[204:207], v[104:107], v[120:123], v[204:207]
    ds_read_b128 v[60:63], v11 offset:0
    v_mfma_f32_16x16x32_bf16 v[208:211], v[104:107], v[124:127], v[208:211]
    ds_read_b128 v[64:67], v11 offset:2048
    v_mfma_f32_16x16x32_bf16 v[212:215], v[104:107], v[128:131], v[212:215]
    ds_read_b128 v[68:71], v11 offset:4096
    v_mfma_f32_16x16x32_bf16 v[216:219], v[108:111], v[116:119], v[216:219]
    ds_read_b128 v[72:75], v11 offset:6144
    v_mfma_f32_16x16x32_bf16 v[220:223], v[108:111], v[120:123], v[220:223]
    ds_read_b128 v[76:79], v11 offset:8192
    v_mfma_f32_16x16x32_bf16 v[224:227], v[108:111], v[124:127], v[224:227]
    ds_read_b128 v[80:83], v11 offset:10240
    v_mfma_f32_16x16x32_bf16 v[228:231], v[108:111], v[128:131], v[228:231]
    ds_read_b128 v[84:87], v11 offset:12288
    v_mfma_f32_16x16x32_bf16 v[232:235], v[112:115], v[116:119], v[232:235]
    ds_read_b128 v[88:91], v11 offset:14336
    v_mfma_f32_16x16x32_bf16 v[236:239], v[112:115], v[120:123], v[236:239]
    ds_read_b128 v[92:95], v11 offset:16384
    v_mfma_f32_16x16x32_bf16 v[240:243], v[112:115], v[124:127], v[240:243]
    v_mfma_f32_16x16x32_bf16 v[244:247], v[112:115], v[128:131], v[244:247]
    v_mfma_f32_16x16x32_bf16 v[168:171], v[132:135], v[152:155], v[168:171]
    v_mfma_f32_16x16x32_bf16 v[172:175], v[132:135], v[156:159], v[172:175]
    s_waitcnt lgkmcnt(0)
    v_mfma_f32_16x16x32_bf16 v[176:179], v[132:135], v[160:163], v[176:179]
    s_add_u32 m0, s35, 0
    s_add_u32 s36, s33, 768
    buffer_load_dwordx4 v12, s[24:27], s36 offen lds
    v_mfma_f32_16x16x32_bf16 v[180:183], v[132:135], v[164:167], v[180:183]
    s_add_u32 m0, s35, 1024
    s_add_u32 s36, s33, 11008
    buffer_load_dwordx4 v13, s[24:27], s36 offen lds
    v_mfma_f32_16x16x32_bf16 v[184:187], v[136:139], v[152:155], v[184:187]
    s_add_u32 m0, s35, 2048
    s_add_u32 s36, s33, 21248
    buffer_load_dwordx4 v12, s[24:27], s36 offen lds
    v_mfma_f32_16x16x32_bf16 v[188:191], v[136:139], v[156:159], v[188:191]
    s_add_u32 m0, s35, 3072
    s_add_u32 s36, s33, 31488
    buffer_load_dwordx4 v13, s[24:27], s36 offen lds
    v_mfma_f32_16x16x32_bf16 v[192:195], v[136:139], v[160:163], v[192:195]
    s_add_u32 m0, s35, 4096
    s_add_u32 s36, s33, 41728
    buffer_load_dwordx4 v12, s[24:27], s36 offen lds
    v_mfma_f32_16x16x32_bf16 v[196:199], v[136:139], v[164:167], v[196:199]
    s_add_u32 m0, s35, 5120
    s_add_u32 s36, s33, 51968
    buffer_load_dwordx4 v13, s[24:27], s36 offen lds
    v_mfma_f32_16x16x32_bf16 v[200:203], v[140:143], v[152:155], v[200:203]
    s_add_u32 m0, s35, 6144
    s_add_u32 s36, s33, 62208
    buffer_load_dwordx4 v12, s[24:27], s36 offen lds
    v_mfma_f32_16x16x32_bf16 v[204:207], v[140:143], v[156:159], v[204:207]
    s_add_u32 m0, s35, 7168
    s_add_u32 s36, s33, 72448
    buffer_load_dwordx4 v13, s[24:27], s36 offen lds
    v_mfma_f32_16x16x32_bf16 v[208:211], v[140:143], v[160:163], v[208:211]
    s_add_u32 m0, s35, 8192
    s_add_u32 s36, s33, 82688
    buffer_load_dwordx4 v12, s[24:27], s36 offen lds
    v_mfma_f32_16x16x32_bf16 v[212:215], v[140:143], v[164:167], v[212:215]
    s_add_u32 m0, s35, 9216
    s_add_u32 s36, s33, 92928
    buffer_load_dwordx4 v13, s[24:27], s36 offen lds
    v_mfma_f32_16x16x32_bf16 v[216:219], v[144:147], v[152:155], v[216:219]
    s_add_u32 m0, s35, 10240
    s_add_u32 s36, s34, 768
    buffer_load_dwordx4 v8, s[8:11], s36 offen lds
    v_mfma_f32_16x16x32_bf16 v[220:223], v[144:147], v[156:159], v[220:223]
    s_add_u32 m0, s35, 11264
    s_add_u32 s36, s34, 46848
    buffer_load_dwordx4 v9, s[8:11], s36 offen lds
    v_mfma_f32_16x16x32_bf16 v[224:227], v[144:147], v[160:163], v[224:227]
    s_add_u32 m0, s35, 12288
    s_add_u32 s36, s34, 92928
    buffer_load_dwordx4 v8, s[8:11], s36 offen lds
    v_mfma_f32_16x16x32_bf16 v[228:231], v[144:147], v[164:167], v[228:231]
    s_add_u32 m0, s35, 13312
    s_add_u32 s36, s34, 139008
    buffer_load_dwordx4 v9, s[8:11], s36 offen lds
    v_mfma_f32_16x16x32_bf16 v[232:235], v[148:151], v[152:155], v[232:235]
    s_add_u32 m0, s35, 14336
    s_add_u32 s36, s34, 185088
    buffer_load_dwordx4 v8, s[8:11], s36 offen lds
    v_mfma_f32_16x16x32_bf16 v[236:239], v[148:151], v[156:159], v[236:239]
    s_add_u32 m0, s35, 15360
    s_add_u32 s36, s34, 231168
    buffer_load_dwordx4 v9, s[8:11], s36 offen lds
    v_mfma_f32_16x16x32_bf16 v[240:243], v[148:151], v[160:163], v[240:243]
    s_add_u32 m0, s35, 16384
    s_add_u32 s36, s34, 277248
    buffer_load_dwordx4 v8, s[8:11], s36 offen lds
    v_mfma_f32_16x16x32_bf16 v[244:247], v[148:151], v[164:167], v[244:247]
    s_add_u32 m0, s35, 17408
    s_add_u32 s36, s34, 323328
    buffer_load_dwordx4 v9, s[8:11], s36 offen lds
    s_waitcnt lgkmcnt(0)
    s_waitcnt vmcnt(18)
    v_mfma_f32_16x16x32_bf16 v[168:171], v[24:27], v[44:47], v[168:171]
    ds_read_b128 v[96:99], v10 offset:18432
    v_mfma_f32_16x16x32_bf16 v[172:175], v[24:27], v[48:51], v[172:175]
    ds_read_b128 v[100:103], v10 offset:20480
    v_mfma_f32_16x16x32_bf16 v[176:179], v[24:27], v[52:55], v[176:179]
    ds_read_b128 v[104:107], v10 offset:22528
    v_mfma_f32_16x16x32_bf16 v[180:183], v[24:27], v[56:59], v[180:183]
    ds_read_b128 v[108:111], v10 offset:24576
    v_mfma_f32_16x16x32_bf16 v[184:187], v[28:31], v[44:47], v[184:187]
    ds_read_b128 v[112:115], v10 offset:26624
    v_mfma_f32_16x16x32_bf16 v[188:191], v[28:31], v[48:51], v[188:191]
    ds_read_b128 v[116:119], v10 offset:28672
    v_mfma_f32_16x16x32_bf16 v[192:195], v[28:31], v[52:55], v[192:195]
    ds_read_b128 v[120:123], v10 offset:30720
    v_mfma_f32_16x16x32_bf16 v[196:199], v[28:31], v[56:59], v[196:199]
    ds_read_b128 v[124:127], v10 offset:32768
    v_mfma_f32_16x16x32_bf16 v[200:203], v[32:35], v[44:47], v[200:203]
    ds_read_b128 v[128:131], v10 offset:34816
    v_mfma_f32_16x16x32_bf16 v[204:207], v[32:35], v[48:51], v[204:207]
    ds_read_b128 v[132:135], v11 offset:18432
    v_mfma_f32_16x16x32_bf16 v[208:211], v[32:35], v[52:55], v[208:211]
    ds_read_b128 v[136:139], v11 offset:20480
    v_mfma_f32_16x16x32_bf16 v[212:215], v[32:35], v[56:59], v[212:215]
    ds_read_b128 v[140:143], v11 offset:22528
    v_mfma_f32_16x16x32_bf16 v[216:219], v[36:39], v[44:47], v[216:219]
    ds_read_b128 v[144:147], v11 offset:24576
    v_mfma_f32_16x16x32_bf16 v[220:223], v[36:39], v[48:51], v[220:223]
    ds_read_b128 v[148:151], v11 offset:26624
    v_mfma_f32_16x16x32_bf16 v[224:227], v[36:39], v[52:55], v[224:227]
    ds_read_b128 v[152:155], v11 offset:28672
    v_mfma_f32_16x16x32_bf16 v[228:231], v[36:39], v[56:59], v[228:231]
    ds_read_b128 v[156:159], v11 offset:30720
    v_mfma_f32_16x16x32_bf16 v[232:235], v[40:43], v[44:47], v[232:235]
    ds_read_b128 v[160:163], v11 offset:32768
    v_mfma_f32_16x16x32_bf16 v[236:239], v[40:43], v[48:51], v[236:239]
    ds_read_b128 v[164:167], v11 offset:34816
    v_mfma_f32_16x16x32_bf16 v[240:243], v[40:43], v[52:55], v[240:243]
    v_mfma_f32_16x16x32_bf16 v[244:247], v[40:43], v[56:59], v[244:247]
    v_mfma_f32_16x16x32_bf16 v[168:171], v[60:63], v[80:83], v[168:171]
    v_mfma_f32_16x16x32_bf16 v[172:175], v[60:63], v[84:87], v[172:175]
    s_waitcnt lgkmcnt(0)
    v_mfma_f32_16x16x32_bf16 v[176:179], v[60:63], v[88:91], v[176:179]
    s_add_u32 m0, s35, 18432
    s_add_u32 s36, s33, 896
    buffer_load_dwordx4 v12, s[24:27], s36 offen lds
    v_mfma_f32_16x16x32_bf16 v[180:183], v[60:63], v[92:95], v[180:183]
    s_add_u32 m0, s35, 19456
    s_add_u32 s36, s33, 11136
    buffer_load_dwordx4 v13, s[24:27], s36 offen lds
    v_mfma_f32_16x16x32_bf16 v[184:187], v[64:67], v[80:83], v[184:187]
    s_add_u32 m0, s35, 20480
    s_add_u32 s36, s33, 21376
    buffer_load_dwordx4 v12, s[24:27], s36 offen lds
    v_mfma_f32_16x16x32_bf16 v[188:191], v[64:67], v[84:87], v[188:191]
    s_add_u32 m0, s35, 21504
    s_add_u32 s36, s33, 31616
    buffer_load_dwordx4 v13, s[24:27], s36 offen lds
    v_mfma_f32_16x16x32_bf16 v[192:195], v[64:67], v[88:91], v[192:195]
    s_add_u32 m0, s35, 22528
    s_add_u32 s36, s33, 41856
    buffer_load_dwordx4 v12, s[24:27], s36 offen lds
    v_mfma_f32_16x16x32_bf16 v[196:199], v[64:67], v[92:95], v[196:199]
    s_add_u32 m0, s35, 23552
    s_add_u32 s36, s33, 52096
    buffer_load_dwordx4 v13, s[24:27], s36 offen lds
    v_mfma_f32_16x16x32_bf16 v[200:203], v[68:71], v[80:83], v[200:203]
    s_add_u32 m0, s35, 24576
    s_add_u32 s36, s33, 62336
    buffer_load_dwordx4 v12, s[24:27], s36 offen lds
    v_mfma_f32_16x16x32_bf16 v[204:207], v[68:71], v[84:87], v[204:207]
    s_add_u32 m0, s35, 25600
    s_add_u32 s36, s33, 72576
    buffer_load_dwordx4 v13, s[24:27], s36 offen lds
    v_mfma_f32_16x16x32_bf16 v[208:211], v[68:71], v[88:91], v[208:211]
    s_add_u32 m0, s35, 26624
    s_add_u32 s36, s33, 82816
    buffer_load_dwordx4 v12, s[24:27], s36 offen lds
    v_mfma_f32_16x16x32_bf16 v[212:215], v[68:71], v[92:95], v[212:215]
    s_add_u32 m0, s35, 27648
    s_add_u32 s36, s33, 93056
    buffer_load_dwordx4 v13, s[24:27], s36 offen lds
    v_mfma_f32_16x16x32_bf16 v[216:219], v[72:75], v[80:83], v[216:219]
    s_add_u32 m0, s35, 28672
    s_add_u32 s36, s34, 896
    buffer_load_dwordx4 v8, s[8:11], s36 offen lds
    v_mfma_f32_16x16x32_bf16 v[220:223], v[72:75], v[84:87], v[220:223]
    s_add_u32 m0, s35, 29696
    s_add_u32 s36, s34, 46976
    buffer_load_dwordx4 v9, s[8:11], s36 offen lds
    v_mfma_f32_16x16x32_bf16 v[224:227], v[72:75], v[88:91], v[224:227]
    s_add_u32 m0, s35, 30720
    s_add_u32 s36, s34, 93056
    buffer_load_dwordx4 v8, s[8:11], s36 offen lds
    v_mfma_f32_16x16x32_bf16 v[228:231], v[72:75], v[92:95], v[228:231]
    s_add_u32 m0, s35, 31744
    s_add_u32 s36, s34, 139136
    buffer_load_dwordx4 v9, s[8:11], s36 offen lds
    v_mfma_f32_16x16x32_bf16 v[232:235], v[76:79], v[80:83], v[232:235]
    s_add_u32 m0, s35, 32768
    s_add_u32 s36, s34, 185216
    buffer_load_dwordx4 v8, s[8:11], s36 offen lds
    v_mfma_f32_16x16x32_bf16 v[236:239], v[76:79], v[84:87], v[236:239]
    s_add_u32 m0, s35, 33792
    s_add_u32 s36, s34, 231296
    buffer_load_dwordx4 v9, s[8:11], s36 offen lds
    v_mfma_f32_16x16x32_bf16 v[240:243], v[76:79], v[88:91], v[240:243]
    s_add_u32 m0, s35, 34816
    s_add_u32 s36, s34, 277376
    buffer_load_dwordx4 v8, s[8:11], s36 offen lds
    v_mfma_f32_16x16x32_bf16 v[244:247], v[76:79], v[92:95], v[244:247]
    s_add_u32 m0, s35, 35840
    s_add_u32 s36, s34, 323456
    buffer_load_dwordx4 v9, s[8:11], s36 offen lds
    s_waitcnt lgkmcnt(0)
    s_waitcnt vmcnt(18)
    v_mfma_f32_16x16x32_bf16 v[168:171], v[96:99], v[116:119], v[168:171]
    ds_read_b128 v[24:27], v10 offset:0
    v_mfma_f32_16x16x32_bf16 v[172:175], v[96:99], v[120:123], v[172:175]
    ds_read_b128 v[28:31], v10 offset:2048
    v_mfma_f32_16x16x32_bf16 v[176:179], v[96:99], v[124:127], v[176:179]
    ds_read_b128 v[32:35], v10 offset:4096
    v_mfma_f32_16x16x32_bf16 v[180:183], v[96:99], v[128:131], v[180:183]
    ds_read_b128 v[36:39], v10 offset:6144
    v_mfma_f32_16x16x32_bf16 v[184:187], v[100:103], v[116:119], v[184:187]
    ds_read_b128 v[40:43], v10 offset:8192
    v_mfma_f32_16x16x32_bf16 v[188:191], v[100:103], v[120:123], v[188:191]
    ds_read_b128 v[44:47], v10 offset:10240
    v_mfma_f32_16x16x32_bf16 v[192:195], v[100:103], v[124:127], v[192:195]
    ds_read_b128 v[48:51], v10 offset:12288
    v_mfma_f32_16x16x32_bf16 v[196:199], v[100:103], v[128:131], v[196:199]
    ds_read_b128 v[52:55], v10 offset:14336
    v_mfma_f32_16x16x32_bf16 v[200:203], v[104:107], v[116:119], v[200:203]
    ds_read_b128 v[56:59], v10 offset:16384
    v_mfma_f32_16x16x32_bf16 v[204:207], v[104:107], v[120:123], v[204:207]
    ds_read_b128 v[60:63], v11 offset:0
    v_mfma_f32_16x16x32_bf16 v[208:211], v[104:107], v[124:127], v[208:211]
    ds_read_b128 v[64:67], v11 offset:2048
    v_mfma_f32_16x16x32_bf16 v[212:215], v[104:107], v[128:131], v[212:215]
    ds_read_b128 v[68:71], v11 offset:4096
    v_mfma_f32_16x16x32_bf16 v[216:219], v[108:111], v[116:119], v[216:219]
    ds_read_b128 v[72:75], v11 offset:6144
    v_mfma_f32_16x16x32_bf16 v[220:223], v[108:111], v[120:123], v[220:223]
    ds_read_b128 v[76:79], v11 offset:8192
    v_mfma_f32_16x16x32_bf16 v[224:227], v[108:111], v[124:127], v[224:227]
    ds_read_b128 v[80:83], v11 offset:10240
    v_mfma_f32_16x16x32_bf16 v[228:231], v[108:111], v[128:131], v[228:231]
    ds_read_b128 v[84:87], v11 offset:12288
    v_mfma_f32_16x16x32_bf16 v[232:235], v[112:115], v[116:119], v[232:235]
    ds_read_b128 v[88:91], v11 offset:14336
    v_mfma_f32_16x16x32_bf16 v[236:239], v[112:115], v[120:123], v[236:239]
    ds_read_b128 v[92:95], v11 offset:16384
    v_mfma_f32_16x16x32_bf16 v[240:243], v[112:115], v[124:127], v[240:243]
    v_mfma_f32_16x16x32_bf16 v[244:247], v[112:115], v[128:131], v[244:247]
    v_mfma_f32_16x16x32_bf16 v[168:171], v[132:135], v[152:155], v[168:171]
    v_mfma_f32_16x16x32_bf16 v[172:175], v[132:135], v[156:159], v[172:175]
    s_waitcnt lgkmcnt(0)
    v_mfma_f32_16x16x32_bf16 v[176:179], v[132:135], v[160:163], v[176:179]
    s_add_u32 m0, s35, 0
    s_add_u32 s36, s33, 1024
    buffer_load_dwordx4 v12, s[24:27], s36 offen lds
    v_mfma_f32_16x16x32_bf16 v[180:183], v[132:135], v[164:167], v[180:183]
    s_add_u32 m0, s35, 1024
    s_add_u32 s36, s33, 11264
    buffer_load_dwordx4 v13, s[24:27], s36 offen lds
    v_mfma_f32_16x16x32_bf16 v[184:187], v[136:139], v[152:155], v[184:187]
    s_add_u32 m0, s35, 2048
    s_add_u32 s36, s33, 21504
    buffer_load_dwordx4 v12, s[24:27], s36 offen lds
    v_mfma_f32_16x16x32_bf16 v[188:191], v[136:139], v[156:159], v[188:191]
    s_add_u32 m0, s35, 3072
    s_add_u32 s36, s33, 31744
    buffer_load_dwordx4 v13, s[24:27], s36 offen lds
    v_mfma_f32_16x16x32_bf16 v[192:195], v[136:139], v[160:163], v[192:195]
    s_add_u32 m0, s35, 4096
    s_add_u32 s36, s33, 41984
    buffer_load_dwordx4 v12, s[24:27], s36 offen lds
    v_mfma_f32_16x16x32_bf16 v[196:199], v[136:139], v[164:167], v[196:199]
    s_add_u32 m0, s35, 5120
    s_add_u32 s36, s33, 52224
    buffer_load_dwordx4 v13, s[24:27], s36 offen lds
    v_mfma_f32_16x16x32_bf16 v[200:203], v[140:143], v[152:155], v[200:203]
    s_add_u32 m0, s35, 6144
    s_add_u32 s36, s33, 62464
    buffer_load_dwordx4 v12, s[24:27], s36 offen lds
    v_mfma_f32_16x16x32_bf16 v[204:207], v[140:143], v[156:159], v[204:207]
    s_add_u32 m0, s35, 7168
    s_add_u32 s36, s33, 72704
    buffer_load_dwordx4 v13, s[24:27], s36 offen lds
    v_mfma_f32_16x16x32_bf16 v[208:211], v[140:143], v[160:163], v[208:211]
    s_add_u32 m0, s35, 8192
    s_add_u32 s36, s33, 82944
    buffer_load_dwordx4 v12, s[24:27], s36 offen lds
    v_mfma_f32_16x16x32_bf16 v[212:215], v[140:143], v[164:167], v[212:215]
    s_add_u32 m0, s35, 9216
    s_add_u32 s36, s33, 93184
    buffer_load_dwordx4 v13, s[24:27], s36 offen lds
    v_mfma_f32_16x16x32_bf16 v[216:219], v[144:147], v[152:155], v[216:219]
    s_add_u32 m0, s35, 10240
    s_add_u32 s36, s34, 1024
    buffer_load_dwordx4 v8, s[8:11], s36 offen lds
    v_mfma_f32_16x16x32_bf16 v[220:223], v[144:147], v[156:159], v[220:223]
    s_add_u32 m0, s35, 11264
    s_add_u32 s36, s34, 47104
    buffer_load_dwordx4 v9, s[8:11], s36 offen lds
    v_mfma_f32_16x16x32_bf16 v[224:227], v[144:147], v[160:163], v[224:227]
    s_add_u32 m0, s35, 12288
    s_add_u32 s36, s34, 93184
    buffer_load_dwordx4 v8, s[8:11], s36 offen lds
    v_mfma_f32_16x16x32_bf16 v[228:231], v[144:147], v[164:167], v[228:231]
    s_add_u32 m0, s35, 13312
    s_add_u32 s36, s34, 139264
    buffer_load_dwordx4 v9, s[8:11], s36 offen lds
    v_mfma_f32_16x16x32_bf16 v[232:235], v[148:151], v[152:155], v[232:235]
    s_add_u32 m0, s35, 14336
    s_add_u32 s36, s34, 185344
    buffer_load_dwordx4 v8, s[8:11], s36 offen lds
    v_mfma_f32_16x16x32_bf16 v[236:239], v[148:151], v[156:159], v[236:239]
    s_add_u32 m0, s35, 15360
    s_add_u32 s36, s34, 231424
    buffer_load_dwordx4 v9, s[8:11], s36 offen lds
    v_mfma_f32_16x16x32_bf16 v[240:243], v[148:151], v[160:163], v[240:243]
    s_add_u32 m0, s35, 16384
    s_add_u32 s36, s34, 277504
    buffer_load_dwordx4 v8, s[8:11], s36 offen lds
    v_mfma_f32_16x16x32_bf16 v[244:247], v[148:151], v[164:167], v[244:247]
    s_add_u32 m0, s35, 17408
    s_add_u32 s36, s34, 323584
    buffer_load_dwordx4 v9, s[8:11], s36 offen lds
    s_waitcnt lgkmcnt(0)
    s_waitcnt vmcnt(18)
    v_mfma_f32_16x16x32_bf16 v[168:171], v[24:27], v[44:47], v[168:171]
    ds_read_b128 v[96:99], v10 offset:18432
    v_mfma_f32_16x16x32_bf16 v[172:175], v[24:27], v[48:51], v[172:175]
    ds_read_b128 v[100:103], v10 offset:20480
    v_mfma_f32_16x16x32_bf16 v[176:179], v[24:27], v[52:55], v[176:179]
    ds_read_b128 v[104:107], v10 offset:22528
    v_mfma_f32_16x16x32_bf16 v[180:183], v[24:27], v[56:59], v[180:183]
    ds_read_b128 v[108:111], v10 offset:24576
    v_mfma_f32_16x16x32_bf16 v[184:187], v[28:31], v[44:47], v[184:187]
    ds_read_b128 v[112:115], v10 offset:26624
    v_mfma_f32_16x16x32_bf16 v[188:191], v[28:31], v[48:51], v[188:191]
    ds_read_b128 v[116:119], v10 offset:28672
    v_mfma_f32_16x16x32_bf16 v[192:195], v[28:31], v[52:55], v[192:195]
    ds_read_b128 v[120:123], v10 offset:30720
    v_mfma_f32_16x16x32_bf16 v[196:199], v[28:31], v[56:59], v[196:199]
    ds_read_b128 v[124:127], v10 offset:32768
    v_mfma_f32_16x16x32_bf16 v[200:203], v[32:35], v[44:47], v[200:203]
    ds_read_b128 v[128:131], v10 offset:34816
    v_mfma_f32_16x16x32_bf16 v[204:207], v[32:35], v[48:51], v[204:207]
    ds_read_b128 v[132:135], v11 offset:18432
    v_mfma_f32_16x16x32_bf16 v[208:211], v[32:35], v[52:55], v[208:211]
    ds_read_b128 v[136:139], v11 offset:20480
    v_mfma_f32_16x16x32_bf16 v[212:215], v[32:35], v[56:59], v[212:215]
    ds_read_b128 v[140:143], v11 offset:22528
    v_mfma_f32_16x16x32_bf16 v[216:219], v[36:39], v[44:47], v[216:219]
    ds_read_b128 v[144:147], v11 offset:24576
    v_mfma_f32_16x16x32_bf16 v[220:223], v[36:39], v[48:51], v[220:223]
    ds_read_b128 v[148:151], v11 offset:26624
    v_mfma_f32_16x16x32_bf16 v[224:227], v[36:39], v[52:55], v[224:227]
    ds_read_b128 v[152:155], v11 offset:28672
    v_mfma_f32_16x16x32_bf16 v[228:231], v[36:39], v[56:59], v[228:231]
    ds_read_b128 v[156:159], v11 offset:30720
    v_mfma_f32_16x16x32_bf16 v[232:235], v[40:43], v[44:47], v[232:235]
    ds_read_b128 v[160:163], v11 offset:32768
    v_mfma_f32_16x16x32_bf16 v[236:239], v[40:43], v[48:51], v[236:239]
    ds_read_b128 v[164:167], v11 offset:34816
    v_mfma_f32_16x16x32_bf16 v[240:243], v[40:43], v[52:55], v[240:243]
    v_mfma_f32_16x16x32_bf16 v[244:247], v[40:43], v[56:59], v[244:247]
    v_mfma_f32_16x16x32_bf16 v[168:171], v[60:63], v[80:83], v[168:171]
    v_mfma_f32_16x16x32_bf16 v[172:175], v[60:63], v[84:87], v[172:175]
    s_waitcnt lgkmcnt(0)
    v_mfma_f32_16x16x32_bf16 v[176:179], v[60:63], v[88:91], v[176:179]
    s_add_u32 m0, s35, 18432
    s_add_u32 s36, s33, 1152
    buffer_load_dwordx4 v12, s[24:27], s36 offen lds
    v_mfma_f32_16x16x32_bf16 v[180:183], v[60:63], v[92:95], v[180:183]
    s_add_u32 m0, s35, 19456
    s_add_u32 s36, s33, 11392
    buffer_load_dwordx4 v13, s[24:27], s36 offen lds
    v_mfma_f32_16x16x32_bf16 v[184:187], v[64:67], v[80:83], v[184:187]
    s_add_u32 m0, s35, 20480
    s_add_u32 s36, s33, 21632
    buffer_load_dwordx4 v12, s[24:27], s36 offen lds
    v_mfma_f32_16x16x32_bf16 v[188:191], v[64:67], v[84:87], v[188:191]
    s_add_u32 m0, s35, 21504
    s_add_u32 s36, s33, 31872
    buffer_load_dwordx4 v13, s[24:27], s36 offen lds
    v_mfma_f32_16x16x32_bf16 v[192:195], v[64:67], v[88:91], v[192:195]
    s_add_u32 m0, s35, 22528
    s_add_u32 s36, s33, 42112
    buffer_load_dwordx4 v12, s[24:27], s36 offen lds
    v_mfma_f32_16x16x32_bf16 v[196:199], v[64:67], v[92:95], v[196:199]
    s_add_u32 m0, s35, 23552
    s_add_u32 s36, s33, 52352
    buffer_load_dwordx4 v13, s[24:27], s36 offen lds
    v_mfma_f32_16x16x32_bf16 v[200:203], v[68:71], v[80:83], v[200:203]
    s_add_u32 m0, s35, 24576
    s_add_u32 s36, s33, 62592
    buffer_load_dwordx4 v12, s[24:27], s36 offen lds
    v_mfma_f32_16x16x32_bf16 v[204:207], v[68:71], v[84:87], v[204:207]
    s_add_u32 m0, s35, 25600
    s_add_u32 s36, s33, 72832
    buffer_load_dwordx4 v13, s[24:27], s36 offen lds
    v_mfma_f32_16x16x32_bf16 v[208:211], v[68:71], v[88:91], v[208:211]
    s_add_u32 m0, s35, 26624
    s_add_u32 s36, s33, 83072
    buffer_load_dwordx4 v12, s[24:27], s36 offen lds
    v_mfma_f32_16x16x32_bf16 v[212:215], v[68:71], v[92:95], v[212:215]
    s_add_u32 m0, s35, 27648
    s_add_u32 s36, s33, 93312
    buffer_load_dwordx4 v13, s[24:27], s36 offen lds
    v_mfma_f32_16x16x32_bf16 v[216:219], v[72:75], v[80:83], v[216:219]
    s_add_u32 m0, s35, 28672
    s_add_u32 s36, s34, 1152
    buffer_load_dwordx4 v8, s[8:11], s36 offen lds
    v_mfma_f32_16x16x32_bf16 v[220:223], v[72:75], v[84:87], v[220:223]
    s_add_u32 m0, s35, 29696
    s_add_u32 s36, s34, 47232
    buffer_load_dwordx4 v9, s[8:11], s36 offen lds
    v_mfma_f32_16x16x32_bf16 v[224:227], v[72:75], v[88:91], v[224:227]
    s_add_u32 m0, s35, 30720
    s_add_u32 s36, s34, 93312
    buffer_load_dwordx4 v8, s[8:11], s36 offen lds
    v_mfma_f32_16x16x32_bf16 v[228:231], v[72:75], v[92:95], v[228:231]
    s_add_u32 m0, s35, 31744
    s_add_u32 s36, s34, 139392
    buffer_load_dwordx4 v9, s[8:11], s36 offen lds
    v_mfma_f32_16x16x32_bf16 v[232:235], v[76:79], v[80:83], v[232:235]
    s_add_u32 m0, s35, 32768
    s_add_u32 s36, s34, 185472
    buffer_load_dwordx4 v8, s[8:11], s36 offen lds
    v_mfma_f32_16x16x32_bf16 v[236:239], v[76:79], v[84:87], v[236:239]
    s_add_u32 m0, s35, 33792
    s_add_u32 s36, s34, 231552
    buffer_load_dwordx4 v9, s[8:11], s36 offen lds
    v_mfma_f32_16x16x32_bf16 v[240:243], v[76:79], v[88:91], v[240:243]
    s_add_u32 m0, s35, 34816
    s_add_u32 s36, s34, 277632
    buffer_load_dwordx4 v8, s[8:11], s36 offen lds
    v_mfma_f32_16x16x32_bf16 v[244:247], v[76:79], v[92:95], v[244:247]
    s_add_u32 m0, s35, 35840
    s_add_u32 s36, s34, 323712
    buffer_load_dwordx4 v9, s[8:11], s36 offen lds
    s_waitcnt lgkmcnt(0)
    s_waitcnt vmcnt(18)
    v_mfma_f32_16x16x32_bf16 v[168:171], v[96:99], v[116:119], v[168:171]
    ds_read_b128 v[24:27], v10 offset:0
    v_mfma_f32_16x16x32_bf16 v[172:175], v[96:99], v[120:123], v[172:175]
    ds_read_b128 v[28:31], v10 offset:2048
    v_mfma_f32_16x16x32_bf16 v[176:179], v[96:99], v[124:127], v[176:179]
    ds_read_b128 v[32:35], v10 offset:4096
    v_mfma_f32_16x16x32_bf16 v[180:183], v[96:99], v[128:131], v[180:183]
    ds_read_b128 v[36:39], v10 offset:6144
    v_mfma_f32_16x16x32_bf16 v[184:187], v[100:103], v[116:119], v[184:187]
    ds_read_b128 v[40:43], v10 offset:8192
    v_mfma_f32_16x16x32_bf16 v[188:191], v[100:103], v[120:123], v[188:191]
    ds_read_b128 v[44:47], v10 offset:10240
    v_mfma_f32_16x16x32_bf16 v[192:195], v[100:103], v[124:127], v[192:195]
    ds_read_b128 v[48:51], v10 offset:12288
    v_mfma_f32_16x16x32_bf16 v[196:199], v[100:103], v[128:131], v[196:199]
    ds_read_b128 v[52:55], v10 offset:14336
    v_mfma_f32_16x16x32_bf16 v[200:203], v[104:107], v[116:119], v[200:203]
    ds_read_b128 v[56:59], v10 offset:16384
    v_mfma_f32_16x16x32_bf16 v[204:207], v[104:107], v[120:123], v[204:207]
    ds_read_b128 v[60:63], v11 offset:0
    v_mfma_f32_16x16x32_bf16 v[208:211], v[104:107], v[124:127], v[208:211]
    ds_read_b128 v[64:67], v11 offset:2048
    v_mfma_f32_16x16x32_bf16 v[212:215], v[104:107], v[128:131], v[212:215]
    ds_read_b128 v[68:71], v11 offset:4096
    v_mfma_f32_16x16x32_bf16 v[216:219], v[108:111], v[116:119], v[216:219]
    ds_read_b128 v[72:75], v11 offset:6144
    v_mfma_f32_16x16x32_bf16 v[220:223], v[108:111], v[120:123], v[220:223]
    ds_read_b128 v[76:79], v11 offset:8192
    v_mfma_f32_16x16x32_bf16 v[224:227], v[108:111], v[124:127], v[224:227]
    ds_read_b128 v[80:83], v11 offset:10240
    v_mfma_f32_16x16x32_bf16 v[228:231], v[108:111], v[128:131], v[228:231]
    ds_read_b128 v[84:87], v11 offset:12288
    v_mfma_f32_16x16x32_bf16 v[232:235], v[112:115], v[116:119], v[232:235]
    ds_read_b128 v[88:91], v11 offset:14336
    v_mfma_f32_16x16x32_bf16 v[236:239], v[112:115], v[120:123], v[236:239]
    ds_read_b128 v[92:95], v11 offset:16384
    v_mfma_f32_16x16x32_bf16 v[240:243], v[112:115], v[124:127], v[240:243]
    v_mfma_f32_16x16x32_bf16 v[244:247], v[112:115], v[128:131], v[244:247]
    v_mfma_f32_16x16x32_bf16 v[168:171], v[132:135], v[152:155], v[168:171]
    v_mfma_f32_16x16x32_bf16 v[172:175], v[132:135], v[156:159], v[172:175]
    v_mfma_f32_16x16x32_bf16 v[176:179], v[132:135], v[160:163], v[176:179]
    v_mfma_f32_16x16x32_bf16 v[180:183], v[132:135], v[164:167], v[180:183]
    v_mfma_f32_16x16x32_bf16 v[184:187], v[136:139], v[152:155], v[184:187]
    v_mfma_f32_16x16x32_bf16 v[188:191], v[136:139], v[156:159], v[188:191]
    v_mfma_f32_16x16x32_bf16 v[192:195], v[136:139], v[160:163], v[192:195]
    v_mfma_f32_16x16x32_bf16 v[196:199], v[136:139], v[164:167], v[196:199]
    v_mfma_f32_16x16x32_bf16 v[200:203], v[140:143], v[152:155], v[200:203]
    v_mfma_f32_16x16x32_bf16 v[204:207], v[140:143], v[156:159], v[204:207]
    v_mfma_f32_16x16x32_bf16 v[208:211], v[140:143], v[160:163], v[208:211]
    v_mfma_f32_16x16x32_bf16 v[212:215], v[140:143], v[164:167], v[212:215]
    v_mfma_f32_16x16x32_bf16 v[216:219], v[144:147], v[152:155], v[216:219]
    v_mfma_f32_16x16x32_bf16 v[220:223], v[144:147], v[156:159], v[220:223]
    v_mfma_f32_16x16x32_bf16 v[224:227], v[144:147], v[160:163], v[224:227]
    v_mfma_f32_16x16x32_bf16 v[228:231], v[144:147], v[164:167], v[228:231]
    v_mfma_f32_16x16x32_bf16 v[232:235], v[148:151], v[152:155], v[232:235]
    v_mfma_f32_16x16x32_bf16 v[236:239], v[148:151], v[156:159], v[236:239]
    v_mfma_f32_16x16x32_bf16 v[240:243], v[148:151], v[160:163], v[240:243]
    v_mfma_f32_16x16x32_bf16 v[244:247], v[148:151], v[164:167], v[244:247]
    s_waitcnt lgkmcnt(0)
    s_waitcnt vmcnt(0)
    v_mfma_f32_16x16x32_bf16 v[168:171], v[24:27], v[44:47], v[168:171]
    ds_read_b128 v[96:99], v10 offset:18432
    v_mfma_f32_16x16x32_bf16 v[172:175], v[24:27], v[48:51], v[172:175]
    ds_read_b128 v[100:103], v10 offset:20480
    v_mfma_f32_16x16x32_bf16 v[176:179], v[24:27], v[52:55], v[176:179]
    ds_read_b128 v[104:107], v10 offset:22528
    v_mfma_f32_16x16x32_bf16 v[180:183], v[24:27], v[56:59], v[180:183]
    ds_read_b128 v[108:111], v10 offset:24576
    v_mfma_f32_16x16x32_bf16 v[184:187], v[28:31], v[44:47], v[184:187]
    ds_read_b128 v[112:115], v10 offset:26624
    v_mfma_f32_16x16x32_bf16 v[188:191], v[28:31], v[48:51], v[188:191]
    ds_read_b128 v[116:119], v10 offset:28672
    v_mfma_f32_16x16x32_bf16 v[192:195], v[28:31], v[52:55], v[192:195]
    ds_read_b128 v[120:123], v10 offset:30720
    v_mfma_f32_16x16x32_bf16 v[196:199], v[28:31], v[56:59], v[196:199]
    ds_read_b128 v[124:127], v10 offset:32768
    v_mfma_f32_16x16x32_bf16 v[200:203], v[32:35], v[44:47], v[200:203]
    ds_read_b128 v[128:131], v10 offset:34816
    v_mfma_f32_16x16x32_bf16 v[204:207], v[32:35], v[48:51], v[204:207]
    ds_read_b128 v[132:135], v11 offset:18432
    v_mfma_f32_16x16x32_bf16 v[208:211], v[32:35], v[52:55], v[208:211]
    ds_read_b128 v[136:139], v11 offset:20480
    v_mfma_f32_16x16x32_bf16 v[212:215], v[32:35], v[56:59], v[212:215]
    ds_read_b128 v[140:143], v11 offset:22528
    v_mfma_f32_16x16x32_bf16 v[216:219], v[36:39], v[44:47], v[216:219]
    ds_read_b128 v[144:147], v11 offset:24576
    v_mfma_f32_16x16x32_bf16 v[220:223], v[36:39], v[48:51], v[220:223]
    ds_read_b128 v[148:151], v11 offset:26624
    v_mfma_f32_16x16x32_bf16 v[224:227], v[36:39], v[52:55], v[224:227]
    ds_read_b128 v[152:155], v11 offset:28672
    v_mfma_f32_16x16x32_bf16 v[228:231], v[36:39], v[56:59], v[228:231]
    ds_read_b128 v[156:159], v11 offset:30720
    v_mfma_f32_16x16x32_bf16 v[232:235], v[40:43], v[44:47], v[232:235]
    ds_read_b128 v[160:163], v11 offset:32768
    v_mfma_f32_16x16x32_bf16 v[236:239], v[40:43], v[48:51], v[236:239]
    ds_read_b128 v[164:167], v11 offset:34816
    v_mfma_f32_16x16x32_bf16 v[240:243], v[40:43], v[52:55], v[240:243]
    v_mfma_f32_16x16x32_bf16 v[244:247], v[40:43], v[56:59], v[244:247]
    v_mfma_f32_16x16x32_bf16 v[168:171], v[60:63], v[80:83], v[168:171]
    v_mfma_f32_16x16x32_bf16 v[172:175], v[60:63], v[84:87], v[172:175]
    v_mfma_f32_16x16x32_bf16 v[176:179], v[60:63], v[88:91], v[176:179]
    v_mfma_f32_16x16x32_bf16 v[180:183], v[60:63], v[92:95], v[180:183]
    v_mfma_f32_16x16x32_bf16 v[184:187], v[64:67], v[80:83], v[184:187]
    v_mfma_f32_16x16x32_bf16 v[188:191], v[64:67], v[84:87], v[188:191]
    v_mfma_f32_16x16x32_bf16 v[192:195], v[64:67], v[88:91], v[192:195]
    v_mfma_f32_16x16x32_bf16 v[196:199], v[64:67], v[92:95], v[196:199]
    v_mfma_f32_16x16x32_bf16 v[200:203], v[68:71], v[80:83], v[200:203]
    v_mfma_f32_16x16x32_bf16 v[204:207], v[68:71], v[84:87], v[204:207]
    v_mfma_f32_16x16x32_bf16 v[208:211], v[68:71], v[88:91], v[208:211]
    v_mfma_f32_16x16x32_bf16 v[212:215], v[68:71], v[92:95], v[212:215]
    v_mfma_f32_16x16x32_bf16 v[216:219], v[72:75], v[80:83], v[216:219]
    v_mfma_f32_16x16x32_bf16 v[220:223], v[72:75], v[84:87], v[220:223]
    v_mfma_f32_16x16x32_bf16 v[224:227], v[72:75], v[88:91], v[224:227]
    v_mfma_f32_16x16x32_bf16 v[228:231], v[72:75], v[92:95], v[228:231]
    v_mfma_f32_16x16x32_bf16 v[232:235], v[76:79], v[80:83], v[232:235]
    v_mfma_f32_16x16x32_bf16 v[236:239], v[76:79], v[84:87], v[236:239]
    v_mfma_f32_16x16x32_bf16 v[240:243], v[76:79], v[88:91], v[240:243]
    v_mfma_f32_16x16x32_bf16 v[244:247], v[76:79], v[92:95], v[244:247]
    s_waitcnt lgkmcnt(0)
    v_mfma_f32_16x16x32_bf16 v[168:171], v[96:99], v[116:119], v[168:171]
    v_mfma_f32_16x16x32_bf16 v[172:175], v[96:99], v[120:123], v[172:175]
    v_mfma_f32_16x16x32_bf16 v[176:179], v[96:99], v[124:127], v[176:179]
    v_mfma_f32_16x16x32_bf16 v[180:183], v[96:99], v[128:131], v[180:183]
    v_mfma_f32_16x16x32_bf16 v[184:187], v[100:103], v[116:119], v[184:187]
    v_mfma_f32_16x16x32_bf16 v[188:191], v[100:103], v[120:123], v[188:191]
    v_mfma_f32_16x16x32_bf16 v[192:195], v[100:103], v[124:127], v[192:195]
    v_mfma_f32_16x16x32_bf16 v[196:199], v[100:103], v[128:131], v[196:199]
    v_mfma_f32_16x16x32_bf16 v[200:203], v[104:107], v[116:119], v[200:203]
    v_mfma_f32_16x16x32_bf16 v[204:207], v[104:107], v[120:123], v[204:207]
    v_mfma_f32_16x16x32_bf16 v[208:211], v[104:107], v[124:127], v[208:211]
    v_mfma_f32_16x16x32_bf16 v[212:215], v[104:107], v[128:131], v[212:215]
    v_mfma_f32_16x16x32_bf16 v[216:219], v[108:111], v[116:119], v[216:219]
    v_mfma_f32_16x16x32_bf16 v[220:223], v[108:111], v[120:123], v[220:223]
    v_mfma_f32_16x16x32_bf16 v[224:227], v[108:111], v[124:127], v[224:227]
    v_mfma_f32_16x16x32_bf16 v[228:231], v[108:111], v[128:131], v[228:231]
    v_mfma_f32_16x16x32_bf16 v[232:235], v[112:115], v[116:119], v[232:235]
    v_mfma_f32_16x16x32_bf16 v[236:239], v[112:115], v[120:123], v[236:239]
    v_mfma_f32_16x16x32_bf16 v[240:243], v[112:115], v[124:127], v[240:243]
    v_mfma_f32_16x16x32_bf16 v[244:247], v[112:115], v[128:131], v[244:247]
    v_mfma_f32_16x16x32_bf16 v[168:171], v[132:135], v[152:155], v[168:171]
    v_mfma_f32_16x16x32_bf16 v[172:175], v[132:135], v[156:159], v[172:175]
    v_mfma_f32_16x16x32_bf16 v[176:179], v[132:135], v[160:163], v[176:179]
    v_mfma_f32_16x16x32_bf16 v[180:183], v[132:135], v[164:167], v[180:183]
    v_mfma_f32_16x16x32_bf16 v[184:187], v[136:139], v[152:155], v[184:187]
    v_mfma_f32_16x16x32_bf16 v[188:191], v[136:139], v[156:159], v[188:191]
    v_mfma_f32_16x16x32_bf16 v[192:195], v[136:139], v[160:163], v[192:195]
    v_mfma_f32_16x16x32_bf16 v[196:199], v[136:139], v[164:167], v[196:199]
    v_mfma_f32_16x16x32_bf16 v[200:203], v[140:143], v[152:155], v[200:203]
    v_mfma_f32_16x16x32_bf16 v[204:207], v[140:143], v[156:159], v[204:207]
    v_mfma_f32_16x16x32_bf16 v[208:211], v[140:143], v[160:163], v[208:211]
    v_mfma_f32_16x16x32_bf16 v[212:215], v[140:143], v[164:167], v[212:215]
    v_mfma_f32_16x16x32_bf16 v[216:219], v[144:147], v[152:155], v[216:219]
    v_mfma_f32_16x16x32_bf16 v[220:223], v[144:147], v[156:159], v[220:223]
    v_mfma_f32_16x16x32_bf16 v[224:227], v[144:147], v[160:163], v[224:227]
    v_mfma_f32_16x16x32_bf16 v[228:231], v[144:147], v[164:167], v[228:231]
    v_mfma_f32_16x16x32_bf16 v[232:235], v[148:151], v[152:155], v[232:235]
    v_mfma_f32_16x16x32_bf16 v[236:239], v[148:151], v[156:159], v[236:239]
    v_mfma_f32_16x16x32_bf16 v[240:243], v[148:151], v[160:163], v[240:243]
    v_mfma_f32_16x16x32_bf16 v[244:247], v[148:151], v[164:167], v[244:247]
    s_branch k2_epi
k2_ffn:
    s_add_u32 m0, s35, 0
    s_add_u32 s36, s33, 0
    buffer_load_dwordx4 v12, s[24:27], s36 offen lds
    s_add_u32 m0, s35, 1024
    s_add_u32 s36, s33, 25600
    buffer_load_dwordx4 v13, s[24:27], s36 offen lds
    s_add_u32 m0, s35, 2048
    s_add_u32 s36, s33, 51200
    buffer_load_dwordx4 v12, s[24:27], s36 offen lds
    s_add_u32 m0, s35, 3072
    s_add_u32 s36, s33, 76800
    buffer_load_dwordx4 v13, s[24:27], s36 offen lds
    s_add_u32 m0, s35, 4096
    s_add_u32 s36, s33, 102400
    buffer_load_dwordx4 v12, s[24:27], s36 offen lds
    s_add_u32 m0, s35, 5120
    s_add_u32 s36, s33, 128000
    buffer_load_dwordx4 v13, s[24:27], s36 offen lds
    s_add_u32 m0, s35, 6144
    s_add_u32 s36, s33, 153600
    buffer_load_dwordx4 v12, s[24:27], s36 offen lds
    s_add_u32 m0, s35, 7168
    s_add_u32 s36, s33, 179200
    buffer_load_dwordx4 v13, s[24:27], s36 offen lds
    s_add_u32 m0, s35, 8192
    s_add_u32 s36, s33, 204800
    buffer_load_dwordx4 v12, s[24:27], s36 offen lds
    s_add_u32 m0, s35, 9216
    s_add_u32 s36, s33, 230400
    buffer_load_dwordx4 v13, s[24:27], s36 offen lds
    s_add_u32 m0, s35, 10240
    s_add_u32 s36, s34, 0
    buffer_load_dwordx4 v8, s[8:11], s36 offen lds
    s_add_u32 m0, s35, 11264
    s_add_u32 s36, s34, 46080
    buffer_load_dwordx4 v9, s[8:11], s36 offen lds
    s_add_u32 m0, s35, 12288
    s_add_u32 s36, s34, 92160
    buffer_load_dwordx4 v8, s[8:11], s36 offen lds
    s_add_u32 m0, s35, 13312
    s_add_u32 s36, s34, 138240
    buffer_load_dwordx4 v9, s[8:11], s36 offen lds
    s_add_u32 m0, s35, 14336
    s_add_u32 s36, s34, 184320
    buffer_load_dwordx4 v8, s[8:11], s36 offen lds
    s_add_u32 m0, s35, 15360
    s_add_u32 s36, s34, 230400
    buffer_load_dwordx4 v9, s[8:11], s36 offen lds
    s_add_u32 m0, s35, 16384
    s_add_u32 s36, s34, 276480
    buffer_load_dwordx4 v8, s[8:11], s36 offen lds
    s_add_u32 m0, s35, 17408
    s_add_u32 s36, s34, 322560
    buffer_load_dwordx4 v9, s[8:11], s36 offen lds
    s_add_u32 m0, s35, 18432
    s_add_u32 s36, s33, 128
    buffer_load_dwordx4 v12, s[24:27], s36 offen lds
    s_add_u32 m0, s35, 19456
    s_add_u32 s36, s33, 25728
    buffer_load_dwordx4 v13, s[24:27], s36 offen lds
    s_add_u32 m0, s35, 20480
    s_add_u32 s36, s33, 51328
    buffer_load_dwordx4 v12, s[24:27], s36 offen lds
    s_add_u32 m0, s35, 21504
    s_add_u32 s36, s33, 76928
    buffer_load_dwordx4 v13, s[24:27], s36 offen lds
    s_add_u32 m0, s35, 22528
    s_add_u32 s36, s33, 102528
    buffer_load_dwordx4 v12, s[24:27], s36 offen lds
    s_add_u32 m0, s35, 23552
    s_add_u32 s36, s33, 128128
    buffer_load_dwordx4 v13, s[24:27], s36 offen lds
    s_add_u32 m0, s35, 24576
    s_add_u32 s36, s33, 153728
    buffer_load_dwordx4 v12, s[24:27], s36 offen lds
    s_add_u32 m0, s35, 25600
    s_add_u32 s36, s33, 179328
    buffer_load_dwordx4 v13, s[24:27], s36 offen lds
    s_add_u32 m0, s35, 26624
    s_add_u32 s36, s33, 204928
    buffer_load_dwordx4 v12, s[24:27], s36 offen lds
    s_add_u32 m0, s35, 27648
    s_add_u32 s36, s33, 230528
    buffer_load_dwordx4 v13, s[24:27], s36 offen lds
    s_add_u32 m0, s35, 28672
    s_add_u32 s36, s34, 128
    buffer_load_dwordx4 v8, s[8:11], s36 offen lds
    s_add_u32 m0, s35, 29696
    s_add_u32 s36, s34, 46208
    buffer_load_dwordx4 v9, s[8:11], s36 offen lds
    s_add_u32 m0, s35, 30720
    s_add_u32 s36, s34, 92288
    buffer_load_dwordx4 v8, s[8:11], s36 offen lds
    s_add_u32 m0, s35, 31744
    s_add_u32 s36, s34, 138368
    buffer_load_dwordx4 v9, s[8:11], s36 offen lds
    s_add_u32 m0, s35, 32768
    s_add_u32 s36, s34, 184448
    buffer_load_dwordx4 v8, s[8:11], s36 offen lds
    s_add_u32 m0, s35, 33792
    s_add_u32 s36, s34, 230528
    buffer_load_dwordx4 v9, s[8:11], s36 offen lds
    s_add_u32 m0, s35, 34816
    s_add_u32 s36, s34, 276608
    buffer_load_dwordx4 v8, s[8:11], s36 offen lds
    s_add_u32 m0, s35, 35840
    s_add_u32 s36, s34, 322688
    buffer_load_dwordx4 v9, s[8:11], s36 offen lds
    s_waitcnt vmcnt(18)
    ds_read_b128 v[24:27], v10 offset:0
    ds_read_b128 v[28:31], v10 offset:2048
    ds_read_b128 v[32:35], v10 offset:4096
    ds_read_b128 v[36:39], v10 offset:6144
    ds_read_b128 v[40:43], v10 offset:8192
    ds_read_b128 v[44:47], v10 offset:10240
    ds_read_b128 v[48:51], v10 offset:12288
    ds_read_b128 v[52:55], v10 offset:14336
    ds_read_b128 v[56:59], v10 offset:16384
    ds_read_b128 v[60:63], v11 offset:0
    ds_read_b128 v[64:67], v11 offset:2048
    ds_read_b128 v[68:71], v11 offset:4096
    ds_read_b128 v[72:75], v11 offset:6144
    ds_read_b128 v[76:79], v11 offset:8192
    ds_read_b128 v[80:83], v11 offset:10240
    ds_read_b128 v[84:87], v11 offset:12288
    ds_read_b128 v[88:91], v11 offset:14336
    ds_read_b128 v[92:95], v11 offset:16384
    s_waitcnt lgkmcnt(0)
    s_add_u32 m0, s35, 0
    s_add_u32 s36, s33, 256
    buffer_load_dwordx4 v12, s[24:27], s36 offen lds
    s_add_u32 m0, s35, 1024
    s_add_u32 s36, s33, 25856
    buffer_load_dwordx4 v13, s[24:27], s36 offen lds
    s_add_u32 m0, s35, 2048
    s_add_u32 s36, s33, 51456
    buffer_load_dwordx4 v12, s[24:27], s36 offen lds
    s_add_u32 m0, s35, 3072
    s_add_u32 s36, s33, 77056
    buffer_load_dwordx4 v13, s[24:27], s36 offen lds
    s_add_u32 m0, s35, 4096
    s_add_u32 s36, s33, 102656
    buffer_load_dwordx4 v12, s[24:27], s36 offen lds
    s_add_u32 m0, s35, 5120
    s_add_u32 s36, s33, 128256
    buffer_load_dwordx4 v13, s[24:27], s36 offen lds
    s_add_u32 m0, s35, 6144
    s_add_u32 s36, s33, 153856
    buffer_load_dwordx4 v12, s[24:27], s36 offen lds
    s_add_u32 m0, s35, 7168
    s_add_u32 s36, s33, 179456
    buffer_load_dwordx4 v13, s[24:27], s36 offen lds
    s_add_u32 m0, s35, 8192
    s_add_u32 s36, s33, 205056
    buffer_load_dwordx4 v12, s[24:27], s36 offen lds
    s_add_u32 m0, s35, 9216
    s_add_u32 s36, s33, 230656
    buffer_load_dwordx4 v13, s[24:27], s36 offen lds
    s_add_u32 m0, s35, 10240
    s_add_u32 s36, s34, 256
    buffer_load_dwordx4 v8, s[8:11], s36 offen lds
    s_add_u32 m0, s35, 11264
    s_add_u32 s36, s34, 46336
    buffer_load_dwordx4 v9, s[8:11], s36 offen lds
    s_add_u32 m0, s35, 12288
    s_add_u32 s36, s34, 92416
    buffer_load_dwordx4 v8, s[8:11], s36 offen lds
    s_add_u32 m0, s35, 13312
    s_add_u32 s36, s34, 138496
    buffer_load_dwordx4 v9, s[8:11], s36 offen lds
    s_add_u32 m0, s35, 14336
    s_add_u32 s36, s34, 184576
    buffer_load_dwordx4 v8, s[8:11], s36 offen lds
    s_add_u32 m0, s35, 15360
    s_add_u32 s36, s34, 230656
    buffer_load_dwordx4 v9, s[8:11], s36 offen lds
    s_add_u32 m0, s35, 16384
    s_add_u32 s36, s34, 276736
    buffer_load_dwordx4 v8, s[8:11], s36 offen lds
    s_add_u32 m0, s35, 17408
    s_add_u32 s36, s34, 322816
    buffer_load_dwordx4 v9, s[8:11], s36 offen lds
    s_waitcnt vmcnt(18)
    v_mfma_f32_16x16x32_bf16 v[168:171], v[24:27], v[44:47], 0
    ds_read_b128 v[96:99], v10 offset:18432
    v_mfma_f32_16x16x32_bf16 v[172:175], v[24:27], v[48:51], 0
    ds_read_b128 v[100:103], v10 offset:20480
    v_mfma_f32_16x16x32_bf16 v[176:179], v[24:27], v[52:55], 0
    ds_read_b128 v[104:107], v10 offset:22528
    v_mfma_f32_16x16x32_bf16 v[180:183], v[24:27], v[56:59], 0
    ds_read_b128 v[108:111], v10 offset:24576
    v_mfma_f32_16x16x32_bf16 v[184:187], v[28:31], v[44:47], 0
    ds_read_b128 v[112:115], v10 offset:26624
    v_mfma_f32_16x16x32_bf16 v[188:191], v[28:31], v[48:51], 0
    ds_read_b128 v[116:119], v10 offset:28672
    v_mfma_f32_16x16x32_bf16 v[192:195], v[28:31], v[52:55], 0
    ds_read_b128 v[120:123], v10 offset:30720
    v_mfma_f32_16x16x32_bf16 v[196:199], v[28:31], v[56:59], 0
    ds_read_b128 v[124:127], v10 offset:32768
    v_mfma_f32_16x16x32_bf16 v[200:203], v[32:35], v[44:47], 0
    ds_read_b128 v[128:131], v10 offset:34816
    v_mfma_f32_16x16x32_bf16 v[204:207], v[32:35], v[48:51], 0
    ds_read_b128 v[132:135], v11 offset:18432
    v_mfma_f32_16x16x32_bf16 v[208:211], v[32:35], v[52:55], 0
    ds_read_b128 v[136:139], v11 offset:20480
    v_mfma_f32_16x16x32_bf16 v[212:215], v[32:35], v[56:59], 0
    ds_read_b128 v[140:143], v11 offset:22528
    v_mfma_f32_16x16x32_bf16 v[216:219], v[36:39], v[44:47], 0
    ds_read_b128 v[144:147], v11 offset:24576
    v_mfma_f32_16x16x32_bf16 v[220:223], v[36:39], v[48:51], 0
    ds_read_b128 v[148:151], v11 offset:26624
    v_mfma_f32_16x16x32_bf16 v[224:227], v[36:39], v[52:55], 0
    ds_read_b128 v[152:155], v11 offset:28672
    v_mfma_f32_16x16x32_bf16 v[228:231], v[36:39], v[56:59], 0
    ds_read_b128 v[156:159], v11 offset:30720
    v_mfma_f32_16x16x32_bf16 v[232:235], v[40:43], v[44:47], 0
    ds_read_b128 v[160:163], v11 offset:32768
    v_mfma_f32_16x16x32_bf16 v[236:239], v[40:43], v[48:51], 0
    ds_read_b128 v[164:167], v11 offset:34816
    v_mfma_f32_16x16x32_bf16 v[240:243], v[40:43], v[52:55], 0
    v_mfma_f32_16x16x32_bf16 v[244:247], v[40:43], v[56:59], 0
    v_mfma_f32_16x16x32_bf16 v[168:171], v[60:63], v[80:83], v[168:171]
    v_mfma_f32_16x16x32_bf16 v[172:175], v[60:63], v[84:87], v[172:175]
    s_waitcnt lgkmcnt(0)
    v_mfma_f32_16x16x32_bf16 v[176:179], v[60:63], v[88:91], v[176:179]
    s_add_u32 m0, s35, 18432
    s_add_u32 s36, s33, 384
    buffer_load_dwordx4 v12, s[24:27], s36 offen lds
    v_mfma_f32_16x16x32_bf16 v[180:183], v[60:63], v[92:95], v[180:183]
    s_add_u32 m0, s35, 19456
    s_add_u32 s36, s33, 25984
    buffer_load_dwordx4 v13, s[24:27], s36 offen lds
    v_mfma_f32_16x16x32_bf16 v[184:187], v[64:67], v[80:83], v[184:187]
    s_add_u32 m0, s35, 20480
    s_add_u32 s36, s33, 51584
    buffer_load_dwordx4 v12, s[24:27], s36 offen lds
    v_mfma_f32_16x16x32_bf16 v[188:191], v[64:67], v[84:87], v[188:191]
    s_add_u32 m0, s35, 21504
    s_add_u32 s36, s33, 77184
    buffer_load_dwordx4 v13, s[24:27], s36 offen lds
    v_mfma_f32_16x16x32_bf16 v[192:195], v[64:67], v[88:91], v[192:195]
    s_add_u32 m0, s35, 22528
    s_add_u32 s36, s33, 102784
    buffer_load_dwordx4 v12, s[24:27], s36 offen lds
    v_mfma_f32_16x16x32_bf16 v[196:199], v[64:67], v[92:95], v[196:199]
    s_add_u32 m0, s35, 23552
    s_add_u32 s36, s33, 128384
    buffer_load_dwordx4 v13, s[24:27], s36 offen lds
    v_mfma_f32_16x16x32_bf16 v[200:203], v[68:71], v[80:83], v[200:203]
    s_add_u32 m0, s35, 24576
    s_add_u32 s36, s33, 153984
    buffer_load_dwordx4 v12, s[24:27], s36 offen lds
    v_mfma_f32_16x16x32_bf16 v[204:207], v[68:71], v[84:87], v[204:207]
    s_add_u32 m0, s35, 25600
    s_add_u32 s36, s33, 179584
    buffer_load_dwordx4 v13, s[24:27], s36 offen lds
    v_mfma_f32_16x16x32_bf16 v[208:211], v[68:71], v[88:91], v[208:211]
    s_add_u32 m0, s35, 26624
    s_add_u32 s36, s33, 205184
    buffer_load_dwordx4 v12, s[24:27], s36 offen lds
    v_mfma_f32_16x16x32_bf16 v[212:215], v[68:71], v[92:95], v[212:215]
    s_add_u32 m0, s35, 27648
    s_add_u32 s36, s33, 230784
    buffer_load_dwordx4 v13, s[24:27], s36 offen lds
    v_mfma_f32_16x16x32_bf16 v[216:219], v[72:75], v[80:83], v[216:219]
    s_add_u32 m0, s35, 28672
    s_add_u32 s36, s34, 384
    buffer_load_dwordx4 v8, s[8:11], s36 offen lds
    v_mfma_f32_16x16x32_bf16 v[220:223], v[72:75], v[84:87], v[220:223]
    s_add_u32 m0, s35, 29696
    s_add_u32 s36, s34, 46464
    buffer_load_dwordx4 v9, s[8:11], s36 offen lds
    v_mfma_f32_16x16x32_bf16 v[224:227], v[72:75], v[88:91], v[224:227]
    s_add_u32 m0, s35, 30720
    s_add_u32 s36, s34, 92544
    buffer_load_dwordx4 v8, s[8:11], s36 offen lds
    v_mfma_f32_16x16x32_bf16 v[228:231], v[72:75], v[92:95], v[228:231]
    s_add_u32 m0, s35, 31744
    s_add_u32 s36, s34, 138624
    buffer_load_dwordx4 v9, s[8:11], s36 offen lds
    v_mfma_f32_16x16x32_bf16 v[232:235], v[76:79], v[80:83], v[232:235]
    s_add_u32 m0, s35, 32768
    s_add_u32 s36, s34, 184704
    buffer_load_dwordx4 v8, s[8:11], s36 offen lds
    v_mfma_f32_16x16x32_bf16 v[236:239], v[76:79], v[84:87], v[236:239]
    s_add_u32 m0, s35, 33792
    s_add_u32 s36, s34, 230784
    buffer_load_dwordx4 v9, s[8:11], s36 offen lds
    v_mfma_f32_16x16x32_bf16 v[240:243], v[76:79], v[88:91], v[240:243]
    s_add_u32 m0, s35, 34816
    s_add_u32 s36, s34, 276864
    buffer_load_dwordx4 v8, s[8:11], s36 offen lds
    v_mfma_f32_16x16x32_bf16 v[244:247], v[76:79], v[92:95], v[244:247]
    s_add_u32 m0, s35, 35840
    s_add_u32 s36, s34, 322944
    buffer_load_dwordx4 v9, s[8:11], s36 offen lds
    s_waitcnt lgkmcnt(0)
    s_waitcnt vmcnt(18)
    v_mfma_f32_16x16x32_bf16 v[168:171], v[96:99], v[116:119], v[168:171]
    ds_read_b128 v[24:27], v10 offset:0
    v_mfma_f32_16x16x32_bf16 v[172:175], v[96:99], v[120:123], v[172:175]
    ds_read_b128 v[28:31], v10 offset:2048
    v_mfma_f32_16x16x32_bf16 v[176:179], v[96:99], v[124:127], v[176:179]
    ds_read_b128 v[32:35], v10 offset:4096
    v_mfma_f32_16x16x32_bf16 v[180:183], v[96:99], v[128:131], v[180:183]
    ds_read_b128 v[36:39], v10 offset:6144
    v_mfma_f32_16x16x32_bf16 v[184:187], v[100:103], v[116:119], v[184:187]
    ds_read_b128 v[40:43], v10 offset:8192
    v_mfma_f32_16x16x32_bf16 v[188:191], v[100:103], v[120:123], v[188:191]
    ds_read_b128 v[44:47], v10 offset:10240
    v_mfma_f32_16x16x32_bf16 v[192:195], v[100:103], v[124:127], v[192:195]
    ds_read_b128 v[48:51], v10 offset:12288
    v_mfma_f32_16x16x32_bf16 v[196:199], v[100:103], v[128:131], v[196:199]
    ds_read_b128 v[52:55], v10 offset:14336
    v_mfma_f32_16x16x32_bf16 v[200:203], v[104:107], v[116:119], v[200:203]
    ds_read_b128 v[56:59], v10 offset:16384
    v_mfma_f32_16x16x32_bf16 v[204:207], v[104:107], v[120:123], v[204:207]
    ds_read_b128 v[60:63], v11 offset:0
    v_mfma_f32_16x16x32_bf16 v[208:211], v[104:107], v[124:127], v[208:211]
    ds_read_b128 v[64:67], v11 offset:2048
    v_mfma_f32_16x16x32_bf16 v[212:215], v[104:107], v[128:131], v[212:215]
    ds_read_b128 v[68:71], v11 offset:4096
    v_mfma_f32_16x16x32_bf16 v[216:219], v[108:111], v[116:119], v[216:219]
    ds_read_b128 v[72:75], v11 offset:6144
    v_mfma_f32_16x16x32_bf16 v[220:223], v[108:111], v[120:123], v[220:223]
    ds_read_b128 v[76:79], v11 offset:8192
    v_mfma_f32_16x16x32_bf16 v[224:227], v[108:111], v[124:127], v[224:227]
    ds_read_b128 v[80:83], v11 offset:10240
    v_mfma_f32_16x16x32_bf16 v[228:231], v[108:111], v[128:131], v[228:231]
    ds_read_b128 v[84:87], v11 offset:12288
    v_mfma_f32_16x16x32_bf16 v[232:235], v[112:115], v[116:119], v[232:235]
    ds_read_b128 v[88:91], v11 offset:14336
    v_mfma_f32_16x16x32_bf16 v[236:239], v[112:115], v[120:123], v[236:239]
    ds_read_b128 v[92:95], v11 offset:16384
    v_mfma_f32_16x16x32_bf16 v[240:243], v[112:115], v[124:127], v[240:243]
    v_mfma_f32_16x16x32_bf16 v[244:247], v[112:115], v[128:131], v[244:247]
    v_mfma_f32_16x16x32_bf16 v[168:171], v[132:135], v[152:155], v[168:171]
    v_mfma_f32_16x16x32_bf16 v[172:175], v[132:135], v[156:159], v[172:175]
    s_waitcnt lgkmcnt(0)
    v_mfma_f32_16x16x32_bf16 v[176:179], v[132:135], v[160:163], v[176:179]
    s_add_u32 m0, s35, 0
    s_add_u32 s36, s33, 512
    buffer_load_dwordx4 v12, s[24:27], s36 offen lds
    v_mfma_f32_16x16x32_bf16 v[180:183], v[132:135], v[164:167], v[180:183]
    s_add_u32 m0, s35, 1024
    s_add_u32 s36, s33, 26112
    buffer_load_dwordx4 v13, s[24:27], s36 offen lds
    v_mfma_f32_16x16x32_bf16 v[184:187], v[136:139], v[152:155], v[184:187]
    s_add_u32 m0, s35, 2048
    s_add_u32 s36, s33, 51712
    buffer_load_dwordx4 v12, s[24:27], s36 offen lds
    v_mfma_f32_16x16x32_bf16 v[188:191], v[136:139], v[156:159], v[188:191]
    s_add_u32 m0, s35, 3072
    s_add_u32 s36, s33, 77312
    buffer_load_dwordx4 v13, s[24:27], s36 offen lds
    v_mfma_f32_16x16x32_bf16 v[192:195], v[136:139], v[160:163], v[192:195]
    s_add_u32 m0, s35, 4096
    s_add_u32 s36, s33, 102912
    buffer_load_dwordx4 v12, s[24:27], s36 offen lds
    v_mfma_f32_16x16x32_bf16 v[196:199], v[136:139], v[164:167], v[196:199]
    s_add_u32 m0, s35, 5120
    s_add_u32 s36, s33, 128512
    buffer_load_dwordx4 v13, s[24:27], s36 offen lds
    v_mfma_f32_16x16x32_bf16 v[200:203], v[140:143], v[152:155], v[200:203]
    s_add_u32 m0, s35, 6144
    s_add_u32 s36, s33, 154112
    buffer_load_dwordx4 v12, s[24:27], s36 offen lds
    v_mfma_f32_16x16x32_bf16 v[204:207], v[140:143], v[156:159], v[204:207]
    s_add_u32 m0, s35, 7168
    s_add_u32 s36, s33, 179712
    buffer_load_dwordx4 v13, s[24:27], s36 offen lds
    v_mfma_f32_16x16x32_bf16 v[208:211], v[140:143], v[160:163], v[208:211]
    s_add_u32 m0, s35, 8192
    s_add_u32 s36, s33, 205312
    buffer_load_dwordx4 v12, s[24:27], s36 offen lds
    v_mfma_f32_16x16x32_bf16 v[212:215], v[140:143], v[164:167], v[212:215]
    s_add_u32 m0, s35, 9216
    s_add_u32 s36, s33, 230912
    buffer_load_dwordx4 v13, s[24:27], s36 offen lds
    v_mfma_f32_16x16x32_bf16 v[216:219], v[144:147], v[152:155], v[216:219]
    s_add_u32 m0, s35, 10240
    s_add_u32 s36, s34, 512
    buffer_load_dwordx4 v8, s[8:11], s36 offen lds
    v_mfma_f32_16x16x32_bf16 v[220:223], v[144:147], v[156:159], v[220:223]
    s_add_u32 m0, s35, 11264
    s_add_u32 s36, s34, 46592
    buffer_load_dwordx4 v9, s[8:11], s36 offen lds
    v_mfma_f32_16x16x32_bf16 v[224:227], v[144:147], v[160:163], v[224:227]
    s_add_u32 m0, s35, 12288
    s_add_u32 s36, s34, 92672
    buffer_load_dwordx4 v8, s[8:11], s36 offen lds
    v_mfma_f32_16x16x32_bf16 v[228:231], v[144:147], v[164:167], v[228:231]
    s_add_u32 m0, s35, 13312
    s_add_u32 s36, s34, 138752
    buffer_load_dwordx4 v9, s[8:11], s36 offen lds
    v_mfma_f32_16x16x32_bf16 v[232:235], v[148:151], v[152:155], v[232:235]
    s_add_u32 m0, s35, 14336
    s_add_u32 s36, s34, 184832
    buffer_load_dwordx4 v8, s[8:11], s36 offen lds
    v_mfma_f32_16x16x32_bf16 v[236:239], v[148:151], v[156:159], v[236:239]
    s_add_u32 m0, s35, 15360
    s_add_u32 s36, s34, 230912
    buffer_load_dwordx4 v9, s[8:11], s36 offen lds
    v_mfma_f32_16x16x32_bf16 v[240:243], v[148:151], v[160:163], v[240:243]
    s_add_u32 m0, s35, 16384
    s_add_u32 s36, s34, 276992
    buffer_load_dwordx4 v8, s[8:11], s36 offen lds
    v_mfma_f32_16x16x32_bf16 v[244:247], v[148:151], v[164:167], v[244:247]
    s_add_u32 m0, s35, 17408
    s_add_u32 s36, s34, 323072
    buffer_load_dwordx4 v9, s[8:11], s36 offen lds
    s_waitcnt lgkmcnt(0)
    s_waitcnt vmcnt(18)
    v_mfma_f32_16x16x32_bf16 v[168:171], v[24:27], v[44:47], v[168:171]
    ds_read_b128 v[96:99], v10 offset:18432
    v_mfma_f32_16x16x32_bf16 v[172:175], v[24:27], v[48:51], v[172:175]
    ds_read_b128 v[100:103], v10 offset:20480
    v_mfma_f32_16x16x32_bf16 v[176:179], v[24:27], v[52:55], v[176:179]
    ds_read_b128 v[104:107], v10 offset:22528
    v_mfma_f32_16x16x32_bf16 v[180:183], v[24:27], v[56:59], v[180:183]
    ds_read_b128 v[108:111], v10 offset:24576
    v_mfma_f32_16x16x32_bf16 v[184:187], v[28:31], v[44:47], v[184:187]
    ds_read_b128 v[112:115], v10 offset:26624
    v_mfma_f32_16x16x32_bf16 v[188:191], v[28:31], v[48:51], v[188:191]
    ds_read_b128 v[116:119], v10 offset:28672
    v_mfma_f32_16x16x32_bf16 v[192:195], v[28:31], v[52:55], v[192:195]
    ds_read_b128 v[120:123], v10 offset:30720
    v_mfma_f32_16x16x32_bf16 v[196:199], v[28:31], v[56:59], v[196:199]
    ds_read_b128 v[124:127], v10 offset:32768
    v_mfma_f32_16x16x32_bf16 v[200:203], v[32:35], v[44:47], v[200:203]
    ds_read_b128 v[128:131], v10 offset:34816
    v_mfma_f32_16x16x32_bf16 v[204:207], v[32:35], v[48:51], v[204:207]
    ds_read_b128 v[132:135], v11 offset:18432
    v_mfma_f32_16x16x32_bf16 v[208:211], v[32:35], v[52:55], v[208:211]
    ds_read_b128 v[136:139], v11 offset:20480
    v_mfma_f32_16x16x32_bf16 v[212:215], v[32:35], v[56:59], v[212:215]
    ds_read_b128 v[140:143], v11 offset:22528
    v_mfma_f32_16x16x32_bf16 v[216:219], v[36:39], v[44:47], v[216:219]
    ds_read_b128 v[144:147], v11 offset:24576
    v_mfma_f32_16x16x32_bf16 v[220:223], v[36:39], v[48:51], v[220:223]
    ds_read_b128 v[148:151], v11 offset:26624
    v_mfma_f32_16x16x32_bf16 v[224:227], v[36:39], v[52:55], v[224:227]
    ds_read_b128 v[152:155], v11 offset:28672
    v_mfma_f32_16x16x32_bf16 v[228:231], v[36:39], v[56:59], v[228:231]
    ds_read_b128 v[156:159], v11 offset:30720
    v_mfma_f32_16x16x32_bf16 v[232:235], v[40:43], v[44:47], v[232:235]
    ds_read_b128 v[160:163], v11 offset:32768
    v_mfma_f32_16x16x32_bf16 v[236:239], v[40:43], v[48:51], v[236:239]
    ds_read_b128 v[164:167], v11 offset:34816
    v_mfma_f32_16x16x32_bf16 v[240:243], v[40:43], v[52:55], v[240:243]
    v_mfma_f32_16x16x32_bf16 v[244:247], v[40:43], v[56:59], v[244:247]
    v_mfma_f32_16x16x32_bf16 v[168:171], v[60:63], v[80:83], v[168:171]
    v_mfma_f32_16x16x32_bf16 v[172:175], v[60:63], v[84:87], v[172:175]
    s_waitcnt lgkmcnt(0)
    v_mfma_f32_16x16x32_bf16 v[176:179], v[60:63], v[88:91], v[176:179]
    s_add_u32 m0, s35, 18432
    s_add_u32 s36, s33, 640
    buffer_load_dwordx4 v12, s[24:27], s36 offen lds
    v_mfma_f32_16x16x32_bf16 v[180:183], v[60:63], v[92:95], v[180:183]
    s_add_u32 m0, s35, 19456
    s_add_u32 s36, s33, 26240
    buffer_load_dwordx4 v13, s[24:27], s36 offen lds
    v_mfma_f32_16x16x32_bf16 v[184:187], v[64:67], v[80:83], v[184:187]
    s_add_u32 m0, s35, 20480
    s_add_u32 s36, s33, 51840
    buffer_load_dwordx4 v12, s[24:27], s36 offen lds
    v_mfma_f32_16x16x32_bf16 v[188:191], v[64:67], v[84:87], v[188:191]
    s_add_u32 m0, s35, 21504
    s_add_u32 s36, s33, 77440
    buffer_load_dwordx4 v13, s[24:27], s36 offen lds
    v_mfma_f32_16x16x32_bf16 v[192:195], v[64:67], v[88:91], v[192:195]
    s_add_u32 m0, s35, 22528
    s_add_u32 s36, s33, 103040
    buffer_load_dwordx4 v12, s[24:27], s36 offen lds
    v_mfma_f32_16x16x32_bf16 v[196:199], v[64:67], v[92:95], v[196:199]
    s_add_u32 m0, s35, 23552
    s_add_u32 s36, s33, 128640
    buffer_load_dwordx4 v13, s[24:27], s36 offen lds
    v_mfma_f32_16x16x32_bf16 v[200:203], v[68:71], v[80:83], v[200:203]
    s_add_u32 m0, s35, 24576
    s_add_u32 s36, s33, 154240
    buffer_load_dwordx4 v12, s[24:27], s36 offen lds
    v_mfma_f32_16x16x32_bf16 v[204:207], v[68:71], v[84:87], v[204:207]
    s_add_u32 m0, s35, 25600
    s_add_u32 s36, s33, 179840
    buffer_load_dwordx4 v13, s[24:27], s36 offen lds
    v_mfma_f32_16x16x32_bf16 v[208:211], v[68:71], v[88:91], v[208:211]
    s_add_u32 m0, s35, 26624
    s_add_u32 s36, s33, 205440
    buffer_load_dwordx4 v12, s[24:27], s36 offen lds
    v_mfma_f32_16x16x32_bf16 v[212:215], v[68:71], v[92:95], v[212:215]
    s_add_u32 m0, s35, 27648
    s_add_u32 s36, s33, 231040
    buffer_load_dwordx4 v13, s[24:27], s36 offen lds
    v_mfma_f32_16x16x32_bf16 v[216:219], v[72:75], v[80:83], v[216:219]
    s_add_u32 m0, s35, 28672
    s_add_u32 s36, s34, 640
    buffer_load_dwordx4 v8, s[8:11], s36 offen lds
    v_mfma_f32_16x16x32_bf16 v[220:223], v[72:75], v[84:87], v[220:223]
    s_add_u32 m0, s35, 29696
    s_add_u32 s36, s34, 46720
    buffer_load_dwordx4 v9, s[8:11], s36 offen lds
    v_mfma_f32_16x16x32_bf16 v[224:227], v[72:75], v[88:91], v[224:227]
    s_add_u32 m0, s35, 30720
    s_add_u32 s36, s34, 92800
    buffer_load_dwordx4 v8, s[8:11], s36 offen lds
    v_mfma_f32_16x16x32_bf16 v[228:231], v[72:75], v[92:95], v[228:231]
    s_add_u32 m0, s35, 31744
    s_add_u32 s36, s34, 138880
    buffer_load_dwordx4 v9, s[8:11], s36 offen lds
    v_mfma_f32_16x16x32_bf16 v[232:235], v[76:79], v[80:83], v[232:235]
    s_add_u32 m0, s35, 32768
    s_add_u32 s36, s34, 184960
    buffer_load_dwordx4 v8, s[8:11], s36 offen lds
    v_mfma_f32_16x16x32_bf16 v[236:239], v[76:79], v[84:87], v[236:239]
    s_add_u32 m0, s35, 33792
    s_add_u32 s36, s34, 231040
    buffer_load_dwordx4 v9, s[8:11], s36 offen lds
    v_mfma_f32_16x16x32_bf16 v[240:243], v[76:79], v[88:91], v[240:243]
    s_add_u32 m0, s35, 34816
    s_add_u32 s36, s34, 277120
    buffer_load_dwordx4 v8, s[8:11], s36 offen lds
    v_mfma_f32_16x16x32_bf16 v[244:247], v[76:79], v[92:95], v[244:247]
    s_add_u32 m0, s35, 35840
    s_add_u32 s36, s34, 323200
    buffer_load_dwordx4 v9, s[8:11], s36 offen lds
    s_waitcnt lgkmcnt(0)
    s_waitcnt vmcnt(18)
    v_mfma_f32_16x16x32_bf16 v[168:171], v[96:99], v[116:119], v[168:171]
    ds_read_b128 v[24:27], v10 offset:0
    v_mfma_f32_16x16x32_bf16 v[172:175], v[96:99], v[120:123], v[172:175]
    ds_read_b128 v[28:31], v10 offset:2048
    v_mfma_f32_16x16x32_bf16 v[176:179], v[96:99], v[124:127], v[176:179]
    ds_read_b128 v[32:35], v10 offset:4096
    v_mfma_f32_16x16x32_bf16 v[180:183], v[96:99], v[128:131], v[180:183]
    ds_read_b128 v[36:39], v10 offset:6144
    v_mfma_f32_16x16x32_bf16 v[184:187], v[100:103], v[116:119], v[184:187]
    ds_read_b128 v[40:43], v10 offset:8192
    v_mfma_f32_16x16x32_bf16 v[188:191], v[100:103], v[120:123], v[188:191]
    ds_read_b128 v[44:47], v10 offset:10240
    v_mfma_f32_16x16x32_bf16 v[192:195], v[100:103], v[124:127], v[192:195]
    ds_read_b128 v[48:51], v10 offset:12288
    v_mfma_f32_16x16x32_bf16 v[196:199], v[100:103], v[128:131], v[196:199]
    ds_read_b128 v[52:55], v10 offset:14336
    v_mfma_f32_16x16x32_bf16 v[200:203], v[104:107], v[116:119], v[200:203]
    ds_read_b128 v[56:59], v10 offset:16384
    v_mfma_f32_16x16x32_bf16 v[204:207], v[104:107], v[120:123], v[204:207]
    ds_read_b128 v[60:63], v11 offset:0
    v_mfma_f32_16x16x32_bf16 v[208:211], v[104:107], v[124:127], v[208:211]
    ds_read_b128 v[64:67], v11 offset:2048
    v_mfma_f32_16x16x32_bf16 v[212:215], v[104:107], v[128:131], v[212:215]
    ds_read_b128 v[68:71], v11 offset:4096
    v_mfma_f32_16x16x32_bf16 v[216:219], v[108:111], v[116:119], v[216:219]
    ds_read_b128 v[72:75], v11 offset:6144
    v_mfma_f32_16x16x32_bf16 v[220:223], v[108:111], v[120:123], v[220:223]
    ds_read_b128 v[76:79], v11 offset:8192
    v_mfma_f32_16x16x32_bf16 v[224:227], v[108:111], v[124:127], v[224:227]
    ds_read_b128 v[80:83], v11 offset:10240
    v_mfma_f32_16x16x32_bf16 v[228:231], v[108:111], v[128:131], v[228:231]
    ds_read_b128 v[84:87], v11 offset:12288
    v_mfma_f32_16x16x32_bf16 v[232:235], v[112:115], v[116:119], v[232:235]
    ds_read_b128 v[88:91], v11 offset:14336
    v_mfma_f32_16x16x32_bf16 v[236:239], v[112:115], v[120:123], v[236:239]
    ds_read_b128 v[92:95], v11 offset:16384
    v_mfma_f32_16x16x32_bf16 v[240:243], v[112:115], v[124:127], v[240:243]
    v_mfma_f32_16x16x32_bf16 v[244:247], v[112:115], v[128:131], v[244:247]
    v_mfma_f32_16x16x32_bf16 v[168:171], v[132:135], v[152:155], v[168:171]
    v_mfma_f32_16x16x32_bf16 v[172:175], v[132:135], v[156:159], v[172:175]
    s_waitcnt lgkmcnt(0)
    v_mfma_f32_16x16x32_bf16 v[176:179], v[132:135], v[160:163], v[176:179]
    s_add_u32 m0, s35, 0
    s_add_u32 s36, s33, 768
    buffer_load_dwordx4 v12, s[24:27], s36 offen lds
    v_mfma_f32_16x16x32_bf16 v[180:183], v[132:135], v[164:167], v[180:183]
    s_add_u32 m0, s35, 1024
    s_add_u32 s36, s33, 26368
    buffer_load_dwordx4 v13, s[24:27], s36 offen lds
    v_mfma_f32_16x16x32_bf16 v[184:187], v[136:139], v[152:155], v[184:187]
    s_add_u32 m0, s35, 2048
    s_add_u32 s36, s33, 51968
    buffer_load_dwordx4 v12, s[24:27], s36 offen lds
    v_mfma_f32_16x16x32_bf16 v[188:191], v[136:139], v[156:159], v[188:191]
    s_add_u32 m0, s35, 3072
    s_add_u32 s36, s33, 77568
    buffer_load_dwordx4 v13, s[24:27], s36 offen lds
    v_mfma_f32_16x16x32_bf16 v[192:195], v[136:139], v[160:163], v[192:195]
    s_add_u32 m0, s35, 4096
    s_add_u32 s36, s33, 103168
    buffer_load_dwordx4 v12, s[24:27], s36 offen lds
    v_mfma_f32_16x16x32_bf16 v[196:199], v[136:139], v[164:167], v[196:199]
    s_add_u32 m0, s35, 5120
    s_add_u32 s36, s33, 128768
    buffer_load_dwordx4 v13, s[24:27], s36 offen lds
    v_mfma_f32_16x16x32_bf16 v[200:203], v[140:143], v[152:155], v[200:203]
    s_add_u32 m0, s35, 6144
    s_add_u32 s36, s33, 154368
    buffer_load_dwordx4 v12, s[24:27], s36 offen lds
    v_mfma_f32_16x16x32_bf16 v[204:207], v[140:143], v[156:159], v[204:207]
    s_add_u32 m0, s35, 7168
    s_add_u32 s36, s33, 179968
    buffer_load_dwordx4 v13, s[24:27], s36 offen lds
    v_mfma_f32_16x16x32_bf16 v[208:211], v[140:143], v[160:163], v[208:211]
    s_add_u32 m0, s35, 8192
    s_add_u32 s36, s33, 205568
    buffer_load_dwordx4 v12, s[24:27], s36 offen lds
    v_mfma_f32_16x16x32_bf16 v[212:215], v[140:143], v[164:167], v[212:215]
    s_add_u32 m0, s35, 9216
    s_add_u32 s36, s33, 231168
    buffer_load_dwordx4 v13, s[24:27], s36 offen lds
    v_mfma_f32_16x16x32_bf16 v[216:219], v[144:147], v[152:155], v[216:219]
    s_add_u32 m0, s35, 10240
    s_add_u32 s36, s34, 768
    buffer_load_dwordx4 v8, s[8:11], s36 offen lds
    v_mfma_f32_16x16x32_bf16 v[220:223], v[144:147], v[156:159], v[220:223]
    s_add_u32 m0, s35, 11264
    s_add_u32 s36, s34, 46848
    buffer_load_dwordx4 v9, s[8:11], s36 offen lds
    v_mfma_f32_16x16x32_bf16 v[224:227], v[144:147], v[160:163], v[224:227]
    s_add_u32 m0, s35, 12288
    s_add_u32 s36, s34, 92928
    buffer_load_dwordx4 v8, s[8:11], s36 offen lds
    v_mfma_f32_16x16x32_bf16 v[228:231], v[144:147], v[164:167], v[228:231]
    s_add_u32 m0, s35, 13312
    s_add_u32 s36, s34, 139008
    buffer_load_dwordx4 v9, s[8:11], s36 offen lds
    v_mfma_f32_16x16x32_bf16 v[232:235], v[148:151], v[152:155], v[232:235]
    s_add_u32 m0, s35, 14336
    s_add_u32 s36, s34, 185088
    buffer_load_dwordx4 v8, s[8:11], s36 offen lds
    v_mfma_f32_16x16x32_bf16 v[236:239], v[148:151], v[156:159], v[236:239]
    s_add_u32 m0, s35, 15360
    s_add_u32 s36, s34, 231168
    buffer_load_dwordx4 v9, s[8:11], s36 offen lds
    v_mfma_f32_16x16x32_bf16 v[240:243], v[148:151], v[160:163], v[240:243]
    s_add_u32 m0, s35, 16384
    s_add_u32 s36, s34, 277248
    buffer_load_dwordx4 v8, s[8:11], s36 offen lds
    v_mfma_f32_16x16x32_bf16 v[244:247], v[148:151], v[164:167], v[244:247]
    s_add_u32 m0, s35, 17408
    s_add_u32 s36, s34, 323328
    buffer_load_dwordx4 v9, s[8:11], s36 offen lds
    s_waitcnt lgkmcnt(0)
    s_waitcnt vmcnt(18)
    v_mfma_f32_16x16x32_bf16 v[168:171], v[24:27], v[44:47], v[168:171]
    ds_read_b128 v[96:99], v10 offset:18432
    v_mfma_f32_16x16x32_bf16 v[172:175], v[24:27], v[48:51], v[172:175]
    ds_read_b128 v[100:103], v10 offset:20480
    v_mfma_f32_16x16x32_bf16 v[176:179], v[24:27], v[52:55], v[176:179]
    ds_read_b128 v[104:107], v10 offset:22528
    v_mfma_f32_16x16x32_bf16 v[180:183], v[24:27], v[56:59], v[180:183]
    ds_read_b128 v[108:111], v10 offset:24576
    v_mfma_f32_16x16x32_bf16 v[184:187], v[28:31], v[44:47], v[184:187]
    ds_read_b128 v[112:115], v10 offset:26624
    v_mfma_f32_16x16x32_bf16 v[188:191], v[28:31], v[48:51], v[188:191]
    ds_read_b128 v[116:119], v10 offset:28672
    v_mfma_f32_16x16x32_bf16 v[192:195], v[28:31], v[52:55], v[192:195]
    ds_read_b128 v[120:123], v10 offset:30720
    v_mfma_f32_16x16x32_bf16 v[196:199], v[28:31], v[56:59], v[196:199]
    ds_read_b128 v[124:127], v10 offset:32768
    v_mfma_f32_16x16x32_bf16 v[200:203], v[32:35], v[44:47], v[200:203]
    ds_read_b128 v[128:131], v10 offset:34816
    v_mfma_f32_16x16x32_bf16 v[204:207], v[32:35], v[48:51], v[204:207]
    ds_read_b128 v[132:135], v11 offset:18432
    v_mfma_f32_16x16x32_bf16 v[208:211], v[32:35], v[52:55], v[208:211]
    ds_read_b128 v[136:139], v11 offset:20480
    v_mfma_f32_16x16x32_bf16 v[212:215], v[32:35], v[56:59], v[212:215]
    ds_read_b128 v[140:143], v11 offset:22528
    v_mfma_f32_16x16x32_bf16 v[216:219], v[36:39], v[44:47], v[216:219]
    ds_read_b128 v[144:147], v11 offset:24576
    v_mfma_f32_16x16x32_bf16 v[220:223], v[36:39], v[48:51], v[220:223]
    ds_read_b128 v[148:151], v11 offset:26624
    v_mfma_f32_16x16x32_bf16 v[224:227], v[36:39], v[52:55], v[224:227]
    ds_read_b128 v[152:155], v11 offset:28672
    v_mfma_f32_16x16x32_bf16 v[228:231], v[36:39], v[56:59], v[228:231]
    ds_read_b128 v[156:159], v11 offset:30720
    v_mfma_f32_16x16x32_bf16 v[232:235], v[40:43], v[44:47], v[232:235]
    ds_read_b128 v[160:163], v11 offset:32768
    v_mfma_f32_16x16x32_bf16 v[236:239], v[40:43], v[48:51], v[236:239]
    ds_read_b128 v[164:167], v11 offset:34816
    v_mfma_f32_16x16x32_bf16 v[240:243], v[40:43], v[52:55], v[240:243]
    v_mfma_f32_16x16x32_bf16 v[244:247], v[40:43], v[56:59], v[244:247]
    v_mfma_f32_16x16x32_bf16 v[168:171], v[60:63], v[80:83], v[168:171]
    v_mfma_f32_16x16x32_bf16 v[172:175], v[60:63], v[84:87], v[172:175]
    s_waitcnt lgkmcnt(0)
    v_mfma_f32_16x16x32_bf16 v[176:179], v[60:63], v[88:91], v[176:179]
    s_add_u32 m0, s35, 18432
    s_add_u32 s36, s33, 896
    buffer_load_dwordx4 v12, s[24:27], s36 offen lds
    v_mfma_f32_16x16x32_bf16 v[180:183], v[60:63], v[92:95], v[180:183]
    s_add_u32 m0, s35, 19456
    s_add_u32 s36, s33, 26496
    buffer_load_dwordx4 v13, s[24:27], s36 offen lds
    v_mfma_f32_16x16x32_bf16 v[184:187], v[64:67], v[80:83], v[184:187]
    s_add_u32 m0, s35, 20480
    s_add_u32 s36, s33, 52096
    buffer_load_dwordx4 v12, s[24:27], s36 offen lds
    v_mfma_f32_16x16x32_bf16 v[188:191], v[64:67], v[84:87], v[188:191]
    s_add_u32 m0, s35, 21504
    s_add_u32 s36, s33, 77696
    buffer_load_dwordx4 v13, s[24:27], s36 offen lds
    v_mfma_f32_16x16x32_bf16 v[192:195], v[64:67], v[88:91], v[192:195]
    s_add_u32 m0, s35, 22528
    s_add_u32 s36, s33, 103296
    buffer_load_dwordx4 v12, s[24:27], s36 offen lds
    v_mfma_f32_16x16x32_bf16 v[196:199], v[64:67], v[92:95], v[196:199]
    s_add_u32 m0, s35, 23552
    s_add_u32 s36, s33, 128896
    buffer_load_dwordx4 v13, s[24:27], s36 offen lds
    v_mfma_f32_16x16x32_bf16 v[200:203], v[68:71], v[80:83], v[200:203]
    s_add_u32 m0, s35, 24576
    s_add_u32 s36, s33, 154496
    buffer_load_dwordx4 v12, s[24:27], s36 offen lds
    v_mfma_f32_16x16x32_bf16 v[204:207], v[68:71], v[84:87], v[204:207]
    s_add_u32 m0, s35, 25600
    s_add_u32 s36, s33, 180096
    buffer_load_dwordx4 v13, s[24:27], s36 offen lds
    v_mfma_f32_16x16x32_bf16 v[208:211], v[68:71], v[88:91], v[208:211]
    s_add_u32 m0, s35, 26624
    s_add_u32 s36, s33, 205696
    buffer_load_dwordx4 v12, s[24:27], s36 offen lds
    v_mfma_f32_16x16x32_bf16 v[212:215], v[68:71], v[92:95], v[212:215]
    s_add_u32 m0, s35, 27648
    s_add_u32 s36, s33, 231296
    buffer_load_dwordx4 v13, s[24:27], s36 offen lds
    v_mfma_f32_16x16x32_bf16 v[216:219], v[72:75], v[80:83], v[216:219]
    s_add_u32 m0, s35, 28672
    s_add_u32 s36, s34, 896
    buffer_load_dwordx4 v8, s[8:11], s36 offen lds
    v_mfma_f32_16x16x32_bf16 v[220:223], v[72:75], v[84:87], v[220:223]
    s_add_u32 m0, s35, 29696
    s_add_u32 s36, s34, 46976
    buffer_load_dwordx4 v9, s[8:11], s36 offen lds
    v_mfma_f32_16x16x32_bf16 v[224:227], v[72:75], v[88:91], v[224:227]
    s_add_u32 m0, s35, 30720
    s_add_u32 s36, s34, 93056
    buffer_load_dwordx4 v8, s[8:11], s36 offen lds
    v_mfma_f32_16x16x32_bf16 v[228:231], v[72:75], v[92:95], v[228:231]
    s_add_u32 m0, s35, 31744
    s_add_u32 s36, s34, 139136
    buffer_load_dwordx4 v9, s[8:11], s36 offen lds
    v_mfma_f32_16x16x32_bf16 v[232:235], v[76:79], v[80:83], v[232:235]
    s_add_u32 m0, s35, 32768
    s_add_u32 s36, s34, 185216
    buffer_load_dwordx4 v8, s[8:11], s36 offen lds
    v_mfma_f32_16x16x32_bf16 v[236:239], v[76:79], v[84:87], v[236:239]
    s_add_u32 m0, s35, 33792
    s_add_u32 s36, s34, 231296
    buffer_load_dwordx4 v9, s[8:11], s36 offen lds
    v_mfma_f32_16x16x32_bf16 v[240:243], v[76:79], v[88:91], v[240:243]
    s_add_u32 m0, s35, 34816
    s_add_u32 s36, s34, 277376
    buffer_load_dwordx4 v8, s[8:11], s36 offen lds
    v_mfma_f32_16x16x32_bf16 v[244:247], v[76:79], v[92:95], v[244:247]
    s_add_u32 m0, s35, 35840
    s_add_u32 s36, s34, 323456
    buffer_load_dwordx4 v9, s[8:11], s36 offen lds
    s_waitcnt lgkmcnt(0)
    s_waitcnt vmcnt(18)
    v_mfma_f32_16x16x32_bf16 v[168:171], v[96:99], v[116:119], v[168:171]
    ds_read_b128 v[24:27], v10 offset:0
    v_mfma_f32_16x16x32_bf16 v[172:175], v[96:99], v[120:123], v[172:175]
    ds_read_b128 v[28:31], v10 offset:2048
    v_mfma_f32_16x16x32_bf16 v[176:179], v[96:99], v[124:127], v[176:179]
    ds_read_b128 v[32:35], v10 offset:4096
    v_mfma_f32_16x16x32_bf16 v[180:183], v[96:99], v[128:131], v[180:183]
    ds_read_b128 v[36:39], v10 offset:6144
    v_mfma_f32_16x16x32_bf16 v[184:187], v[100:103], v[116:119], v[184:187]
    ds_read_b128 v[40:43], v10 offset:8192
    v_mfma_f32_16x16x32_bf16 v[188:191], v[100:103], v[120:123], v[188:191]
    ds_read_b128 v[44:47], v10 offset:10240
    v_mfma_f32_16x16x32_bf16 v[192:195], v[100:103], v[124:127], v[192:195]
    ds_read_b128 v[48:51], v10 offset:12288
    v_mfma_f32_16x16x32_bf16 v[196:199], v[100:103], v[128:131], v[196:199]
    ds_read_b128 v[52:55], v10 offset:14336
    v_mfma_f32_16x16x32_bf16 v[200:203], v[104:107], v[116:119], v[200:203]
    ds_read_b128 v[56:59], v10 offset:16384
    v_mfma_f32_16x16x32_bf16 v[204:207], v[104:107], v[120:123], v[204:207]
    ds_read_b128 v[60:63], v11 offset:0
    v_mfma_f32_16x16x32_bf16 v[208:211], v[104:107], v[124:127], v[208:211]
    ds_read_b128 v[64:67], v11 offset:2048
    v_mfma_f32_16x16x32_bf16 v[212:215], v[104:107], v[128:131], v[212:215]
    ds_read_b128 v[68:71], v11 offset:4096
    v_mfma_f32_16x16x32_bf16 v[216:219], v[108:111], v[116:119], v[216:219]
    ds_read_b128 v[72:75], v11 offset:6144
    v_mfma_f32_16x16x32_bf16 v[220:223], v[108:111], v[120:123], v[220:223]
    ds_read_b128 v[76:79], v11 offset:8192
    v_mfma_f32_16x16x32_bf16 v[224:227], v[108:111], v[124:127], v[224:227]
    ds_read_b128 v[80:83], v11 offset:10240
    v_mfma_f32_16x16x32_bf16 v[228:231], v[108:111], v[128:131], v[228:231]
    ds_read_b128 v[84:87], v11 offset:12288
    v_mfma_f32_16x16x32_bf16 v[232:235], v[112:115], v[116:119], v[232:235]
    ds_read_b128 v[88:91], v11 offset:14336
    v_mfma_f32_16x16x32_bf16 v[236:239], v[112:115], v[120:123], v[236:239]
    ds_read_b128 v[92:95], v11 offset:16384
    v_mfma_f32_16x16x32_bf16 v[240:243], v[112:115], v[124:127], v[240:243]
    v_mfma_f32_16x16x32_bf16 v[244:247], v[112:115], v[128:131], v[244:247]
    v_mfma_f32_16x16x32_bf16 v[168:171], v[132:135], v[152:155], v[168:171]
    v_mfma_f32_16x16x32_bf16 v[172:175], v[132:135], v[156:159], v[172:175]
    s_waitcnt lgkmcnt(0)
    v_mfma_f32_16x16x32_bf16 v[176:179], v[132:135], v[160:163], v[176:179]
    s_add_u32 m0, s35, 0
    s_add_u32 s36, s33, 1024
    buffer_load_dwordx4 v12, s[24:27], s36 offen lds
    v_mfma_f32_16x16x32_bf16 v[180:183], v[132:135], v[164:167], v[180:183]
    s_add_u32 m0, s35, 1024
    s_add_u32 s36, s33, 26624
    buffer_load_dwordx4 v13, s[24:27], s36 offen lds
    v_mfma_f32_16x16x32_bf16 v[184:187], v[136:139], v[152:155], v[184:187]
    s_add_u32 m0, s35, 2048
    s_add_u32 s36, s33, 52224
    buffer_load_dwordx4 v12, s[24:27], s36 offen lds
    v_mfma_f32_16x16x32_bf16 v[188:191], v[136:139], v[156:159], v[188:191]
    s_add_u32 m0, s35, 3072
    s_add_u32 s36, s33, 77824
    buffer_load_dwordx4 v13, s[24:27], s36 offen lds
    v_mfma_f32_16x16x32_bf16 v[192:195], v[136:139], v[160:163], v[192:195]
    s_add_u32 m0, s35, 4096
    s_add_u32 s36, s33, 103424
    buffer_load_dwordx4 v12, s[24:27], s36 offen lds
    v_mfma_f32_16x16x32_bf16 v[196:199], v[136:139], v[164:167], v[196:199]
    s_add_u32 m0, s35, 5120
    s_add_u32 s36, s33, 129024
    buffer_load_dwordx4 v13, s[24:27], s36 offen lds
    v_mfma_f32_16x16x32_bf16 v[200:203], v[140:143], v[152:155], v[200:203]
    s_add_u32 m0, s35, 6144
    s_add_u32 s36, s33, 154624
    buffer_load_dwordx4 v12, s[24:27], s36 offen lds
    v_mfma_f32_16x16x32_bf16 v[204:207], v[140:143], v[156:159], v[204:207]
    s_add_u32 m0, s35, 7168
    s_add_u32 s36, s33, 180224
    buffer_load_dwordx4 v13, s[24:27], s36 offen lds
    v_mfma_f32_16x16x32_bf16 v[208:211], v[140:143], v[160:163], v[208:211]
    s_add_u32 m0, s35, 8192
    s_add_u32 s36, s33, 205824
    buffer_load_dwordx4 v12, s[24:27], s36 offen lds
    v_mfma_f32_16x16x32_bf16 v[212:215], v[140:143], v[164:167], v[212:215]
    s_add_u32 m0, s35, 9216
    s_add_u32 s36, s33, 231424
    buffer_load_dwordx4 v13, s[24:27], s36 offen lds
    v_mfma_f32_16x16x32_bf16 v[216:219], v[144:147], v[152:155], v[216:219]
    s_add_u32 m0, s35, 10240
    s_add_u32 s36, s34, 1024
    buffer_load_dwordx4 v8, s[8:11], s36 offen lds
    v_mfma_f32_16x16x32_bf16 v[220:223], v[144:147], v[156:159], v[220:223]
    s_add_u32 m0, s35, 11264
    s_add_u32 s36, s34, 47104
    buffer_load_dwordx4 v9, s[8:11], s36 offen lds
    v_mfma_f32_16x16x32_bf16 v[224:227], v[144:147], v[160:163], v[224:227]
    s_add_u32 m0, s35, 12288
    s_add_u32 s36, s34, 93184
    buffer_load_dwordx4 v8, s[8:11], s36 offen lds
    v_mfma_f32_16x16x32_bf16 v[228:231], v[144:147], v[164:167], v[228:231]
    s_add_u32 m0, s35, 13312
    s_add_u32 s36, s34, 139264
    buffer_load_dwordx4 v9, s[8:11], s36 offen lds
    v_mfma_f32_16x16x32_bf16 v[232:235], v[148:151], v[152:155], v[232:235]
    s_add_u32 m0, s35, 14336
    s_add_u32 s36, s34, 185344
    buffer_load_dwordx4 v8, s[8:11], s36 offen lds
    v_mfma_f32_16x16x32_bf16 v[236:239], v[148:151], v[156:159], v[236:239]
    s_add_u32 m0, s35, 15360
    s_add_u32 s36, s34, 231424
    buffer_load_dwordx4 v9, s[8:11], s36 offen lds
    v_mfma_f32_16x16x32_bf16 v[240:243], v[148:151], v[160:163], v[240:243]
    s_add_u32 m0, s35, 16384
    s_add_u32 s36, s34, 277504
    buffer_load_dwordx4 v8, s[8:11], s36 offen lds
    v_mfma_f32_16x16x32_bf16 v[244:247], v[148:151], v[164:167], v[244:247]
    s_add_u32 m0, s35, 17408
    s_add_u32 s36, s34, 323584
    buffer_load_dwordx4 v9, s[8:11], s36 offen lds
    s_waitcnt lgkmcnt(0)
    s_waitcnt vmcnt(18)
    v_mfma_f32_16x16x32_bf16 v[168:171], v[24:27], v[44:47], v[168:171]
    ds_read_b128 v[96:99], v10 offset:18432
    v_mfma_f32_16x16x32_bf16 v[172:175], v[24:27], v[48:51], v[172:175]
    ds_read_b128 v[100:103], v10 offset:20480
    v_mfma_f32_16x16x32_bf16 v[176:179], v[24:27], v[52:55], v[176:179]
    ds_read_b128 v[104:107], v10 offset:22528
    v_mfma_f32_16x16x32_bf16 v[180:183], v[24:27], v[56:59], v[180:183]
    ds_read_b128 v[108:111], v10 offset:24576
    v_mfma_f32_16x16x32_bf16 v[184:187], v[28:31], v[44:47], v[184:187]
    ds_read_b128 v[112:115], v10 offset:26624
    v_mfma_f32_16x16x32_bf16 v[188:191], v[28:31], v[48:51], v[188:191]
    ds_read_b128 v[116:119], v10 offset:28672
    v_mfma_f32_16x16x32_bf16 v[192:195], v[28:31], v[52:55], v[192:195]
    ds_read_b128 v[120:123], v10 offset:30720
    v_mfma_f32_16x16x32_bf16 v[196:199], v[28:31], v[56:59], v[196:199]
    ds_read_b128 v[124:127], v10 offset:32768
    v_mfma_f32_16x16x32_bf16 v[200:203], v[32:35], v[44:47], v[200:203]
    ds_read_b128 v[128:131], v10 offset:34816
    v_mfma_f32_16x16x32_bf16 v[204:207], v[32:35], v[48:51], v[204:207]
    ds_read_b128 v[132:135], v11 offset:18432
    v_mfma_f32_16x16x32_bf16 v[208:211], v[32:35], v[52:55], v[208:211]
    ds_read_b128 v[136:139], v11 offset:20480
    v_mfma_f32_16x16x32_bf16 v[212:215], v[32:35], v[56:59], v[212:215]
    ds_read_b128 v[140:143], v11 offset:22528
    v_mfma_f32_16x16x32_bf16 v[216:219], v[36:39], v[44:47], v[216:219]
    ds_read_b128 v[144:147], v11 offset:24576
    v_mfma_f32_16x16x32_bf16 v[220:223], v[36:39], v[48:51], v[220:223]
    ds_read_b128 v[148:151], v11 offset:26624
    v_mfma_f32_16x16x32_bf16 v[224:227], v[36:39], v[52:55], v[224:227]
    ds_read_b128 v[152:155], v11 offset:28672
    v_mfma_f32_16x16x32_bf16 v[228:231], v[36:39], v[56:59], v[228:231]
    ds_read_b128 v[156:159], v11 offset:30720
    v_mfma_f32_16x16x32_bf16 v[232:235], v[40:43], v[44:47], v[232:235]
    ds_read_b128 v[160:163], v11 offset:32768
    v_mfma_f32_16x16x32_bf16 v[236:239], v[40:43], v[48:51], v[236:239]
    ds_read_b128 v[164:167], v11 offset:34816
    v_mfma_f32_16x16x32_bf16 v[240:243], v[40:43], v[52:55], v[240:243]
    v_mfma_f32_16x16x32_bf16 v[244:247], v[40:43], v[56:59], v[244:247]
    v_mfma_f32_16x16x32_bf16 v[168:171], v[60:63], v[80:83], v[168:171]
    v_mfma_f32_16x16x32_bf16 v[172:175], v[60:63], v[84:87], v[172:175]
    s_waitcnt lgkmcnt(0)
    v_mfma_f32_16x16x32_bf16 v[176:179], v[60:63], v[88:91], v[176:179]
    s_add_u32 m0, s35, 18432
    s_add_u32 s36, s33, 1152
    buffer_load_dwordx4 v12, s[24:27], s36 offen lds
    v_mfma_f32_16x16x32_bf16 v[180:183], v[60:63], v[92:95], v[180:183]
    s_add_u32 m0, s35, 19456
    s_add_u32 s36, s33, 26752
    buffer_load_dwordx4 v13, s[24:27], s36 offen lds
    v_mfma_f32_16x16x32_bf16 v[184:187], v[64:67], v[80:83], v[184:187]
    s_add_u32 m0, s35, 20480
    s_add_u32 s36, s33, 52352
    buffer_load_dwordx4 v12, s[24:27], s36 offen lds
    v_mfma_f32_16x16x32_bf16 v[188:191], v[64:67], v[84:87], v[188:191]
    s_add_u32 m0, s35, 21504
    s_add_u32 s36, s33, 77952
    buffer_load_dwordx4 v13, s[24:27], s36 offen lds
    v_mfma_f32_16x16x32_bf16 v[192:195], v[64:67], v[88:91], v[192:195]
    s_add_u32 m0, s35, 22528
    s_add_u32 s36, s33, 103552
    buffer_load_dwordx4 v12, s[24:27], s36 offen lds
    v_mfma_f32_16x16x32_bf16 v[196:199], v[64:67], v[92:95], v[196:199]
    s_add_u32 m0, s35, 23552
    s_add_u32 s36, s33, 129152
    buffer_load_dwordx4 v13, s[24:27], s36 offen lds
    v_mfma_f32_16x16x32_bf16 v[200:203], v[68:71], v[80:83], v[200:203]
    s_add_u32 m0, s35, 24576
    s_add_u32 s36, s33, 154752
    buffer_load_dwordx4 v12, s[24:27], s36 offen lds
    v_mfma_f32_16x16x32_bf16 v[204:207], v[68:71], v[84:87], v[204:207]
    s_add_u32 m0, s35, 25600
    s_add_u32 s36, s33, 180352
    buffer_load_dwordx4 v13, s[24:27], s36 offen lds
    v_mfma_f32_16x16x32_bf16 v[208:211], v[68:71], v[88:91], v[208:211]
    s_add_u32 m0, s35, 26624
    s_add_u32 s36, s33, 205952
    buffer_load_dwordx4 v12, s[24:27], s36 offen lds
    v_mfma_f32_16x16x32_bf16 v[212:215], v[68:71], v[92:95], v[212:215]
    s_add_u32 m0, s35, 27648
    s_add_u32 s36, s33, 231552
    buffer_load_dwordx4 v13, s[24:27], s36 offen lds
    v_mfma_f32_16x16x32_bf16 v[216:219], v[72:75], v[80:83], v[216:219]
    s_add_u32 m0, s35, 28672
    s_add_u32 s36, s34, 1152
    buffer_load_dwordx4 v8, s[8:11], s36 offen lds
    v_mfma_f32_16x16x32_bf16 v[220:223], v[72:75], v[84:87], v[220:223]
    s_add_u32 m0, s35, 29696
    s_add_u32 s36, s34, 47232
    buffer_load_dwordx4 v9, s[8:11], s36 offen lds
    v_mfma_f32_16x16x32_bf16 v[224:227], v[72:75], v[88:91], v[224:227]
    s_add_u32 m0, s35, 30720
    s_add_u32 s36, s34, 93312
    buffer_load_dwordx4 v8, s[8:11], s36 offen lds
    v_mfma_f32_16x16x32_bf16 v[228:231], v[72:75], v[92:95], v[228:231]
    s_add_u32 m0, s35, 31744
    s_add_u32 s36, s34, 139392
    buffer_load_dwordx4 v9, s[8:11], s36 offen lds
    v_mfma_f32_16x16x32_bf16 v[232:235], v[76:79], v[80:83], v[232:235]
    s_add_u32 m0, s35, 32768
    s_add_u32 s36, s34, 185472
    buffer_load_dwordx4 v8, s[8:11], s36 offen lds
    v_mfma_f32_16x16x32_bf16 v[236:239], v[76:79], v[84:87], v[236:239]
    s_add_u32 m0, s35, 33792
    s_add_u32 s36, s34, 231552
    buffer_load_dwordx4 v9, s[8:11], s36 offen lds
    v_mfma_f32_16x16x32_bf16 v[240:243], v[76:79], v[88:91], v[240:243]
    s_add_u32 m0, s35, 34816
    s_add_u32 s36, s34, 277632
    buffer_load_dwordx4 v8, s[8:11], s36 offen lds
    v_mfma_f32_16x16x32_bf16 v[244:247], v[76:79], v[92:95], v[244:247]
    s_add_u32 m0, s35, 35840
    s_add_u32 s36, s34, 323712
    buffer_load_dwordx4 v9, s[8:11], s36 offen lds
    s_waitcnt lgkmcnt(0)
    s_waitcnt vmcnt(18)
    v_mfma_f32_16x16x32_bf16 v[168:171], v[96:99], v[116:119], v[168:171]
    ds_read_b128 v[24:27], v10 offset:0
    v_mfma_f32_16x16x32_bf16 v[172:175], v[96:99], v[120:123], v[172:175]
    ds_read_b128 v[28:31], v10 offset:2048
    v_mfma_f32_16x16x32_bf16 v[176:179], v[96:99], v[124:127], v[176:179]
    ds_read_b128 v[32:35], v10 offset:4096
    v_mfma_f32_16x16x32_bf16 v[180:183], v[96:99], v[128:131], v[180:183]
    ds_read_b128 v[36:39], v10 offset:6144
    v_mfma_f32_16x16x32_bf16 v[184:187], v[100:103], v[116:119], v[184:187]
    ds_read_b128 v[40:43], v10 offset:8192
    v_mfma_f32_16x16x32_bf16 v[188:191], v[100:103], v[120:123], v[188:191]
    ds_read_b128 v[44:47], v10 offset:10240
    v_mfma_f32_16x16x32_bf16 v[192:195], v[100:103], v[124:127], v[192:195]
    ds_read_b128 v[48:51], v10 offset:12288
    v_mfma_f32_16x16x32_bf16 v[196:199], v[100:103], v[128:131], v[196:199]
    ds_read_b128 v[52:55], v10 offset:14336
    v_mfma_f32_16x16x32_bf16 v[200:203], v[104:107], v[116:119], v[200:203]
    ds_read_b128 v[56:59], v10 offset:16384
    v_mfma_f32_16x16x32_bf16 v[204:207], v[104:107], v[120:123], v[204:207]
    ds_read_b128 v[60:63], v11 offset:0
    v_mfma_f32_16x16x32_bf16 v[208:211], v[104:107], v[124:127], v[208:211]
    ds_read_b128 v[64:67], v11 offset:2048
    v_mfma_f32_16x16x32_bf16 v[212:215], v[104:107], v[128:131], v[212:215]
    ds_read_b128 v[68:71], v11 offset:4096
    v_mfma_f32_16x16x32_bf16 v[216:219], v[108:111], v[116:119], v[216:219]
    ds_read_b128 v[72:75], v11 offset:6144
    v_mfma_f32_16x16x32_bf16 v[220:223], v[108:111], v[120:123], v[220:223]
    ds_read_b128 v[76:79], v11 offset:8192
    v_mfma_f32_16x16x32_bf16 v[224:227], v[108:111], v[124:127], v[224:227]
    ds_read_b128 v[80:83], v11 offset:10240
    v_mfma_f32_16x16x32_bf16 v[228:231], v[108:111], v[128:131], v[228:231]
    ds_read_b128 v[84:87], v11 offset:12288
    v_mfma_f32_16x16x32_bf16 v[232:235], v[112:115], v[116:119], v[232:235]
    ds_read_b128 v[88:91], v11 offset:14336
    v_mfma_f32_16x16x32_bf16 v[236:239], v[112:115], v[120:123], v[236:239]
    ds_read_b128 v[92:95], v11 offset:16384
    v_mfma_f32_16x16x32_bf16 v[240:243], v[112:115], v[124:127], v[240:243]
    v_mfma_f32_16x16x32_bf16 v[244:247], v[112:115], v[128:131], v[244:247]
    v_mfma_f32_16x16x32_bf16 v[168:171], v[132:135], v[152:155], v[168:171]
    v_mfma_f32_16x16x32_bf16 v[172:175], v[132:135], v[156:159], v[172:175]
    s_waitcnt lgkmcnt(0)
    v_mfma_f32_16x16x32_bf16 v[176:179], v[132:135], v[160:163], v[176:179]
    s_add_u32 m0, s35, 0
    s_add_u32 s36, s33, 1280
    buffer_load_dwordx4 v12, s[24:27], s36 offen lds
    v_mfma_f32_16x16x32_bf16 v[180:183], v[132:135], v[164:167], v[180:183]
    s_add_u32 m0, s35, 1024
    s_add_u32 s36, s33, 26880
    buffer_load_dwordx4 v13, s[24:27], s36 offen lds
    v_mfma_f32_16x16x32_bf16 v[184:187], v[136:139], v[152:155], v[184:187]
    s_add_u32 m0, s35, 2048
    s_add_u32 s36, s33, 52480
    buffer_load_dwordx4 v12, s[24:27], s36 offen lds
    v_mfma_f32_16x16x32_bf16 v[188:191], v[136:139], v[156:159], v[188:191]
    s_add_u32 m0, s35, 3072
    s_add_u32 s36, s33, 78080
    buffer_load_dwordx4 v13, s[24:27], s36 offen lds
    v_mfma_f32_16x16x32_bf16 v[192:195], v[136:139], v[160:163], v[192:195]
    s_add_u32 m0, s35, 4096
    s_add_u32 s36, s33, 103680
    buffer_load_dwordx4 v12, s[24:27], s36 offen lds
    v_mfma_f32_16x16x32_bf16 v[196:199], v[136:139], v[164:167], v[196:199]
    s_add_u32 m0, s35, 5120
    s_add_u32 s36, s33, 129280
    buffer_load_dwordx4 v13, s[24:27], s36 offen lds
    v_mfma_f32_16x16x32_bf16 v[200:203], v[140:143], v[152:155], v[200:203]
    s_add_u32 m0, s35, 6144
    s_add_u32 s36, s33, 154880
    buffer_load_dwordx4 v12, s[24:27], s36 offen lds
    v_mfma_f32_16x16x32_bf16 v[204:207], v[140:143], v[156:159], v[204:207]
    s_add_u32 m0, s35, 7168
    s_add_u32 s36, s33, 180480
    buffer_load_dwordx4 v13, s[24:27], s36 offen lds
    v_mfma_f32_16x16x32_bf16 v[208:211], v[140:143], v[160:163], v[208:211]
    s_add_u32 m0, s35, 8192
    s_add_u32 s36, s33, 206080
    buffer_load_dwordx4 v12, s[24:27], s36 offen lds
    v_mfma_f32_16x16x32_bf16 v[212:215], v[140:143], v[164:167], v[212:215]
    s_add_u32 m0, s35, 9216
    s_add_u32 s36, s33, 231680
    buffer_load_dwordx4 v13, s[24:27], s36 offen lds
    v_mfma_f32_16x16x32_bf16 v[216:219], v[144:147], v[152:155], v[216:219]
    s_add_u32 m0, s35, 10240
    s_add_u32 s36, s34, 1280
    buffer_load_dwordx4 v8, s[8:11], s36 offen lds
    v_mfma_f32_16x16x32_bf16 v[220:223], v[144:147], v[156:159], v[220:223]
    s_add_u32 m0, s35, 11264
    s_add_u32 s36, s34, 47360
    buffer_load_dwordx4 v9, s[8:11], s36 offen lds
    v_mfma_f32_16x16x32_bf16 v[224:227], v[144:147], v[160:163], v[224:227]
    s_add_u32 m0, s35, 12288
    s_add_u32 s36, s34, 93440
    buffer_load_dwordx4 v8, s[8:11], s36 offen lds
    v_mfma_f32_16x16x32_bf16 v[228:231], v[144:147], v[164:167], v[228:231]
    s_add_u32 m0, s35, 13312
    s_add_u32 s36, s34, 139520
    buffer_load_dwordx4 v9, s[8:11], s36 offen lds
    v_mfma_f32_16x16x32_bf16 v[232:235], v[148:151], v[152:155], v[232:235]
    s_add_u32 m0, s35, 14336
    s_add_u32 s36, s34, 185600
    buffer_load_dwordx4 v8, s[8:11], s36 offen lds
    v_mfma_f32_16x16x32_bf16 v[236:239], v[148:151], v[156:159], v[236:239]
    s_add_u32 m0, s35, 15360
    s_add_u32 s36, s34, 231680
    buffer_load_dwordx4 v9, s[8:11], s36 offen lds
    v_mfma_f32_16x16x32_bf16 v[240:243], v[148:151], v[160:163], v[240:243]
    s_add_u32 m0, s35, 16384
    s_add_u32 s36, s34, 277760
    buffer_load_dwordx4 v8, s[8:11], s36 offen lds
    v_mfma_f32_16x16x32_bf16 v[244:247], v[148:151], v[164:167], v[244:247]
    s_add_u32 m0, s35, 17408
    s_add_u32 s36, s34, 323840
    buffer_load_dwordx4 v9, s[8:11], s36 offen lds
    s_waitcnt lgkmcnt(0)
    s_waitcnt vmcnt(18)
    v_mfma_f32_16x16x32_bf16 v[168:171], v[24:27], v[44:47], v[168:171]
    ds_read_b128 v[96:99], v10 offset:18432
    v_mfma_f32_16x16x32_bf16 v[172:175], v[24:27], v[48:51], v[172:175]
    ds_read_b128 v[100:103], v10 offset:20480
    v_mfma_f32_16x16x32_bf16 v[176:179], v[24:27], v[52:55], v[176:179]
    ds_read_b128 v[104:107], v10 offset:22528
    v_mfma_f32_16x16x32_bf16 v[180:183], v[24:27], v[56:59], v[180:183]
    ds_read_b128 v[108:111], v10 offset:24576
    v_mfma_f32_16x16x32_bf16 v[184:187], v[28:31], v[44:47], v[184:187]
    ds_read_b128 v[112:115], v10 offset:26624
    v_mfma_f32_16x16x32_bf16 v[188:191], v[28:31], v[48:51], v[188:191]
    ds_read_b128 v[116:119], v10 offset:28672
    v_mfma_f32_16x16x32_bf16 v[192:195], v[28:31], v[52:55], v[192:195]
    ds_read_b128 v[120:123], v10 offset:30720
    v_mfma_f32_16x16x32_bf16 v[196:199], v[28:31], v[56:59], v[196:199]
    ds_read_b128 v[124:127], v10 offset:32768
    v_mfma_f32_16x16x32_bf16 v[200:203], v[32:35], v[44:47], v[200:203]
    ds_read_b128 v[128:131], v10 offset:34816
    v_mfma_f32_16x16x32_bf16 v[204:207], v[32:35], v[48:51], v[204:207]
    ds_read_b128 v[132:135], v11 offset:18432
    v_mfma_f32_16x16x32_bf16 v[208:211], v[32:35], v[52:55], v[208:211]
    ds_read_b128 v[136:139], v11 offset:20480
    v_mfma_f32_16x16x32_bf16 v[212:215], v[32:35], v[56:59], v[212:215]
    ds_read_b128 v[140:143], v11 offset:22528
    v_mfma_f32_16x16x32_bf16 v[216:219], v[36:39], v[44:47], v[216:219]
    ds_read_b128 v[144:147], v11 offset:24576
    v_mfma_f32_16x16x32_bf16 v[220:223], v[36:39], v[48:51], v[220:223]
    ds_read_b128 v[148:151], v11 offset:26624
    v_mfma_f32_16x16x32_bf16 v[224:227], v[36:39], v[52:55], v[224:227]
    ds_read_b128 v[152:155], v11 offset:28672
    v_mfma_f32_16x16x32_bf16 v[228:231], v[36:39], v[56:59], v[228:231]
    ds_read_b128 v[156:159], v11 offset:30720
    v_mfma_f32_16x16x32_bf16 v[232:235], v[40:43], v[44:47], v[232:235]
    ds_read_b128 v[160:163], v11 offset:32768
    v_mfma_f32_16x16x32_bf16 v[236:239], v[40:43], v[48:51], v[236:239]
    ds_read_b128 v[164:167], v11 offset:34816
    v_mfma_f32_16x16x32_bf16 v[240:243], v[40:43], v[52:55], v[240:243]
    v_mfma_f32_16x16x32_bf16 v[244:247], v[40:43], v[56:59], v[244:247]
    v_mfma_f32_16x16x32_bf16 v[168:171], v[60:63], v[80:83], v[168:171]
    v_mfma_f32_16x16x32_bf16 v[172:175], v[60:63], v[84:87], v[172:175]
    s_waitcnt lgkmcnt(0)
    v_mfma_f32_16x16x32_bf16 v[176:179], v[60:63], v[88:91], v[176:179]
    s_add_u32 m0, s35, 18432
    s_add_u32 s36, s33, 1408
    buffer_load_dwordx4 v12, s[24:27], s36 offen lds
    v_mfma_f32_16x16x32_bf16 v[180:183], v[60:63], v[92:95], v[180:183]
    s_add_u32 m0, s35, 19456
    s_add_u32 s36, s33, 27008
    buffer_load_dwordx4 v13, s[24:27], s36 offen lds
    v_mfma_f32_16x16x32_bf16 v[184:187], v[64:67], v[80:83], v[184:187]
    s_add_u32 m0, s35, 20480
    s_add_u32 s36, s33, 52608
    buffer_load_dwordx4 v12, s[24:27], s36 offen lds
    v_mfma_f32_16x16x32_bf16 v[188:191], v[64:67], v[84:87], v[188:191]
    s_add_u32 m0, s35, 21504
    s_add_u32 s36, s33, 78208
    buffer_load_dwordx4 v13, s[24:27], s36 offen lds
    v_mfma_f32_16x16x32_bf16 v[192:195], v[64:67], v[88:91], v[192:195]
    s_add_u32 m0, s35, 22528
    s_add_u32 s36, s33, 103808
    buffer_load_dwordx4 v12, s[24:27], s36 offen lds
    v_mfma_f32_16x16x32_bf16 v[196:199], v[64:67], v[92:95], v[196:199]
    s_add_u32 m0, s35, 23552
    s_add_u32 s36, s33, 129408
    buffer_load_dwordx4 v13, s[24:27], s36 offen lds
    v_mfma_f32_16x16x32_bf16 v[200:203], v[68:71], v[80:83], v[200:203]
    s_add_u32 m0, s35, 24576
    s_add_u32 s36, s33, 155008
    buffer_load_dwordx4 v12, s[24:27], s36 offen lds
    v_mfma_f32_16x16x32_bf16 v[204:207], v[68:71], v[84:87], v[204:207]
    s_add_u32 m0, s35, 25600
    s_add_u32 s36, s33, 180608
    buffer_load_dwordx4 v13, s[24:27], s36 offen lds
    v_mfma_f32_16x16x32_bf16 v[208:211], v[68:71], v[88:91], v[208:211]
    s_add_u32 m0, s35, 26624
    s_add_u32 s36, s33, 206208
    buffer_load_dwordx4 v12, s[24:27], s36 offen lds
    v_mfma_f32_16x16x32_bf16 v[212:215], v[68:71], v[92:95], v[212:215]
    s_add_u32 m0, s35, 27648
    s_add_u32 s36, s33, 231808
    buffer_load_dwordx4 v13, s[24:27], s36 offen lds
    v_mfma_f32_16x16x32_bf16 v[216:219], v[72:75], v[80:83], v[216:219]
    s_add_u32 m0, s35, 28672
    s_add_u32 s36, s34, 1408
    buffer_load_dwordx4 v8, s[8:11], s36 offen lds
    v_mfma_f32_16x16x32_bf16 v[220:223], v[72:75], v[84:87], v[220:223]
    s_add_u32 m0, s35, 29696
    s_add_u32 s36, s34, 47488
    buffer_load_dwordx4 v9, s[8:11], s36 offen lds
    v_mfma_f32_16x16x32_bf16 v[224:227], v[72:75], v[88:91], v[224:227]
    s_add_u32 m0, s35, 30720
    s_add_u32 s36, s34, 93568
    buffer_load_dwordx4 v8, s[8:11], s36 offen lds
    v_mfma_f32_16x16x32_bf16 v[228:231], v[72:75], v[92:95], v[228:231]
    s_add_u32 m0, s35, 31744
    s_add_u32 s36, s34, 139648
    buffer_load_dwordx4 v9, s[8:11], s36 offen lds
    v_mfma_f32_16x16x32_bf16 v[232:235], v[76:79], v[80:83], v[232:235]
    s_add_u32 m0, s35, 32768
    s_add_u32 s36, s34, 185728
    buffer_load_dwordx4 v8, s[8:11], s36 offen lds
    v_mfma_f32_16x16x32_bf16 v[236:239], v[76:79], v[84:87], v[236:239]
    s_add_u32 m0, s35, 33792
    s_add_u32 s36, s34, 231808
    buffer_load_dwordx4 v9, s[8:11], s36 offen lds
    v_mfma_f32_16x16x32_bf16 v[240:243], v[76:79], v[88:91], v[240:243]
    s_add_u32 m0, s35, 34816
    s_add_u32 s36, s34, 277888
    buffer_load_dwordx4 v8, s[8:11], s36 offen lds
    v_mfma_f32_16x16x32_bf16 v[244:247], v[76:79], v[92:95], v[244:247]
    s_add_u32 m0, s35, 35840
    s_add_u32 s36, s34, 323968
    buffer_load_dwordx4 v9, s[8:11], s36 offen lds
    s_waitcnt lgkmcnt(0)
    s_waitcnt vmcnt(18)
    v_mfma_f32_16x16x32_bf16 v[168:171], v[96:99], v[116:119], v[168:171]
    ds_read_b128 v[24:27], v10 offset:0
    v_mfma_f32_16x16x32_bf16 v[172:175], v[96:99], v[120:123], v[172:175]
    ds_read_b128 v[28:31], v10 offset:2048
    v_mfma_f32_16x16x32_bf16 v[176:179], v[96:99], v[124:127], v[176:179]
    ds_read_b128 v[32:35], v10 offset:4096
    v_mfma_f32_16x16x32_bf16 v[180:183], v[96:99], v[128:131], v[180:183]
    ds_read_b128 v[36:39], v10 offset:6144
    v_mfma_f32_16x16x32_bf16 v[184:187], v[100:103], v[116:119], v[184:187]
    ds_read_b128 v[40:43], v10 offset:8192
    v_mfma_f32_16x16x32_bf16 v[188:191], v[100:103], v[120:123], v[188:191]
    ds_read_b128 v[44:47], v10 offset:10240
    v_mfma_f32_16x16x32_bf16 v[192:195], v[100:103], v[124:127], v[192:195]
    ds_read_b128 v[48:51], v10 offset:12288
    v_mfma_f32_16x16x32_bf16 v[196:199], v[100:103], v[128:131], v[196:199]
    ds_read_b128 v[52:55], v10 offset:14336
    v_mfma_f32_16x16x32_bf16 v[200:203], v[104:107], v[116:119], v[200:203]
    ds_read_b128 v[56:59], v10 offset:16384
    v_mfma_f32_16x16x32_bf16 v[204:207], v[104:107], v[120:123], v[204:207]
    ds_read_b128 v[60:63], v11 offset:0
    v_mfma_f32_16x16x32_bf16 v[208:211], v[104:107], v[124:127], v[208:211]
    ds_read_b128 v[64:67], v11 offset:2048
    v_mfma_f32_16x16x32_bf16 v[212:215], v[104:107], v[128:131], v[212:215]
    ds_read_b128 v[68:71], v11 offset:4096
    v_mfma_f32_16x16x32_bf16 v[216:219], v[108:111], v[116:119], v[216:219]
    ds_read_b128 v[72:75], v11 offset:6144
    v_mfma_f32_16x16x32_bf16 v[220:223], v[108:111], v[120:123], v[220:223]
    ds_read_b128 v[76:79], v11 offset:8192
    v_mfma_f32_16x16x32_bf16 v[224:227], v[108:111], v[124:127], v[224:227]
    ds_read_b128 v[80:83], v11 offset:10240
    v_mfma_f32_16x16x32_bf16 v[228:231], v[108:111], v[128:131], v[228:231]
    ds_read_b128 v[84:87], v11 offset:12288
    v_mfma_f32_16x16x32_bf16 v[232:235], v[112:115], v[116:119], v[232:235]
    ds_read_b128 v[88:91], v11 offset:14336
    v_mfma_f32_16x16x32_bf16 v[236:239], v[112:115], v[120:123], v[236:239]
    ds_read_b128 v[92:95], v11 offset:16384
    v_mfma_f32_16x16x32_bf16 v[240:243], v[112:115], v[124:127], v[240:243]
    v_mfma_f32_16x16x32_bf16 v[244:247], v[112:115], v[128:131], v[244:247]
    v_mfma_f32_16x16x32_bf16 v[168:171], v[132:135], v[152:155], v[168:171]
    v_mfma_f32_16x16x32_bf16 v[172:175], v[132:135], v[156:159], v[172:175]
    v_mfma_f32_16x16x32_bf16 v[176:179], v[132:135], v[160:163], v[176:179]
    v_mfma_f32_16x16x32_bf16 v[180:183], v[132:135], v[164:167], v[180:183]
    v_mfma_f32_16x16x32_bf16 v[184:187], v[136:139], v[152:155], v[184:187]
    v_mfma_f32_16x16x32_bf16 v[188:191], v[136:139], v[156:159], v[188:191]
    v_mfma_f32_16x16x32_bf16 v[192:195], v[136:139], v[160:163], v[192:195]
    v_mfma_f32_16x16x32_bf16 v[196:199], v[136:139], v[164:167], v[196:199]
    v_mfma_f32_16x16x32_bf16 v[200:203], v[140:143], v[152:155], v[200:203]
    v_mfma_f32_16x16x32_bf16 v[204:207], v[140:143], v[156:159], v[204:207]
    v_mfma_f32_16x16x32_bf16 v[208:211], v[140:143], v[160:163], v[208:211]
    v_mfma_f32_16x16x32_bf16 v[212:215], v[140:143], v[164:167], v[212:215]
    v_mfma_f32_16x16x32_bf16 v[216:219], v[144:147], v[152:155], v[216:219]
    v_mfma_f32_16x16x32_bf16 v[220:223], v[144:147], v[156:159], v[220:223]
    v_mfma_f32_16x16x32_bf16 v[224:227], v[144:147], v[160:163], v[224:227]
    v_mfma_f32_16x16x32_bf16 v[228:231], v[144:147], v[164:167], v[228:231]
    v_mfma_f32_16x16x32_bf16 v[232:235], v[148:151], v[152:155], v[232:235]
    v_mfma_f32_16x16x32_bf16 v[236:239], v[148:151], v[156:159], v[236:239]
    v_mfma_f32_16x16x32_bf16 v[240:243], v[148:151], v[160:163], v[240:243]
    v_mfma_f32_16x16x32_bf16 v[244:247], v[148:151], v[164:167], v[244:247]
    s_waitcnt lgkmcnt(0)
    s_waitcnt vmcnt(0)
    v_mfma_f32_16x16x32_bf16 v[168:171], v[24:27], v[44:47], v[168:171]
    ds_read_b128 v[96:99], v10 offset:18432
    v_mfma_f32_16x16x32_bf16 v[172:175], v[24:27], v[48:51], v[172:175]
    ds_read_b128 v[100:103], v10 offset:20480
    v_mfma_f32_16x16x32_bf16 v[176:179], v[24:27], v[52:55], v[176:179]
    ds_read_b128 v[104:107], v10 offset:22528
    v_mfma_f32_16x16x32_bf16 v[180:183], v[24:27], v[56:59], v[180:183]
    ds_read_b128 v[108:111], v10 offset:24576
    v_mfma_f32_16x16x32_bf16 v[184:187], v[28:31], v[44:47], v[184:187]
    ds_read_b128 v[112:115], v10 offset:26624
    v_mfma_f32_16x16x32_bf16 v[188:191], v[28:31], v[48:51], v[188:191]
    ds_read_b128 v[116:119], v10 offset:28672
    v_mfma_f32_16x16x32_bf16 v[192:195], v[28:31], v[52:55], v[192:195]
    ds_read_b128 v[120:123], v10 offset:30720
    v_mfma_f32_16x16x32_bf16 v[196:199], v[28:31], v[56:59], v[196:199]
    ds_read_b128 v[124:127], v10 offset:32768
    v_mfma_f32_16x16x32_bf16 v[200:203], v[32:35], v[44:47], v[200:203]
    ds_read_b128 v[128:131], v10 offset:34816
    v_mfma_f32_16x16x32_bf16 v[204:207], v[32:35], v[48:51], v[204:207]
    ds_read_b128 v[132:135], v11 offset:18432
    v_mfma_f32_16x16x32_bf16 v[208:211], v[32:35], v[52:55], v[208:211]
    ds_read_b128 v[136:139], v11 offset:20480
    v_mfma_f32_16x16x32_bf16 v[212:215], v[32:35], v[56:59], v[212:215]
    ds_read_b128 v[140:143], v11 offset:22528
    v_mfma_f32_16x16x32_bf16 v[216:219], v[36:39], v[44:47], v[216:219]
    ds_read_b128 v[144:147], v11 offset:24576
    v_mfma_f32_16x16x32_bf16 v[220:223], v[36:39], v[48:51], v[220:223]
    ds_read_b128 v[148:151], v11 offset:26624
    v_mfma_f32_16x16x32_bf16 v[224:227], v[36:39], v[52:55], v[224:227]
    ds_read_b128 v[152:155], v11 offset:28672
    v_mfma_f32_16x16x32_bf16 v[228:231], v[36:39], v[56:59], v[228:231]
    ds_read_b128 v[156:159], v11 offset:30720
    v_mfma_f32_16x16x32_bf16 v[232:235], v[40:43], v[44:47], v[232:235]
    ds_read_b128 v[160:163], v11 offset:32768
    v_mfma_f32_16x16x32_bf16 v[236:239], v[40:43], v[48:51], v[236:239]
    ds_read_b128 v[164:167], v11 offset:34816
    v_mfma_f32_16x16x32_bf16 v[240:243], v[40:43], v[52:55], v[240:243]
    v_mfma_f32_16x16x32_bf16 v[244:247], v[40:43], v[56:59], v[244:247]
    v_mfma_f32_16x16x32_bf16 v[168:171], v[60:63], v[80:83], v[168:171]
    v_mfma_f32_16x16x32_bf16 v[172:175], v[60:63], v[84:87], v[172:175]
    v_mfma_f32_16x16x32_bf16 v[176:179], v[60:63], v[88:91], v[176:179]
    v_mfma_f32_16x16x32_bf16 v[180:183], v[60:63], v[92:95], v[180:183]
    v_mfma_f32_16x16x32_bf16 v[184:187], v[64:67], v[80:83], v[184:187]
    v_mfma_f32_16x16x32_bf16 v[188:191], v[64:67], v[84:87], v[188:191]
    v_mfma_f32_16x16x32_bf16 v[192:195], v[64:67], v[88:91], v[192:195]
    v_mfma_f32_16x16x32_bf16 v[196:199], v[64:67], v[92:95], v[196:199]
    v_mfma_f32_16x16x32_bf16 v[200:203], v[68:71], v[80:83], v[200:203]
    v_mfma_f32_16x16x32_bf16 v[204:207], v[68:71], v[84:87], v[204:207]
    v_mfma_f32_16x16x32_bf16 v[208:211], v[68:71], v[88:91], v[208:211]
    v_mfma_f32_16x16x32_bf16 v[212:215], v[68:71], v[92:95], v[212:215]
    v_mfma_f32_16x16x32_bf16 v[216:219], v[72:75], v[80:83], v[216:219]
    v_mfma_f32_16x16x32_bf16 v[220:223], v[72:75], v[84:87], v[220:223]
    v_mfma_f32_16x16x32_bf16 v[224:227], v[72:75], v[88:91], v[224:227]
    v_mfma_f32_16x16x32_bf16 v[228:231], v[72:75], v[92:95], v[228:231]
    v_mfma_f32_16x16x32_bf16 v[232:235], v[76:79], v[80:83], v[232:235]
    v_mfma_f32_16x16x32_bf16 v[236:239], v[76:79], v[84:87], v[236:239]
    v_mfma_f32_16x16x32_bf16 v[240:243], v[76:79], v[88:91], v[240:243]
    v_mfma_f32_16x16x32_bf16 v[244:247], v[76:79], v[92:95], v[244:247]
    s_waitcnt lgkmcnt(0)
    v_mfma_f32_16x16x32_bf16 v[168:171], v[96:99], v[116:119], v[168:171]
    v_mfma_f32_16x16x32_bf16 v[172:175], v[96:99], v[120:123], v[172:175]
    v_mfma_f32_16x16x32_bf16 v[176:179], v[96:99], v[124:127], v[176:179]
    v_mfma_f32_16x16x32_bf16 v[180:183], v[96:99], v[128:131], v[180:183]
    v_mfma_f32_16x16x32_bf16 v[184:187], v[100:103], v[116:119], v[184:187]
    v_mfma_f32_16x16x32_bf16 v[188:191], v[100:103], v[120:123], v[188:191]
    v_mfma_f32_16x16x32_bf16 v[192:195], v[100:103], v[124:127], v[192:195]
    v_mfma_f32_16x16x32_bf16 v[196:199], v[100:103], v[128:131], v[196:199]
    v_mfma_f32_16x16x32_bf16 v[200:203], v[104:107], v[116:119], v[200:203]
    v_mfma_f32_16x16x32_bf16 v[204:207], v[104:107], v[120:123], v[204:207]
    v_mfma_f32_16x16x32_bf16 v[208:211], v[104:107], v[124:127], v[208:211]
    v_mfma_f32_16x16x32_bf16 v[212:215], v[104:107], v[128:131], v[212:215]
    v_mfma_f32_16x16x32_bf16 v[216:219], v[108:111], v[116:119], v[216:219]
    v_mfma_f32_16x16x32_bf16 v[220:223], v[108:111], v[120:123], v[220:223]
    v_mfma_f32_16x16x32_bf16 v[224:227], v[108:111], v[124:127], v[224:227]
    v_mfma_f32_16x16x32_bf16 v[228:231], v[108:111], v[128:131], v[228:231]
    v_mfma_f32_16x16x32_bf16 v[232:235], v[112:115], v[116:119], v[232:235]
    v_mfma_f32_16x16x32_bf16 v[236:239], v[112:115], v[120:123], v[236:239]
    v_mfma_f32_16x16x32_bf16 v[240:243], v[112:115], v[124:127], v[240:243]
    v_mfma_f32_16x16x32_bf16 v[244:247], v[112:115], v[128:131], v[244:247]
    v_mfma_f32_16x16x32_bf16 v[168:171], v[132:135], v[152:155], v[168:171]
    v_mfma_f32_16x16x32_bf16 v[172:175], v[132:135], v[156:159], v[172:175]
    v_mfma_f32_16x16x32_bf16 v[176:179], v[132:135], v[160:163], v[176:179]
    v_mfma_f32_16x16x32_bf16 v[180:183], v[132:135], v[164:167], v[180:183]
    v_mfma_f32_16x16x32_bf16 v[184:187], v[136:139], v[152:155], v[184:187]
    v_mfma_f32_16x16x32_bf16 v[188:191], v[136:139], v[156:159], v[188:191]
    v_mfma_f32_16x16x32_bf16 v[192:195], v[136:139], v[160:163], v[192:195]
    v_mfma_f32_16x16x32_bf16 v[196:199], v[136:139], v[164:167], v[196:199]
    v_mfma_f32_16x16x32_bf16 v[200:203], v[140:143], v[152:155], v[200:203]
    v_mfma_f32_16x16x32_bf16 v[204:207], v[140:143], v[156:159], v[204:207]
    v_mfma_f32_16x16x32_bf16 v[208:211], v[140:143], v[160:163], v[208:211]
    v_mfma_f32_16x16x32_bf16 v[212:215], v[140:143], v[164:167], v[212:215]
    v_mfma_f32_16x16x32_bf16 v[216:219], v[144:147], v[152:155], v[216:219]
    v_mfma_f32_16x16x32_bf16 v[220:223], v[144:147], v[156:159], v[220:223]
    v_mfma_f32_16x16x32_bf16 v[224:227], v[144:147], v[160:163], v[224:227]
    v_mfma_f32_16x16x32_bf16 v[228:231], v[144:147], v[164:167], v[228:231]
    v_mfma_f32_16x16x32_bf16 v[232:235], v[148:151], v[152:155], v[232:235]
    v_mfma_f32_16x16x32_bf16 v[236:239], v[148:151], v[156:159], v[236:239]
    v_mfma_f32_16x16x32_bf16 v[240:243], v[148:151], v[160:163], v[240:243]
    v_mfma_f32_16x16x32_bf16 v[244:247], v[148:151], v[164:167], v[244:247]
k2_epi:
    s_mov_b32 s37, 0xccccccd
    s_lshl_b32 s34, s30, 6
    s_lshl_b32 s38, s32, 4
    s_add_u32 s34, s34, s38
    s_mul_i32 s38, s31, 80
    s_mul_i32 s39, s32, 5376
    s_movk_i32 s36, 1408
    v_add_u32 v5, 0, v2
    v_mul_hi_u32 v6, v5, s37
    v_mul_u32_u24 v7, 20, v6
    v_sub_u32 v7, v5, v7
    v_mul_u32_u24 v9, 336, v6
    v_lshl_add_u32 v9, v7, 4, v9
    v_add_u32 v54, s39, v9
    v_add_u32 v6, s34, v6
    v_lshl_add_u32 v7, v7, 2, s38
    v_mul_u32_u24 v8, 640, v6
    v_add_u32 v8, v8, v7
    v_lshlrev_b32 v59, 2, v8
    v_lshlrev_b32 v8, 1, v8
    v_mul_lo_u32 v9, v6, s36
    v_lshl_add_u32 v9, v7, 1, v9
    v_lshlrev_b32 v7, 1, v7
    buffer_load_dwordx2 v[24:25], v8, s[12:15], 0 offen
    buffer_load_dwordx2 v[34:35], v9, s[8:11], 0 offen offset:0
    buffer_load_dwordx2 v[44:45], v7, s[16:19], 0 offen
    v_add_u32 v5, 64, v2
    v_mul_hi_u32 v6, v5, s37
    v_mul_u32_u24 v7, 20, v6
    v_sub_u32 v7, v5, v7
    v_mul_u32_u24 v9, 336, v6
    v_lshl_add_u32 v9, v7, 4, v9
    v_add_u32 v55, s39, v9
    v_add_u32 v6, s34, v6
    v_lshl_add_u32 v7, v7, 2, s38
    v_mul_u32_u24 v8, 640, v6
    v_add_u32 v8, v8, v7
    v_lshlrev_b32 v60, 2, v8
    v_lshlrev_b32 v8, 1, v8
    v_mul_lo_u32 v9, v6, s36
    v_lshl_add_u32 v9, v7, 1, v9
    v_lshlrev_b32 v7, 1, v7
    buffer_load_dwordx2 v[26:27], v8, s[12:15], 0 offen
    buffer_load_dwordx2 v[36:37], v9, s[8:11], 0 offen offset:0
    buffer_load_dwordx2 v[46:47], v7, s[16:19], 0 offen
    v_add_u32 v5, 128, v2
    v_mul_hi_u32 v6, v5, s37
    v_mul_u32_u24 v7, 20, v6
    v_sub_u32 v7, v5, v7
    v_mul_u32_u24 v9, 336, v6
    v_lshl_add_u32 v9, v7, 4, v9
    v_add_u32 v56, s39, v9
    v_add_u32 v6, s34, v6
    v_lshl_add_u32 v7, v7, 2, s38
    v_mul_u32_u24 v8, 640, v6
    v_add_u32 v8, v8, v7
    v_lshlrev_b32 v61, 2, v8
    v_lshlrev_b32 v8, 1, v8
    v_mul_lo_u32 v9, v6, s36
    v_lshl_add_u32 v9, v7, 1, v9
    v_lshlrev_b32 v7, 1, v7
    buffer_load_dwordx2 v[28:29], v8, s[12:15], 0 offen
    buffer_load_dwordx2 v[38:39], v9, s[8:11], 0 offen offset:0
    buffer_load_dwordx2 v[48:49], v7, s[16:19], 0 offen
    v_add_u32 v5, 192, v2
    v_mul_hi_u32 v6, v5, s37
    v_mul_u32_u24 v7, 20, v6
    v_sub_u32 v7, v5, v7
    v_mul_u32_u24 v9, 336, v6
    v_lshl_add_u32 v9, v7, 4, v9
    v_add_u32 v57, s39, v9
    v_add_u32 v6, s34, v6
    v_lshl_add_u32 v7, v7, 2, s38
    v_mul_u32_u24 v8, 640, v6
    v_add_u32 v8, v8, v7
    v_lshlrev_b32 v62, 2, v8
    v_lshlrev_b32 v8, 1, v8
    v_mul_lo_u32 v9, v6, s36
    v_lshl_add_u32 v9, v7, 1, v9
    v_lshlrev_b32 v7, 1, v7
    buffer_load_dwordx2 v[30:31], v8, s[12:15], 0 offen
    buffer_load_dwordx2 v[40:41], v9, s[8:11], 0 offen offset:0
    buffer_load_dwordx2 v[50:51], v7, s[16:19], 0 offen
    v_add_u32 v5, 256, v2
    v_mul_hi_u32 v6, v5, s37
    v_mul_u32_u24 v7, 20, v6
    v_sub_u32 v7, v5, v7
    v_mul_u32_u24 v9, 336, v6
    v_lshl_add_u32 v9, v7, 4, v9
    v_add_u32 v58, s39, v9
    v_add_u32 v6, s34, v6
    v_lshl_add_u32 v7, v7, 2, s38
    v_mul_u32_u24 v8, 640, v6
    v_add_u32 v8, v8, v7
    v_lshlrev_b32 v63, 2, v8
    v_lshlrev_b32 v8, 1, v8
    v_mul_lo_u32 v9, v6, s36
    v_lshl_add_u32 v9, v7, 1, v9
    v_lshlrev_b32 v7, 1, v7
    buffer_load_dwordx2 v[32:33], v8, s[12:15], 0 offen
    buffer_load_dwordx2 v[42:43], v9, s[8:11], 0 offen offset:0
    buffer_load_dwordx2 v[52:53], v7, s[16:19], 0 offen
    v_mul_u32_u24 v10, 336, v3
    v_lshl_add_u32 v10, v4, 4, v10
    v_add_u32 v10, s35, v10
    s_nop 3
    ds_write_b128 v10, v[168:171] offset:0
    ds_write_b128 v10, v[172:175] offset:5376
    ds_write_b128 v10, v[176:179] offset:10752
    ds_write_b128 v10, v[180:183] offset:16128
    ds_write_b128 v10, v[184:187] offset:64
    ds_write_b128 v10, v[188:191] offset:5440
    ds_write_b128 v10, v[192:195] offset:10816
    ds_write_b128 v10, v[196:199] offset:16192
    ds_write_b128 v10, v[200:203] offset:128
    ds_write_b128 v10, v[204:207] offset:5504
    ds_write_b128 v10, v[208:211] offset:10880
    ds_write_b128 v10, v[212:215] offset:16256
    ds_write_b128 v10, v[216:219] offset:192
    ds_write_b128 v10, v[220:223] offset:5568
    ds_write_b128 v10, v[224:227] offset:10944
    ds_write_b128 v10, v[228:231] offset:16320
    ds_write_b128 v10, v[232:235] offset:256
    ds_write_b128 v10, v[236:239] offset:5632
    ds_write_b128 v10, v[240:243] offset:11008
    ds_write_b128 v10, v[244:247] offset:16384
    s_waitcnt lgkmcnt(0)
    s_barrier
    v_add_u32 v11, 73728, v54
    ds_read_b128 v[64:67], v54
    ds_read_b128 v[84:87], v54 offset:36864
    ds_read_b128 v[104:107], v11
    ds_read_b128 v[124:127], v11 offset:36864
    v_add_u32 v11, 73728, v55
    ds_read_b128 v[68:71], v55
    ds_read_b128 v[88:91], v55 offset:36864
    ds_read_b128 v[108:111], v11
    ds_read_b128 v[128:131], v11 offset:36864
    v_add_u32 v11, 73728, v56
    ds_read_b128 v[72:75], v56
    ds_read_b128 v[92:95], v56 offset:36864
    ds_read_b128 v[112:115], v11
    ds_read_b128 v[132:135], v11 offset:36864
    v_add_u32 v11, 73728, v57
    ds_read_b128 v[76:79], v57
    ds_read_b128 v[96:99], v57 offset:36864
    ds_read_b128 v[116:119], v11
    ds_read_b128 v[136:139], v11 offset:36864
    v_add_u32 v11, 73728, v58
    ds_read_b128 v[80:83], v58
    ds_read_b128 v[100:103], v58 offset:36864
    ds_read_b128 v[120:123], v11
    ds_read_b128 v[140:143], v11 offset:36864
    s_mov_b32 s34, 0xbfb8aa3b
    s_waitcnt vmcnt(0) lgkmcnt(0)
    v_add_f32 v64, v64, v84
    v_add_f32 v104, v104, v124
    v_add_f32 v65, v65, v85
    v_add_f32 v105, v105, v125
    v_add_f32 v66, v66, v86
    v_add_f32 v106, v106, v126
    v_add_f32 v67, v67, v87
    v_add_f32 v107, v107, v127
    v_lshlrev_b32 v144, 16, v24
    v_and_b32 v145, 0xffff0000, v24
    v_lshlrev_b32 v146, 16, v25
    v_and_b32 v147, 0xffff0000, v25
    v_lshlrev_b32 v148, 16, v34
    v_and_b32 v149, 0xffff0000, v34
    v_lshlrev_b32 v150, 16, v35
    v_and_b32 v151, 0xffff0000, v35
    v_lshlrev_b32 v152, 16, v44
    v_and_b32 v153, 0xffff0000, v44
    v_lshlrev_b32 v154, 16, v45
    v_and_b32 v155, 0xffff0000, v45
    v_mul_f32 v148, v148, v152
    v_mul_f32 v149, v149, v153
    v_mul_f32 v150, v150, v154
    v_mul_f32 v151, v151, v155
    v_cvt_pk_bf16_f32 v156, v148, v149
    v_cvt_pk_bf16_f32 v158, v104, v105
    v_cvt_pk_bf16_f32 v157, v150, v151
    v_cvt_pk_bf16_f32 v159, v106, v107
    v_lshlrev_b32 v148, 16, v156
    v_and_b32 v149, 0xffff0000, v156
    v_lshlrev_b32 v152, 16, v158
    v_and_b32 v153, 0xffff0000, v158
    v_lshlrev_b32 v150, 16, v157
    v_and_b32 v151, 0xffff0000, v157
    v_lshlrev_b32 v154, 16, v159
    v_and_b32 v155, 0xffff0000, v159
    v_add_f32 v64, v64, v148
    v_mul_f32 v160, s34, v152
    v_add_f32 v65, v65, v149
    v_mul_f32 v161, s34, v153
    v_add_f32 v66, v66, v150
    v_mul_f32 v162, s34, v154
    v_add_f32 v67, v67, v151
    v_mul_f32 v163, s34, v155
    v_exp_f32 v160, v160
    v_exp_f32 v161, v161
    v_exp_f32 v162, v162
    v_exp_f32 v163, v163
    v_add_f32 v160, 1.0, v160
    v_add_f32 v161, 1.0, v161
    v_add_f32 v162, 1.0, v162
    v_add_f32 v163, 1.0, v163
    v_rcp_f32 v160, v160
    v_rcp_f32 v161, v161
    v_rcp_f32 v162, v162
    v_rcp_f32 v163, v163
    v_mul_f32 v152, v152, v160
    v_mul_f32 v153, v153, v161
    v_mul_f32 v154, v154, v162
    v_mul_f32 v155, v155, v163
    v_cvt_pk_bf16_f32 v156, v152, v153
    v_cvt_pk_bf16_f32 v157, v154, v155
    v_lshlrev_b32 v152, 16, v156
    v_and_b32 v153, 0xffff0000, v156
    v_lshlrev_b32 v154, 16, v157
    v_and_b32 v155, 0xffff0000, v157
    v_mul_f32 v164, v64, v152
    v_mul_f32 v165, v65, v153
    v_mul_f32 v166, v66, v154
    v_mul_f32 v167, v67, v155
    v_add_f32 v164, v144, v164
    v_add_f32 v165, v145, v165
    v_add_f32 v166, v146, v166
    v_add_f32 v167, v147, v167
    buffer_store_dwordx4 v[164:167], v59, s[20:23], 0 offen sc1
    v_add_f32 v68, v68, v88
    v_add_f32 v108, v108, v128
    v_add_f32 v69, v69, v89
    v_add_f32 v109, v109, v129
    v_add_f32 v70, v70, v90
    v_add_f32 v110, v110, v130
    v_add_f32 v71, v71, v91
    v_add_f32 v111, v111, v131
    v_lshlrev_b32 v176, 16, v26
    v_and_b32 v177, 0xffff0000, v26
    v_lshlrev_b32 v178, 16, v27
    v_and_b32 v179, 0xffff0000, v27
    v_lshlrev_b32 v180, 16, v36
    v_and_b32 v181, 0xffff0000, v36
    v_lshlrev_b32 v182, 16, v37
    v_and_b32 v183, 0xffff0000, v37
    v_lshlrev_b32 v184, 16, v46
    v_and_b32 v185, 0xffff0000, v46
    v_lshlrev_b32 v186, 16, v47
    v_and_b32 v187, 0xffff0000, v47
    v_mul_f32 v180, v180, v184
    v_mul_f32 v181, v181, v185
    v_mul_f32 v182, v182, v186
    v_mul_f32 v183, v183, v187
    v_cvt_pk_bf16_f32 v188, v180, v181
    v_cvt_pk_bf16_f32 v190, v108, v109
    v_cvt_pk_bf16_f32 v189, v182, v183
    v_cvt_pk_bf16_f32 v191, v110, v111
    v_lshlrev_b32 v180, 16, v188
    v_and_b32 v181, 0xffff0000, v188
    v_lshlrev_b32 v184, 16, v190
    v_and_b32 v185, 0xffff0000, v190
    v_lshlrev_b32 v182, 16, v189
    v_and_b32 v183, 0xffff0000, v189
    v_lshlrev_b32 v186, 16, v191
    v_and_b32 v187, 0xffff0000, v191
    v_add_f32 v68, v68, v180
    v_mul_f32 v192, s34, v184
    v_add_f32 v69, v69, v181
    v_mul_f32 v193, s34, v185
    v_add_f32 v70, v70, v182
    v_mul_f32 v194, s34, v186
    v_add_f32 v71, v71, v183
    v_mul_f32 v195, s34, v187
    v_exp_f32 v192, v192
    v_exp_f32 v193, v193
    v_exp_f32 v194, v194
    v_exp_f32 v195, v195
    v_add_f32 v192, 1.0, v192
    v_add_f32 v193, 1.0, v193
    v_add_f32 v194, 1.0, v194
    v_add_f32 v195, 1.0, v195
    v_rcp_f32 v192, v192
    v_rcp_f32 v193, v193
    v_rcp_f32 v194, v194
    v_rcp_f32 v195, v195
    v_mul_f32 v184, v184, v192
    v_mul_f32 v185, v185, v193
    v_mul_f32 v186, v186, v194
    v_mul_f32 v187, v187, v195
    v_cvt_pk_bf16_f32 v188, v184, v185
    v_cvt_pk_bf16_f32 v189, v186, v187
    v_lshlrev_b32 v184, 16, v188
    v_and_b32 v185, 0xffff0000, v188
    v_lshlrev_b32 v186, 16, v189
    v_and_b32 v187, 0xffff0000, v189
    v_mul_f32 v196, v68, v184
    v_mul_f32 v197, v69, v185
    v_mul_f32 v198, v70, v186
    v_mul_f32 v199, v71, v187
    v_add_f32 v196, v176, v196
    v_add_f32 v197, v177, v197
    v_add_f32 v198, v178, v198
    v_add_f32 v199, v179, v199
    buffer_store_dwordx4 v[196:199], v60, s[20:23], 0 offen sc1
    v_add_f32 v72, v72, v92
    v_add_f32 v112, v112, v132
    v_add_f32 v73, v73, v93
    v_add_f32 v113, v113, v133
    v_add_f32 v74, v74, v94
    v_add_f32 v114, v114, v134
    v_add_f32 v75, v75, v95
    v_add_f32 v115, v115, v135
    v_lshlrev_b32 v144, 16, v28
    v_and_b32 v145, 0xffff0000, v28
    v_lshlrev_b32 v146, 16, v29
    v_and_b32 v147, 0xffff0000, v29
    v_lshlrev_b32 v148, 16, v38
    v_and_b32 v149, 0xffff0000, v38
    v_lshlrev_b32 v150, 16, v39
    v_and_b32 v151, 0xffff0000, v39
    v_lshlrev_b32 v152, 16, v48
    v_and_b32 v153, 0xffff0000, v48
    v_lshlrev_b32 v154, 16, v49
    v_and_b32 v155, 0xffff0000, v49
    v_mul_f32 v148, v148, v152
    v_mul_f32 v149, v149, v153
    v_mul_f32 v150, v150, v154
    v_mul_f32 v151, v151, v155
    v_cvt_pk_bf16_f32 v156, v148, v149
    v_cvt_pk_bf16_f32 v158, v112, v113
    v_cvt_pk_bf16_f32 v157, v150, v151
    v_cvt_pk_bf16_f32 v159, v114, v115
    v_lshlrev_b32 v148, 16, v156
    v_and_b32 v149, 0xffff0000, v156
    v_lshlrev_b32 v152, 16, v158
    v_and_b32 v153, 0xffff0000, v158
    v_lshlrev_b32 v150, 16, v157
    v_and_b32 v151, 0xffff0000, v157
    v_lshlrev_b32 v154, 16, v159
    v_and_b32 v155, 0xffff0000, v159
    v_add_f32 v72, v72, v148
    v_mul_f32 v160, s34, v152
    v_add_f32 v73, v73, v149
    v_mul_f32 v161, s34, v153
    v_add_f32 v74, v74, v150
    v_mul_f32 v162, s34, v154
    v_add_f32 v75, v75, v151
    v_mul_f32 v163, s34, v155
    v_exp_f32 v160, v160
    v_exp_f32 v161, v161
    v_exp_f32 v162, v162
    v_exp_f32 v163, v163
    v_add_f32 v160, 1.0, v160
    v_add_f32 v161, 1.0, v161
    v_add_f32 v162, 1.0, v162
    v_add_f32 v163, 1.0, v163
    v_rcp_f32 v160, v160
    v_rcp_f32 v161, v161
    v_rcp_f32 v162, v162
    v_rcp_f32 v163, v163
    v_mul_f32 v152, v152, v160
    v_mul_f32 v153, v153, v161
    v_mul_f32 v154, v154, v162
    v_mul_f32 v155, v155, v163
    v_cvt_pk_bf16_f32 v156, v152, v153
    v_cvt_pk_bf16_f32 v157, v154, v155
    v_lshlrev_b32 v152, 16, v156
    v_and_b32 v153, 0xffff0000, v156
    v_lshlrev_b32 v154, 16, v157
    v_and_b32 v155, 0xffff0000, v157
    v_mul_f32 v164, v72, v152
    v_mul_f32 v165, v73, v153
    v_mul_f32 v166, v74, v154
    v_mul_f32 v167, v75, v155
    v_add_f32 v164, v144, v164
    v_add_f32 v165, v145, v165
    v_add_f32 v166, v146, v166
    v_add_f32 v167, v147, v167
    buffer_store_dwordx4 v[164:167], v61, s[20:23], 0 offen sc1
    v_add_f32 v76, v76, v96
    v_add_f32 v116, v116, v136
    v_add_f32 v77, v77, v97
    v_add_f32 v117, v117, v137
    v_add_f32 v78, v78, v98
    v_add_f32 v118, v118, v138
    v_add_f32 v79, v79, v99
    v_add_f32 v119, v119, v139
    v_lshlrev_b32 v176, 16, v30
    v_and_b32 v177, 0xffff0000, v30
    v_lshlrev_b32 v178, 16, v31
    v_and_b32 v179, 0xffff0000, v31
    v_lshlrev_b32 v180, 16, v40
    v_and_b32 v181, 0xffff0000, v40
    v_lshlrev_b32 v182, 16, v41
    v_and_b32 v183, 0xffff0000, v41
    v_lshlrev_b32 v184, 16, v50
    v_and_b32 v185, 0xffff0000, v50
    v_lshlrev_b32 v186, 16, v51
    v_and_b32 v187, 0xffff0000, v51
    v_mul_f32 v180, v180, v184
    v_mul_f32 v181, v181, v185
    v_mul_f32 v182, v182, v186
    v_mul_f32 v183, v183, v187
    v_cvt_pk_bf16_f32 v188, v180, v181
    v_cvt_pk_bf16_f32 v190, v116, v117
    v_cvt_pk_bf16_f32 v189, v182, v183
    v_cvt_pk_bf16_f32 v191, v118, v119
    v_lshlrev_b32 v180, 16, v188
    v_and_b32 v181, 0xffff0000, v188
    v_lshlrev_b32 v184, 16, v190
    v_and_b32 v185, 0xffff0000, v190
    v_lshlrev_b32 v182, 16, v189
    v_and_b32 v183, 0xffff0000, v189
    v_lshlrev_b32 v186, 16, v191
    v_and_b32 v187, 0xffff0000, v191
    v_add_f32 v76, v76, v180
    v_mul_f32 v192, s34, v184
    v_add_f32 v77, v77, v181
    v_mul_f32 v193, s34, v185
    v_add_f32 v78, v78, v182
    v_mul_f32 v194, s34, v186
    v_add_f32 v79, v79, v183
    v_mul_f32 v195, s34, v187
    v_exp_f32 v192, v192
    v_exp_f32 v193, v193
    v_exp_f32 v194, v194
    v_exp_f32 v195, v195
    v_add_f32 v192, 1.0, v192
    v_add_f32 v193, 1.0, v193
    v_add_f32 v194, 1.0, v194
    v_add_f32 v195, 1.0, v195
    v_rcp_f32 v192, v192
    v_rcp_f32 v193, v193
    v_rcp_f32 v194, v194
    v_rcp_f32 v195, v195
    v_mul_f32 v184, v184, v192
    v_mul_f32 v185, v185, v193
    v_mul_f32 v186, v186, v194
    v_mul_f32 v187, v187, v195
    v_cvt_pk_bf16_f32 v188, v184, v185
    v_cvt_pk_bf16_f32 v189, v186, v187
    v_lshlrev_b32 v184, 16, v188
    v_and_b32 v185, 0xffff0000, v188
    v_lshlrev_b32 v186, 16, v189
    v_and_b32 v187, 0xffff0000, v189
    v_mul_f32 v196, v76, v184
    v_mul_f32 v197, v77, v185
    v_mul_f32 v198, v78, v186
    v_mul_f32 v199, v79, v187
    v_add_f32 v196, v176, v196
    v_add_f32 v197, v177, v197
    v_add_f32 v198, v178, v198
    v_add_f32 v199, v179, v199
    buffer_store_dwordx4 v[196:199], v62, s[20:23], 0 offen sc1
    v_add_f32 v80, v80, v100
    v_add_f32 v120, v120, v140
    v_add_f32 v81, v81, v101
    v_add_f32 v121, v121, v141
    v_add_f32 v82, v82, v102
    v_add_f32 v122, v122, v142
    v_add_f32 v83, v83, v103
    v_add_f32 v123, v123, v143
    v_lshlrev_b32 v144, 16, v32
    v_and_b32 v145, 0xffff0000, v32
    v_lshlrev_b32 v146, 16, v33
    v_and_b32 v147, 0xffff0000, v33
    v_lshlrev_b32 v148, 16, v42
    v_and_b32 v149, 0xffff0000, v42
    v_lshlrev_b32 v150, 16, v43
    v_and_b32 v151, 0xffff0000, v43
    v_lshlrev_b32 v152, 16, v52
    v_and_b32 v153, 0xffff0000, v52
    v_lshlrev_b32 v154, 16, v53
    v_and_b32 v155, 0xffff0000, v53
    v_mul_f32 v148, v148, v152
    v_mul_f32 v149, v149, v153
    v_mul_f32 v150, v150, v154
    v_mul_f32 v151, v151, v155
    v_cvt_pk_bf16_f32 v156, v148, v149
    v_cvt_pk_bf16_f32 v158, v120, v121
    v_cvt_pk_bf16_f32 v157, v150, v151
    v_cvt_pk_bf16_f32 v159, v122, v123
    v_lshlrev_b32 v148, 16, v156
    v_and_b32 v149, 0xffff0000, v156
    v_lshlrev_b32 v152, 16, v158
    v_and_b32 v153, 0xffff0000, v158
    v_lshlrev_b32 v150, 16, v157
    v_and_b32 v151, 0xffff0000, v157
    v_lshlrev_b32 v154, 16, v159
    v_and_b32 v155, 0xffff0000, v159
    v_add_f32 v80, v80, v148
    v_mul_f32 v160, s34, v152
    v_add_f32 v81, v81, v149
    v_mul_f32 v161, s34, v153
    v_add_f32 v82, v82, v150
    v_mul_f32 v162, s34, v154
    v_add_f32 v83, v83, v151
    v_mul_f32 v163, s34, v155
    v_exp_f32 v160, v160
    v_exp_f32 v161, v161
    v_exp_f32 v162, v162
    v_exp_f32 v163, v163
    v_add_f32 v160, 1.0, v160
    v_add_f32 v161, 1.0, v161
    v_add_f32 v162, 1.0, v162
    v_add_f32 v163, 1.0, v163
    v_rcp_f32 v160, v160
    v_rcp_f32 v161, v161
    v_rcp_f32 v162, v162
    v_rcp_f32 v163, v163
    v_mul_f32 v152, v152, v160
    v_mul_f32 v153, v153, v161
    v_mul_f32 v154, v154, v162
    v_mul_f32 v155, v155, v163
    v_cvt_pk_bf16_f32 v156, v152, v153
    v_cvt_pk_bf16_f32 v157, v154, v155
    v_lshlrev_b32 v152, 16, v156
    v_and_b32 v153, 0xffff0000, v156
    v_lshlrev_b32 v154, 16, v157
    v_and_b32 v155, 0xffff0000, v157
    v_mul_f32 v164, v80, v152
    v_mul_f32 v165, v81, v153
    v_mul_f32 v166, v82, v154
    v_mul_f32 v167, v83, v155
    v_add_f32 v164, v144, v164
    v_add_f32 v165, v145, v165
    v_add_f32 v166, v146, v166
    v_add_f32 v167, v147, v167
    buffer_store_dwordx4 v[164:167], v63, s[20:23], 0 offen sc1
k2_exit:
    s_endpgm
k_code_end:
.section .rodata,"a"
.p2align 6
.amdhsa_kernel k0_kernel
  .amdhsa_next_free_vgpr 104
  .amdhsa_next_free_sgpr 48
  .amdhsa_accum_offset 104
  .amdhsa_group_segment_fixed_size 0
  .amdhsa_kernarg_size 120
  .amdhsa_user_sgpr_count 2
  .amdhsa_user_sgpr_kernarg_segment_ptr 1
  .amdhsa_system_sgpr_workgroup_id_x 1
  .amdhsa_float_denorm_mode_32 3
.end_amdhsa_kernel
.p2align 6
.amdhsa_kernel k1_kernel
  .amdhsa_next_free_vgpr 256
  .amdhsa_next_free_sgpr 102
  .amdhsa_accum_offset 256
  .amdhsa_group_segment_fixed_size 0
  .amdhsa_kernarg_size 120
  .amdhsa_user_sgpr_count 2
  .amdhsa_user_sgpr_kernarg_segment_ptr 1
  .amdhsa_system_sgpr_workgroup_id_x 1
  .amdhsa_float_denorm_mode_32 3
.end_amdhsa_kernel
.p2align 6
.amdhsa_kernel k2_kernel
  .amdhsa_next_free_vgpr 256
  .amdhsa_next_free_sgpr 102
  .amdhsa_accum_offset 256
  .amdhsa_group_segment_fixed_size 0
  .amdhsa_kernarg_size 120
  .amdhsa_user_sgpr_count 2
  .amdhsa_user_sgpr_kernarg_segment_ptr 1
  .amdhsa_system_sgpr_workgroup_id_x 1
  .amdhsa_float_denorm_mode_32 3
.end_amdhsa_kernel
```
